```python
import torch

def _softmax(x, axis=-1):
    return torch.softmax(x, dim=axis)
def _gelu(x):
    return torch.nn.functional.gelu(x, approximate="tanh")
def _silu(x):
    return torch.nn.functional.silu(x)
def _sigmoid(x):
    return torch.sigmoid(x)
def _layernorm(x, axis=-1, eps=1e-5):
    m = x.mean(dim=axis, keepdim=True)
    v = x.var(dim=axis, keepdim=True, unbiased=False)
    return (x - m) / torch.sqrt(v + eps)
def _scatter_add(tgt, idx, src, axis=0):
    return tgt.clone().index_add_(axis, idx, src)
def _segment_sum(src, seg, n):
    out = torch.zeros((n,) + src.shape[1:], dtype=src.dtype)
    return out.index_add_(0, seg, src)
def _pad(x, pw):
    flat = tuple(v for pair in reversed(pw) for v in pair)
    return torch.nn.functional.pad(x, flat)

kernel_name = 'interleave_layers__grouped_kv_mqa__moe_arch_mod__prompt'

def setup_inputs():

    _w = (lambda a: (lambda t: t.to(torch.bfloat16) if t.is_floating_point() else t)(torch.as_tensor(a)))
    def _A_setup():
        B, S, D, H = 1, 2048, 576, 32
        Dh = D // H
        return {
            "x": _w((lambda *s: torch.randn(*s, dtype=torch.bfloat16) * 0.05)(B, S, D)),
            "wq": _w((lambda *s: torch.randn(*s, dtype=torch.bfloat16) * 0.05)(D, H * Dh)),
            "wk": _w((lambda *s: torch.randn(*s, dtype=torch.bfloat16) * 0.05)(D, Dh)),
            "wv": _w((lambda *s: torch.randn(*s, dtype=torch.bfloat16) * 0.05)(D, Dh)),
            "wo": _w((lambda *s: torch.randn(*s, dtype=torch.bfloat16) * 0.05)(H * Dh, D)),
        }
    _A_in = _A_setup()

    def _B_setup():
        B, S, D, F, C = 1, 2048, 576, 4608, 1
        return {
            "x": _w((lambda *s: torch.randn(*s, dtype=torch.bfloat16) * 0.05)(B, S, D)),
            "w_r": _w((lambda *s: torch.randn(*s, dtype=torch.bfloat16) * 0.05)(D)),
            "w_gate": _w((lambda *s: torch.randn(*s, dtype=torch.bfloat16) * 0.05)(D, F)),
            "w_up": _w((lambda *s: torch.randn(*s, dtype=torch.bfloat16) * 0.05)(D, F)),
            "w_down": _w((lambda *s: torch.randn(*s, dtype=torch.bfloat16) * 0.05)(F, D)),
        }
    _B_in = _B_setup()

    return {
        "A_x": _A_in["x"],
        "A_wq": _A_in["wq"],
        "A_wk": _A_in["wk"],
        "A_wv": _A_in["wv"],
        "A_wo": _A_in["wo"],
        "B_x": _B_in["x"],
        "B_w_r": _B_in["w_r"],
        "B_w_gate": _B_in["w_gate"],
        "B_w_up": _B_in["w_up"],
        "B_w_down": _B_in["w_down"],
    }

def reference(A_x, A_wq, A_wk, A_wv, A_wo, B_x, B_w_r, B_w_gate, B_w_up, B_w_down):
    def _A_ref(x, wq, wk, wv, wo):
        B, S, D = x.shape
        H = 32
        Dh = D // H
        q = (lambda x, *d: x.permute(*d))((x @ wq).reshape(B, S, H, Dh), 0, 2, 1, 3)
        k = x @ wk
        v = x @ wv
        scores = torch.einsum("bhqd,bkd->bhqk", q, k) * (Dh ** -0.5)
        p = _softmax(scores, axis=-1)
        o = torch.einsum("bhqk,bkd->bhqd", p, v)
        return (lambda x, *d: x.permute(*d))(o, 0, 2, 1, 3).reshape(B, S, H * Dh) @ wo

    def _B_ref(x, w_r, w_gate, w_up, w_down):
        B, S, D = x.shape
        C = 1
        r = x @ w_r
        idx = torch.argsort(-r, axis=-1)[:, :C]
        idx_e = (lambda x, n, axis: torch.repeat_interleave(x, n, dim=axis))(idx.reshape(B, C, 1), D, axis=2)
        x_sel = (lambda x, i, axis: torch.take_along_dim(x, i, dim=axis))(x, idx_e, axis=1)
        g = _silu(x_sel @ w_gate)
        u = x_sel @ w_up
        y = (g * u) @ w_down
        r_sel = _sigmoid((lambda x, i, axis: torch.take_along_dim(x, i, dim=axis))(r, idx, axis=1))
        y = y * r_sel.reshape(B, C, 1)
        b_off = (torch.arange(B) * S).reshape(B, 1)
        flat_idx = (idx + b_off).reshape(B * C)
        zero = (x * 0.0).reshape(B * S, D)
        upd = _scatter_add(zero, flat_idx, y.reshape(B * C, D), axis=0)
        return x + upd.reshape(B, S, D)

    x = A_x
    x = x + _A_ref(_layernorm(x, axis=-1), A_wq, A_wk, A_wv, A_wo)
    x = x + _B_ref(_layernorm(x, axis=-1), B_w_r, B_w_gate, B_w_up, B_w_down)
    x = x + _A_ref(_layernorm(x, axis=-1), A_wq, A_wk, A_wv, A_wo)
    x = x + _B_ref(_layernorm(x, axis=-1), B_w_r, B_w_gate, B_w_up, B_w_down)
    return x
```

```asm
; @launch grid=(256,1,1) block=(768,1,1) lds=163840
.amdgcn_target "amdgcn-amd-amdhsa--gfx950"
.text
.globl interleave_layers__grouped_kv_mqa__moe_arch_mod__prompt_kernel
.p2align 8
.type interleave_layers__grouped_kv_mqa__moe_arch_mod__prompt_kernel,@function
interleave_layers__grouped_kv_mqa__moe_arch_mod__prompt_kernel:
    s_cmp_ge_u32 s2, 256
    s_cbranch_scc1 L_exit
    s_load_dwordx16 s[8:23], s[0:1], 0
    s_load_dwordx8 s[24:31], s[0:1], 64
    s_load_dwordx2 s[32:33], s[0:1], 96
    v_lshrrev_b32 v1, 6, v0
    v_and_b32 v0, 63, v0
    v_readfirstlane_b32 s3, v1
    v_lshlrev_b32 v1, 2, v0
    v_add_u32 v1, 158720, v1
    v_lshlrev_b32 v0, 4, v0
    s_lshr_b32 s4, s2, 6
    s_and_b32 s5, s2, 7
    s_lshl2_add_u32 s4, s5, s4
    s_bfe_u32 s5, s2, 0x30003
    s_and_b32 s6, s3, 3
    s_lshr_b32 s7, s3, 2
    s_mul_i32 s64, s5, 144
    s_mul_i32 s65, s4, 335872
    s_add_u32 s65, s65, 1048576
    s_mul_i32 s66, s6, 18432
    s_add_u32 s66, s66, s65
    s_mov_b32 s34, 2000000
    s_mov_b32 s35, 0
    s_mov_b32 s67, -1
    s_mov_b32 s68, 0
    s_mov_b32 s69, -1
    s_mov_b32 s39, 0x00020000
    s_mov_b32 s38, 16777216
    s_mov_b32 s42, 2359296
    s_mov_b32 s43, s39
    s_mov_b32 s46, 663552
    s_mov_b32 s47, s39
    s_mov_b32 s50, 663552
    s_mov_b32 s51, s39
    s_mov_b32 s54, 2359296
    s_mov_b32 s55, s39
    s_mov_b32 s58, 1152
    s_mov_b32 s59, s39
    s_mov_b32 s62, 5308416
    s_mov_b32 s63, s39
    s_cmp_eq_u32 s7, 1
    s_cbranch_scc1 L_B_start
    s_cmp_eq_u32 s7, 2
    s_cbranch_scc1 L_H_start
    v_lshrrev_b32 v4, 3, v0
    v_and_b32 v4, 0x20, v4
    v_and_b32 v2, 0x70, v0
    v_xor_b32 v2, v2, v4
    v_lshrrev_b32 v4, 7, v0
    v_mul_u32_u24 v4, 1152, v4
    v_add_u32 v2, v2, v4
    v_xor_b32 v3, 64, v2
    s_mul_i32 s76, s6, 768
    v_add_u32 v6, s76, v0
    v_bfe_u32 v4, v6, 4, 1
    v_bfe_u32 v5, v6, 7, 2
    v_lshl_add_u32 v4, v4, 2, v5
    v_bfe_u32 v5, v6, 9, 1
    v_lshl_add_u32 v4, v4, 1, v5
    v_bfe_u32 v5, v6, 5, 2
    v_lshl_add_u32 v4, v4, 2, v5
    v_lshrrev_b32 v5, 10, v6
    v_lshl_add_u32 v4, v5, 6, v4
    v_mul_u32_u24 v4, 1152, v4
    s_add_u32 s76, s76, 73728
    s_mul_i32 s74, s6, 6144
    s_mul_i32 s75, s6, 55296
    s_add_u32 s75, s75, s64
    s_waitcnt lgkmcnt(0)
    s_mov_b64 s[36:37], s[32:33]
    s_mov_b64 s[40:41], s[8:9]
    s_mov_b64 s[44:45], s[10:11]
    s_mov_b64 s[48:49], s[16:17]
    s_mov_b64 s[52:53], s[28:29]
    s_mov_b64 s[56:57], s[20:21]
    s_mov_b64 s[60:61], s[26:27]
    s_mov_b64 s[20:21], s[22:23]
    s_mov_b32 s22, 5308416
    s_mov_b32 s23, s39
    s_mov_b32 s26, 5308416
    s_mov_b32 s27, s39
    s_mov_b32 s28, 82944
    s_mov_b32 s29, 0
    s_barrier
    s_add_u32 m0, s74, 0
    s_add_u32 s79, s75, 0
    buffer_load_dwordx4 v2, s[44:47], s79 offen lds
    s_add_u32 m0, s74, 1024
    s_add_u32 s79, s75, 9216
    buffer_load_dwordx4 v3, s[44:47], s79 offen lds
    s_add_u32 m0, s74, 2048
    s_add_u32 s79, s75, 18432
    buffer_load_dwordx4 v2, s[44:47], s79 offen lds
    s_add_u32 m0, s74, 3072
    s_add_u32 s79, s75, 27648
    buffer_load_dwordx4 v3, s[44:47], s79 offen lds
    s_add_u32 m0, s74, 4096
    s_add_u32 s79, s75, 36864
    buffer_load_dwordx4 v2, s[44:47], s79 offen lds
    s_add_u32 m0, s74, 5120
    s_add_u32 s79, s75, 46080
    buffer_load_dwordx4 v3, s[44:47], s79 offen lds
    s_add_u32 m0, s76, 0
    s_add_u32 s79, s64, 128
    s_mov_b32 exec_hi, 0xffff
    buffer_load_dwordx4 v4, s[44:47], s79 offen lds
    s_mov_b32 exec_hi, -1
    s_add_u32 m0, s74, 24576
    s_add_u32 s79, s75, 221184
    buffer_load_dwordx4 v2, s[44:47], s79 offen lds
    s_add_u32 m0, s74, 25600
    s_add_u32 s79, s75, 230400
    buffer_load_dwordx4 v3, s[44:47], s79 offen lds
    s_add_u32 m0, s74, 26624
    s_add_u32 s79, s75, 239616
    buffer_load_dwordx4 v2, s[44:47], s79 offen lds
    s_add_u32 m0, s74, 27648
    s_add_u32 s79, s75, 248832
    buffer_load_dwordx4 v3, s[44:47], s79 offen lds
    s_add_u32 m0, s74, 28672
    s_add_u32 s79, s75, 258048
    buffer_load_dwordx4 v2, s[44:47], s79 offen lds
    s_add_u32 m0, s74, 29696
    s_add_u32 s79, s75, 267264
    buffer_load_dwordx4 v3, s[44:47], s79 offen lds
    s_add_u32 m0, s76, 3072
    s_add_u32 s79, s64, 221312
    s_mov_b32 exec_hi, 0xffff
    buffer_load_dwordx4 v4, s[44:47], s79 offen lds
    s_mov_b32 exec_hi, -1
    s_waitcnt vmcnt(7)
    s_add_u32 s79, s6, 16
    s_lshl_b64 exec, 1, s79
    v_mov_b32 v5, 1
    ds_write_b32 v1, v5
    s_mov_b64 exec, -1
L_w1:
    ds_read_b32 v5, v1
    s_waitcnt lgkmcnt(0)
    v_cmp_gt_u32 vcc, 1, v5
    s_and_b32 s79, vcc_hi, 0x3f000000
    s_cbranch_scc0 L_wd2
    s_sub_i32 s34, s34, 1
    s_cmp_gt_i32 s34, 0
    s_cbranch_scc1 L_w1
L_wd2:
    s_add_u32 m0, s74, 49152
    s_add_u32 s79, s75, 442368
    buffer_load_dwordx4 v2, s[44:47], s79 offen lds
    s_add_u32 m0, s74, 50176
    s_add_u32 s79, s75, 451584
    buffer_load_dwordx4 v3, s[44:47], s79 offen lds
    s_add_u32 m0, s74, 51200
    s_add_u32 s79, s75, 460800
    buffer_load_dwordx4 v2, s[44:47], s79 offen lds
    s_add_u32 m0, s74, 52224
    s_add_u32 s79, s75, 470016
    buffer_load_dwordx4 v3, s[44:47], s79 offen lds
    s_add_u32 m0, s74, 53248
    s_add_u32 s79, s75, 479232
    buffer_load_dwordx4 v2, s[44:47], s79 offen lds
    s_add_u32 m0, s74, 54272
    s_add_u32 s79, s75, 488448
    buffer_load_dwordx4 v3, s[44:47], s79 offen lds
    s_add_u32 m0, s76, 6144
    s_add_u32 s79, s64, 442496
    s_mov_b32 exec_hi, 0xffff
    buffer_load_dwordx4 v4, s[44:47], s79 offen lds
    s_mov_b32 exec_hi, -1
    s_waitcnt vmcnt(7)
    s_add_u32 s79, s6, 16
    s_lshl_b64 exec, 1, s79
    v_mov_b32 v4, 2
    ds_write_b32 v1, v4
    s_mov_b64 exec, -1
    s_waitcnt vmcnt(0)
    s_add_u32 s79, s6, 16
    s_lshl_b64 exec, 1, s79
    v_mov_b32 v4, 3
    ds_write_b32 v1, v4
    s_mov_b64 exec, -1
    v_bfe_u32 v3, v0, 4, 4
    s_lshl_b32 s18, s4, 6
    s_lshl_b32 s19, s6, 4
    s_add_u32 s18, s18, s19
    v_add_u32 v3, s18, v3
    v_mul_u32_u24 v3, 1152, v3
    v_lshrrev_b32 v4, 8, v0
    v_lshl_add_u32 v3, v4, 3, v3
    v_mov_b32 v142, 1.0
    v_mov_b32 v143, 0
    buffer_load_dwordx2 v[132:133], v3, s[40:43], s64 offen offset:0
    buffer_load_dwordx2 v[134:135], v3, s[40:43], s64 offen offset:32
    buffer_load_dwordx2 v[136:137], v3, s[40:43], s64 offen offset:64
    buffer_load_dwordx2 v[138:139], v3, s[40:43], s64 offen offset:96
    buffer_load_dwordx2 v[140:141], v3, s[40:43], s64 offen offset:128
L_A_att:
L_att:
    ds_read_b32 v5, v1
    s_lshl_b32 s75, 268435456, s6
    s_bitset1_b32 s75, 11
    s_lshl_b32 s72, s35, 4
    s_add_u32 s72, s72, 1
    s_xor_b32 s73, s3, 4
    s_cmp_lg_u32 s7, 0
    s_cselect_b32 s73, 11, s73
    s_mul_i32 s76, s6, 3072
    s_mul_i32 s77, s7, 1280
    s_add_u32 s76, s76, 57344
    s_add_u32 s76, s76, s28
    s_sub_u32 s78, s76, s77
    s_add_u32 s78, s78, 1280
    s_add_u32 s76, s76, s77
    s_mul_i32 s77, s7, 9472
    s_add_u32 s77, s77, s28
    v_mov_b32 v32, 0
    v_mov_b32 v33, 0
    v_mov_b32 v34, 0
    v_mov_b32 v35, 0
    v_bfe_u32 v2, v0, 6, 3
    v_mul_u32_u24 v2, 160, v2
    v_mfma_f32_32x32x4_2b_bf16 v[100:131], v[32:33], v[32:33], 0
    v_bfe_u32 v3, v0, 4, 2
    v_mad_u32_u24 v2, v3, 36, v2
    v_lshrrev_b32 v3, 9, v0
    v_lshl_add_u32 v4, v3, 4, v2
    v_add_u32 v6, s76, v4
    v_add_u32 v7, s78, v4
    v_add_u32 v68, s78, v2
    s_mov_b32 exec_hi, 0
    v_mov_b32 v68, v6
    s_mov_b32 exec_hi, -1
    v_mov_b32 v17, 0
    v_mov_b32 v18, 0
    v_add_u32 v2, s77, v0
    v_and_b32 v4, 0x1f0, v0
    s_movk_i32 s74, 304
    v_mad_u32_u24 v3, v3, s74, v4
    s_add_u32 s77, s77, 4096
    v_add_u32 v3, s77, v3
    s_mov_b32 exec_lo, 0xfff80000
    s_mov_b32 exec_hi, 0xfff80000
    v_mov_b32 v3, 0x30000
    s_mov_b64 exec, -1
    s_add_u32 s77, s77, 4864
    v_lshrrev_b32 v4, 2, v4
    v_add_u32 v4, s77, v4
    v_mov_b32 v92, 0
    v_mov_b32 v93, 0
    v_mov_b32 v94, 0
    v_mov_b32 v95, 0
    s_waitcnt lgkmcnt(0)
    v_cmp_gt_u32 vcc, s72, v5
    s_and_b32 s79, vcc_lo, s75
    s_cbranch_scc0 L_att_go
L_w3:
    ds_read_b32 v5, v1
    s_waitcnt lgkmcnt(0)
    v_cmp_gt_u32 vcc, s72, v5
    s_and_b32 s79, vcc_lo, s75
    s_cbranch_scc0 L_wd4
    s_sub_i32 s34, s34, 1
    s_cmp_gt_i32 s34, 0
    s_cbranch_scc1 L_w3
L_wd4:
L_att_go:
    ds_read_b32 v16, v68 offset:32
    ds_read_b32 v20, v4
    ds_read_b32 v21, v4 offset:128
    ds_read_b128 v[24:27], v2
    ds_read2_b32 v[8:9], v6 offset0:0 offset1:1
    ds_read2_b32 v[10:11], v6 offset0:2 offset1:3
    ds_read2_b32 v[12:13], v7 offset0:0 offset1:1
    ds_read2_b32 v[14:15], v7 offset0:2 offset1:3
    ds_read_b32 v19, v68 offset:32
    ds_read_b32 v22, v4 offset:256
    ds_read_b32 v23, v4 offset:384
    ds_read_b128 v[28:31], v3
    s_add_u32 s79, s3, 0
    s_lshl_b64 exec, 1, s79
    v_mov_b32 v5, s72
    ds_write_b32 v1, v5
    s_mov_b64 exec, -1
    s_add_u32 s72, s72, 1
    s_setprio 2
    s_cmp_lg_u32 s7, 0
    s_cbranch_scc0 L_att_c
    s_setprio 1
L_att_c:
    s_xor_b32 s76, s3, 4
    s_mul_i32 s76, s76, 2432
    s_add_u32 s76, s76, s28
    s_add_u32 s76, s76, 36864
    v_add_u32 v6, s76, v0
    v_lshrrev_b32 v7, 2, v0
    s_add_u32 s76, s76, 2048
    v_add_u32 v7, s76, v7
    s_waitcnt lgkmcnt(10)
    v_mfma_f32_32x32x4_2b_bf16 v[36:67], v[20:21], v[16:17], 0
    s_waitcnt lgkmcnt(5)
    s_nop 15
    s_nop 0
    v_mfma_f32_32x32x16_bf16 v[36:51], v[24:27], v[8:11], v[36:51]
    v_mfma_f32_32x32x16_bf16 v[52:67], v[24:27], v[12:15], v[52:67]
    ds_read_b128 v[24:27], v2 offset:1024
    s_waitcnt lgkmcnt(1)
    s_nop 8
.p2align 6
L_aloop:
    v_exp_f32 v36, v36
    v_exp_f32 v37, v37
    v_mfma_f32_32x32x16_bf16 v[116:131], v[32:35], v[92:95], v[116:131]
    ds_read_b128 v[32:35], v3 offset:608
    v_exp_f32 v38, v38
    v_exp_f32 v39, v39
    v_exp_f32 v40, v40
    v_mfma_f32_32x32x4_2b_bf16 v[68:99], v[20:21], v[18:19], 0
    v_exp_f32 v41, v41
    v_exp_f32 v42, v42
    v_exp_f32 v43, v43
    v_cvt_pk_bf16_f32 v36, v36, v37
    v_cvt_pk_bf16_f32 v37, v38, v39
    v_cvt_pk_bf16_f32 v38, v40, v41
    v_cvt_pk_bf16_f32 v39, v42, v43
    v_exp_f32 v44, v44
    v_exp_f32 v45, v45
    v_exp_f32 v46, v46
    s_waitcnt lgkmcnt(1)
    v_mfma_f32_32x32x16_bf16 v[100:115], v[28:31], v[36:39], v[100:115]
    v_exp_f32 v47, v47
    v_exp_f32 v48, v48
    v_exp_f32 v49, v49
    v_exp_f32 v50, v50
    v_exp_f32 v51, v51
    v_cvt_pk_bf16_f32 v44, v44, v45
    v_cvt_pk_bf16_f32 v45, v46, v47
    v_mfma_f32_32x32x16_bf16 v[68:83], v[24:27], v[8:11], v[68:83]
    v_cvt_pk_bf16_f32 v46, v48, v49
    v_cvt_pk_bf16_f32 v47, v50, v51
    v_exp_f32 v52, v52
    v_exp_f32 v53, v53
    v_exp_f32 v54, v54
    v_exp_f32 v55, v55
    s_waitcnt lgkmcnt(0)
    v_mfma_f32_32x32x16_bf16 v[100:115], v[32:35], v[44:47], v[100:115]
    v_exp_f32 v56, v56
    v_exp_f32 v57, v57
    v_exp_f32 v58, v58
    v_exp_f32 v59, v59
    v_cvt_pk_bf16_f32 v52, v52, v53
    v_cvt_pk_bf16_f32 v53, v54, v55
    v_mfma_f32_32x32x16_bf16 v[84:99], v[24:27], v[12:15], v[84:99]
    ds_read_b128 v[24:27], v2 offset:2048
    v_cvt_pk_bf16_f32 v54, v56, v57
    v_cvt_pk_bf16_f32 v55, v58, v59
    v_exp_f32 v60, v60
    v_exp_f32 v61, v61
    v_exp_f32 v62, v62
    v_exp_f32 v63, v63
    v_mfma_f32_32x32x16_bf16 v[116:131], v[28:31], v[52:55], v[116:131]
    ds_read_b128 v[28:31], v3 offset:1216
    v_exp_f32 v64, v64
    v_exp_f32 v65, v65
    v_exp_f32 v66, v66
    v_exp_f32 v67, v67
    v_cvt_pk_bf16_f32 v60, v60, v61
    v_cvt_pk_bf16_f32 v61, v62, v63
    v_cvt_pk_bf16_f32 v62, v64, v65
    v_cvt_pk_bf16_f32 v63, v66, v67
    v_exp_f32 v68, v68
    v_exp_f32 v69, v69
    v_mfma_f32_32x32x16_bf16 v[116:131], v[32:35], v[60:63], v[116:131]
    ds_read_b128 v[32:35], v3 offset:1824
    v_exp_f32 v70, v70
    v_exp_f32 v71, v71
    v_exp_f32 v72, v72
    v_mfma_f32_32x32x4_2b_bf16 v[36:67], v[22:23], v[16:17], 0
    v_exp_f32 v73, v73
    v_exp_f32 v74, v74
    v_exp_f32 v75, v75
    v_cvt_pk_bf16_f32 v68, v68, v69
    v_cvt_pk_bf16_f32 v69, v70, v71
    v_cvt_pk_bf16_f32 v70, v72, v73
    v_cvt_pk_bf16_f32 v71, v74, v75
    v_exp_f32 v76, v76
    v_exp_f32 v77, v77
    v_exp_f32 v78, v78
    s_waitcnt lgkmcnt(1)
    v_mfma_f32_32x32x16_bf16 v[100:115], v[28:31], v[68:71], v[100:115]
    v_exp_f32 v79, v79
    v_exp_f32 v80, v80
    v_exp_f32 v81, v81
    v_exp_f32 v82, v82
    v_exp_f32 v83, v83
    v_cvt_pk_bf16_f32 v76, v76, v77
    v_cvt_pk_bf16_f32 v77, v78, v79
    v_mfma_f32_32x32x16_bf16 v[36:51], v[24:27], v[8:11], v[36:51]
    v_cvt_pk_bf16_f32 v78, v80, v81
    v_cvt_pk_bf16_f32 v79, v82, v83
    v_exp_f32 v84, v84
    v_exp_f32 v85, v85
    v_exp_f32 v86, v86
    v_exp_f32 v87, v87
    s_waitcnt lgkmcnt(0)
    v_mfma_f32_32x32x16_bf16 v[100:115], v[32:35], v[76:79], v[100:115]
    v_exp_f32 v88, v88
    v_exp_f32 v89, v89
    v_exp_f32 v90, v90
    v_exp_f32 v91, v91
    v_cvt_pk_bf16_f32 v84, v84, v85
    v_cvt_pk_bf16_f32 v85, v86, v87
    v_mfma_f32_32x32x16_bf16 v[52:67], v[24:27], v[12:15], v[52:67]
    ds_read_b128 v[24:27], v2 offset:3072
    v_cvt_pk_bf16_f32 v86, v88, v89
    v_cvt_pk_bf16_f32 v87, v90, v91
    v_exp_f32 v92, v92
    v_exp_f32 v93, v93
    v_exp_f32 v94, v94
    v_exp_f32 v95, v95
    v_mfma_f32_32x32x16_bf16 v[116:131], v[28:31], v[84:87], v[116:131]
    ds_read_b128 v[28:31], v3 offset:2432
    v_exp_f32 v96, v96
    v_exp_f32 v97, v97
    v_exp_f32 v98, v98
    v_exp_f32 v99, v99
    v_cvt_pk_bf16_f32 v92, v92, v93
    v_cvt_pk_bf16_f32 v93, v94, v95
    v_cvt_pk_bf16_f32 v94, v96, v97
    v_cvt_pk_bf16_f32 v95, v98, v99
    v_exp_f32 v36, v36
    v_exp_f32 v37, v37
    v_mfma_f32_32x32x16_bf16 v[116:131], v[32:35], v[92:95], v[116:131]
    ds_read_b128 v[32:35], v3 offset:3040
    ds_read_b32 v5, v1
    v_exp_f32 v38, v38
    v_exp_f32 v39, v39
    v_exp_f32 v40, v40
    v_mfma_f32_32x32x4_2b_bf16 v[68:99], v[22:23], v[18:19], 0
    v_exp_f32 v41, v41
    v_exp_f32 v42, v42
    v_exp_f32 v43, v43
    v_cvt_pk_bf16_f32 v36, v36, v37
    v_cvt_pk_bf16_f32 v37, v38, v39
    v_cvt_pk_bf16_f32 v38, v40, v41
    v_cvt_pk_bf16_f32 v39, v42, v43
    v_exp_f32 v44, v44
    v_exp_f32 v45, v45
    v_exp_f32 v46, v46
    s_waitcnt lgkmcnt(2)
    v_mfma_f32_32x32x16_bf16 v[100:115], v[28:31], v[36:39], v[100:115]
    v_exp_f32 v47, v47
    v_exp_f32 v48, v48
    v_exp_f32 v49, v49
    v_exp_f32 v50, v50
    v_exp_f32 v51, v51
    v_cvt_pk_bf16_f32 v44, v44, v45
    v_cvt_pk_bf16_f32 v45, v46, v47
    v_mfma_f32_32x32x16_bf16 v[68:83], v[24:27], v[8:11], v[68:83]
    v_cvt_pk_bf16_f32 v46, v48, v49
    v_cvt_pk_bf16_f32 v47, v50, v51
    v_exp_f32 v52, v52
    v_exp_f32 v53, v53
    v_exp_f32 v54, v54
    v_exp_f32 v55, v55
    s_waitcnt lgkmcnt(1)
    v_mfma_f32_32x32x16_bf16 v[100:115], v[32:35], v[44:47], v[100:115]
    v_exp_f32 v56, v56
    v_exp_f32 v57, v57
    v_exp_f32 v58, v58
    v_exp_f32 v59, v59
    v_cvt_pk_bf16_f32 v52, v52, v53
    v_cvt_pk_bf16_f32 v53, v54, v55
    s_waitcnt lgkmcnt(0)
    v_cmp_gt_u32 vcc, s72, v5
    s_bitcmp1_b32 vcc_lo, 11
    s_cbranch_scc1 L_slow5
L_back6:
    s_bitcmp1_b32 vcc_lo, s73
    s_cbranch_scc0 L_pr7
    s_setprio 0
L_pr7:
    v_mfma_f32_32x32x16_bf16 v[84:99], v[24:27], v[12:15], v[84:99]
    ds_read_b128 v[24:27], v2 offset:18944
    ds_read_b32 v20, v4 offset:18944
    ds_read_b32 v21, v4 offset:19072
    v_cvt_pk_bf16_f32 v54, v56, v57
    v_cvt_pk_bf16_f32 v55, v58, v59
    v_exp_f32 v60, v60
    v_exp_f32 v61, v61
    v_exp_f32 v62, v62
    v_exp_f32 v63, v63
    v_mfma_f32_32x32x16_bf16 v[116:131], v[28:31], v[52:55], v[116:131]
    ds_read_b128 v[28:31], v3 offset:3648
    v_exp_f32 v64, v64
    v_exp_f32 v65, v65
    v_exp_f32 v66, v66
    v_exp_f32 v67, v67
    v_cvt_pk_bf16_f32 v60, v60, v61
    v_cvt_pk_bf16_f32 v61, v62, v63
    v_cvt_pk_bf16_f32 v62, v64, v65
    v_cvt_pk_bf16_f32 v63, v66, v67
    v_exp_f32 v68, v68
    v_exp_f32 v69, v69
    v_mfma_f32_32x32x16_bf16 v[116:131], v[32:35], v[60:63], v[116:131]
    ds_read_b128 v[32:35], v3 offset:4256
    ds_read_b32 v22, v4 offset:19200
    ds_read_b32 v23, v4 offset:19328
    v_exp_f32 v70, v70
    v_exp_f32 v71, v71
    v_exp_f32 v72, v72
    s_waitcnt lgkmcnt(5)
    v_mfma_f32_32x32x4_2b_bf16 v[36:67], v[20:21], v[16:17], 0
    v_exp_f32 v73, v73
    v_exp_f32 v74, v74
    v_exp_f32 v75, v75
    v_cvt_pk_bf16_f32 v68, v68, v69
    v_cvt_pk_bf16_f32 v69, v70, v71
    v_cvt_pk_bf16_f32 v70, v72, v73
    v_cvt_pk_bf16_f32 v71, v74, v75
    v_exp_f32 v76, v76
    v_exp_f32 v77, v77
    v_exp_f32 v78, v78
    s_waitcnt lgkmcnt(3)
    v_mfma_f32_32x32x16_bf16 v[100:115], v[28:31], v[68:71], v[100:115]
    v_exp_f32 v79, v79
    v_exp_f32 v80, v80
    v_exp_f32 v81, v81
    v_exp_f32 v82, v82
    v_exp_f32 v83, v83
    v_cvt_pk_bf16_f32 v76, v76, v77
    v_cvt_pk_bf16_f32 v77, v78, v79
    v_mfma_f32_32x32x16_bf16 v[36:51], v[24:27], v[8:11], v[36:51]
    v_cvt_pk_bf16_f32 v78, v80, v81
    v_cvt_pk_bf16_f32 v79, v82, v83
    v_exp_f32 v84, v84
    v_exp_f32 v85, v85
    v_exp_f32 v86, v86
    v_exp_f32 v87, v87
    s_waitcnt lgkmcnt(2)
    v_mfma_f32_32x32x16_bf16 v[100:115], v[32:35], v[76:79], v[100:115]
    v_mov_b32 v5, s72
    s_lshl_b64 exec, 1, s3
    ds_write_b32 v1, v5
    s_mov_b64 exec, -1
    s_add_u32 s72, s72, 1
    v_exp_f32 v88, v88
    v_exp_f32 v89, v89
    v_exp_f32 v90, v90
    v_exp_f32 v91, v91
    v_cvt_pk_bf16_f32 v84, v84, v85
    v_cvt_pk_bf16_f32 v85, v86, v87
    s_bitcmp1_b32 vcc_lo, s73
    s_cbranch_scc0 L_pr8
    s_setprio 2
L_pr8:
    v_mfma_f32_32x32x16_bf16 v[52:67], v[24:27], v[12:15], v[52:67]
    ds_read_b128 v[24:27], v2 offset:19968
    v_cvt_pk_bf16_f32 v86, v88, v89
    v_cvt_pk_bf16_f32 v87, v90, v91
    v_exp_f32 v92, v92
    v_exp_f32 v93, v93
    v_exp_f32 v94, v94
    v_exp_f32 v95, v95
    v_mfma_f32_32x32x16_bf16 v[116:131], v[28:31], v[84:87], v[116:131]
    ds_read_b128 v[28:31], v3 offset:18944
    v_exp_f32 v96, v96
    v_exp_f32 v97, v97
    v_exp_f32 v98, v98
    v_exp_f32 v99, v99
    v_cvt_pk_bf16_f32 v92, v92, v93
    v_cvt_pk_bf16_f32 v93, v94, v95
    v_cvt_pk_bf16_f32 v94, v96, v97
    v_cvt_pk_bf16_f32 v95, v98, v99
    v_exp_f32 v36, v36
    v_exp_f32 v37, v37
    v_mfma_f32_32x32x16_bf16 v[116:131], v[32:35], v[92:95], v[116:131]
    ds_read_b128 v[32:35], v3 offset:19552
    v_exp_f32 v38, v38
    v_exp_f32 v39, v39
    v_exp_f32 v40, v40
    v_mfma_f32_32x32x4_2b_bf16 v[68:99], v[20:21], v[18:19], 0
    v_exp_f32 v41, v41
    v_exp_f32 v42, v42
    v_exp_f32 v43, v43
    v_cvt_pk_bf16_f32 v36, v36, v37
    v_cvt_pk_bf16_f32 v37, v38, v39
    v_cvt_pk_bf16_f32 v38, v40, v41
    v_cvt_pk_bf16_f32 v39, v42, v43
    v_exp_f32 v44, v44
    v_exp_f32 v45, v45
    v_exp_f32 v46, v46
    s_waitcnt lgkmcnt(1)
    v_mfma_f32_32x32x16_bf16 v[100:115], v[28:31], v[36:39], v[100:115]
    v_exp_f32 v47, v47
    v_exp_f32 v48, v48
    v_exp_f32 v49, v49
    v_exp_f32 v50, v50
    v_exp_f32 v51, v51
    v_cvt_pk_bf16_f32 v44, v44, v45
    v_cvt_pk_bf16_f32 v45, v46, v47
    v_mfma_f32_32x32x16_bf16 v[68:83], v[24:27], v[8:11], v[68:83]
    v_cvt_pk_bf16_f32 v46, v48, v49
    v_cvt_pk_bf16_f32 v47, v50, v51
    v_exp_f32 v52, v52
    v_exp_f32 v53, v53
    v_exp_f32 v54, v54
    v_exp_f32 v55, v55
    s_waitcnt lgkmcnt(0)
    v_mfma_f32_32x32x16_bf16 v[100:115], v[32:35], v[44:47], v[100:115]
    v_exp_f32 v56, v56
    v_exp_f32 v57, v57
    v_exp_f32 v58, v58
    v_exp_f32 v59, v59
    v_cvt_pk_bf16_f32 v52, v52, v53
    v_cvt_pk_bf16_f32 v53, v54, v55
    v_mfma_f32_32x32x16_bf16 v[84:99], v[24:27], v[12:15], v[84:99]
    ds_read_b128 v[24:27], v2 offset:20992
    v_cvt_pk_bf16_f32 v54, v56, v57
    v_cvt_pk_bf16_f32 v55, v58, v59
    v_exp_f32 v60, v60
    v_exp_f32 v61, v61
    v_exp_f32 v62, v62
    v_exp_f32 v63, v63
    v_mfma_f32_32x32x16_bf16 v[116:131], v[28:31], v[52:55], v[116:131]
    ds_read_b128 v[28:31], v3 offset:20160
    v_exp_f32 v64, v64
    v_exp_f32 v65, v65
    v_exp_f32 v66, v66
    v_exp_f32 v67, v67
    v_cvt_pk_bf16_f32 v60, v60, v61
    v_cvt_pk_bf16_f32 v61, v62, v63
    v_cvt_pk_bf16_f32 v62, v64, v65
    v_cvt_pk_bf16_f32 v63, v66, v67
    v_exp_f32 v68, v68
    v_exp_f32 v69, v69
    v_mfma_f32_32x32x16_bf16 v[116:131], v[32:35], v[60:63], v[116:131]
    ds_read_b128 v[32:35], v3 offset:20768
    v_exp_f32 v70, v70
    v_exp_f32 v71, v71
    v_exp_f32 v72, v72
    v_mfma_f32_32x32x4_2b_bf16 v[36:67], v[22:23], v[16:17], 0
    v_exp_f32 v73, v73
    v_exp_f32 v74, v74
    v_exp_f32 v75, v75
    v_cvt_pk_bf16_f32 v68, v68, v69
    v_cvt_pk_bf16_f32 v69, v70, v71
    v_cvt_pk_bf16_f32 v70, v72, v73
    v_cvt_pk_bf16_f32 v71, v74, v75
    v_exp_f32 v76, v76
    v_exp_f32 v77, v77
    v_exp_f32 v78, v78
    s_waitcnt lgkmcnt(1)
    v_mfma_f32_32x32x16_bf16 v[100:115], v[28:31], v[68:71], v[100:115]
    v_exp_f32 v79, v79
    v_exp_f32 v80, v80
    v_exp_f32 v81, v81
    v_exp_f32 v82, v82
    v_exp_f32 v83, v83
    v_cvt_pk_bf16_f32 v76, v76, v77
    v_cvt_pk_bf16_f32 v77, v78, v79
    v_mfma_f32_32x32x16_bf16 v[36:51], v[24:27], v[8:11], v[36:51]
    v_cvt_pk_bf16_f32 v78, v80, v81
    v_cvt_pk_bf16_f32 v79, v82, v83
    v_exp_f32 v84, v84
    v_exp_f32 v85, v85
    v_exp_f32 v86, v86
    v_exp_f32 v87, v87
    s_waitcnt lgkmcnt(0)
    v_mfma_f32_32x32x16_bf16 v[100:115], v[32:35], v[76:79], v[100:115]
    v_exp_f32 v88, v88
    v_exp_f32 v89, v89
    v_exp_f32 v90, v90
    v_exp_f32 v91, v91
    v_cvt_pk_bf16_f32 v84, v84, v85
    v_cvt_pk_bf16_f32 v85, v86, v87
    v_mfma_f32_32x32x16_bf16 v[52:67], v[24:27], v[12:15], v[52:67]
    ds_read_b128 v[24:27], v2 offset:22016
    v_cvt_pk_bf16_f32 v86, v88, v89
    v_cvt_pk_bf16_f32 v87, v90, v91
    v_exp_f32 v92, v92
    v_exp_f32 v93, v93
    v_exp_f32 v94, v94
    v_exp_f32 v95, v95
    v_mfma_f32_32x32x16_bf16 v[116:131], v[28:31], v[84:87], v[116:131]
    ds_read_b128 v[28:31], v3 offset:21376
    v_exp_f32 v96, v96
    v_exp_f32 v97, v97
    v_exp_f32 v98, v98
    v_exp_f32 v99, v99
    v_cvt_pk_bf16_f32 v92, v92, v93
    v_cvt_pk_bf16_f32 v93, v94, v95
    v_cvt_pk_bf16_f32 v94, v96, v97
    v_cvt_pk_bf16_f32 v95, v98, v99
    v_exp_f32 v36, v36
    v_exp_f32 v37, v37
    v_mfma_f32_32x32x16_bf16 v[116:131], v[32:35], v[92:95], v[116:131]
    ds_read_b128 v[32:35], v3 offset:21984
    ds_read_b32 v5, v1
    v_exp_f32 v38, v38
    v_exp_f32 v39, v39
    v_exp_f32 v40, v40
    v_mfma_f32_32x32x4_2b_bf16 v[68:99], v[22:23], v[18:19], 0
    v_exp_f32 v41, v41
    v_exp_f32 v42, v42
    v_exp_f32 v43, v43
    v_cvt_pk_bf16_f32 v36, v36, v37
    v_cvt_pk_bf16_f32 v37, v38, v39
    v_cvt_pk_bf16_f32 v38, v40, v41
    v_cvt_pk_bf16_f32 v39, v42, v43
    v_exp_f32 v44, v44
    v_exp_f32 v45, v45
    v_exp_f32 v46, v46
    s_waitcnt lgkmcnt(2)
    v_mfma_f32_32x32x16_bf16 v[100:115], v[28:31], v[36:39], v[100:115]
    v_exp_f32 v47, v47
    v_exp_f32 v48, v48
    v_exp_f32 v49, v49
    v_exp_f32 v50, v50
    v_exp_f32 v51, v51
    v_cvt_pk_bf16_f32 v44, v44, v45
    v_cvt_pk_bf16_f32 v45, v46, v47
    v_mfma_f32_32x32x16_bf16 v[68:83], v[24:27], v[8:11], v[68:83]
    v_cvt_pk_bf16_f32 v46, v48, v49
    v_cvt_pk_bf16_f32 v47, v50, v51
    v_exp_f32 v52, v52
    v_exp_f32 v53, v53
    v_exp_f32 v54, v54
    v_exp_f32 v55, v55
    s_waitcnt lgkmcnt(1)
    v_mfma_f32_32x32x16_bf16 v[100:115], v[32:35], v[44:47], v[100:115]
    v_exp_f32 v56, v56
    v_exp_f32 v57, v57
    v_exp_f32 v58, v58
    v_exp_f32 v59, v59
    v_cvt_pk_bf16_f32 v52, v52, v53
    v_cvt_pk_bf16_f32 v53, v54, v55
    s_waitcnt lgkmcnt(0)
    v_cmp_gt_u32 vcc, s72, v5
    s_bitcmp1_b32 vcc_lo, 11
    s_cbranch_scc1 L_slow9
L_back10:
    s_bitcmp1_b32 vcc_lo, s73
    s_cbranch_scc0 L_pr11
    s_setprio 0
L_pr11:
    v_mfma_f32_32x32x16_bf16 v[84:99], v[24:27], v[12:15], v[84:99]
    ds_read_b128 v[24:27], v2 offset:37888
    ds_read_b32 v20, v4 offset:37888
    ds_read_b32 v21, v4 offset:38016
    v_cvt_pk_bf16_f32 v54, v56, v57
    v_cvt_pk_bf16_f32 v55, v58, v59
    v_exp_f32 v60, v60
    v_exp_f32 v61, v61
    v_exp_f32 v62, v62
    v_exp_f32 v63, v63
    v_mfma_f32_32x32x16_bf16 v[116:131], v[28:31], v[52:55], v[116:131]
    ds_read_b128 v[28:31], v3 offset:22592
    v_exp_f32 v64, v64
    v_exp_f32 v65, v65
    v_exp_f32 v66, v66
    v_exp_f32 v67, v67
    v_cvt_pk_bf16_f32 v60, v60, v61
    v_cvt_pk_bf16_f32 v61, v62, v63
    v_cvt_pk_bf16_f32 v62, v64, v65
    v_cvt_pk_bf16_f32 v63, v66, v67
    v_exp_f32 v68, v68
    v_exp_f32 v69, v69
    v_mfma_f32_32x32x16_bf16 v[116:131], v[32:35], v[60:63], v[116:131]
    ds_read_b128 v[32:35], v3 offset:23200
    ds_read_b32 v22, v4 offset:38144
    ds_read_b32 v23, v4 offset:38272
    v_exp_f32 v70, v70
    v_exp_f32 v71, v71
    v_exp_f32 v72, v72
    s_waitcnt lgkmcnt(5)
    v_mfma_f32_32x32x4_2b_bf16 v[36:67], v[20:21], v[16:17], 0
    v_exp_f32 v73, v73
    v_exp_f32 v74, v74
    v_exp_f32 v75, v75
    v_cvt_pk_bf16_f32 v68, v68, v69
    v_cvt_pk_bf16_f32 v69, v70, v71
    v_cvt_pk_bf16_f32 v70, v72, v73
    v_cvt_pk_bf16_f32 v71, v74, v75
    v_exp_f32 v76, v76
    v_exp_f32 v77, v77
    v_exp_f32 v78, v78
    s_waitcnt lgkmcnt(3)
    v_mfma_f32_32x32x16_bf16 v[100:115], v[28:31], v[68:71], v[100:115]
    v_exp_f32 v79, v79
    v_exp_f32 v80, v80
    v_exp_f32 v81, v81
    v_exp_f32 v82, v82
    v_exp_f32 v83, v83
    v_cvt_pk_bf16_f32 v76, v76, v77
    v_cvt_pk_bf16_f32 v77, v78, v79
    v_mfma_f32_32x32x16_bf16 v[36:51], v[24:27], v[8:11], v[36:51]
    v_cvt_pk_bf16_f32 v78, v80, v81
    v_cvt_pk_bf16_f32 v79, v82, v83
    v_exp_f32 v84, v84
    v_exp_f32 v85, v85
    v_exp_f32 v86, v86
    v_exp_f32 v87, v87
    s_waitcnt lgkmcnt(2)
    v_mfma_f32_32x32x16_bf16 v[100:115], v[32:35], v[76:79], v[100:115]
    v_mov_b32 v5, s72
    s_lshl_b64 exec, 1, s3
    ds_write_b32 v1, v5
    s_mov_b64 exec, -1
    s_add_u32 s72, s72, 1
    v_exp_f32 v88, v88
    v_exp_f32 v89, v89
    v_exp_f32 v90, v90
    v_exp_f32 v91, v91
    v_cvt_pk_bf16_f32 v84, v84, v85
    v_cvt_pk_bf16_f32 v85, v86, v87
    s_bitcmp1_b32 vcc_lo, s73
    s_cbranch_scc0 L_pr12
    s_setprio 2
L_pr12:
    v_mfma_f32_32x32x16_bf16 v[52:67], v[24:27], v[12:15], v[52:67]
    ds_read_b128 v[24:27], v2 offset:38912
    v_cvt_pk_bf16_f32 v86, v88, v89
    v_cvt_pk_bf16_f32 v87, v90, v91
    v_exp_f32 v92, v92
    v_exp_f32 v93, v93
    v_exp_f32 v94, v94
    v_exp_f32 v95, v95
    v_mfma_f32_32x32x16_bf16 v[116:131], v[28:31], v[84:87], v[116:131]
    ds_read_b128 v[28:31], v3 offset:37888
    v_exp_f32 v96, v96
    v_exp_f32 v97, v97
    v_exp_f32 v98, v98
    v_exp_f32 v99, v99
    v_cvt_pk_bf16_f32 v92, v92, v93
    v_cvt_pk_bf16_f32 v93, v94, v95
    v_cvt_pk_bf16_f32 v94, v96, v97
    v_cvt_pk_bf16_f32 v95, v98, v99
    v_exp_f32 v36, v36
    v_exp_f32 v37, v37
    v_mfma_f32_32x32x16_bf16 v[116:131], v[32:35], v[92:95], v[116:131]
    ds_read_b128 v[32:35], v3 offset:38496
    v_exp_f32 v38, v38
    v_exp_f32 v39, v39
    v_exp_f32 v40, v40
    v_mfma_f32_32x32x4_2b_bf16 v[68:99], v[20:21], v[18:19], 0
    v_exp_f32 v41, v41
    v_exp_f32 v42, v42
    v_exp_f32 v43, v43
    v_cvt_pk_bf16_f32 v36, v36, v37
    v_cvt_pk_bf16_f32 v37, v38, v39
    v_cvt_pk_bf16_f32 v38, v40, v41
    v_cvt_pk_bf16_f32 v39, v42, v43
    v_exp_f32 v44, v44
    v_exp_f32 v45, v45
    v_exp_f32 v46, v46
    s_waitcnt lgkmcnt(1)
    v_mfma_f32_32x32x16_bf16 v[100:115], v[28:31], v[36:39], v[100:115]
    v_exp_f32 v47, v47
    v_exp_f32 v48, v48
    v_exp_f32 v49, v49
    v_exp_f32 v50, v50
    v_exp_f32 v51, v51
    v_cvt_pk_bf16_f32 v44, v44, v45
    v_cvt_pk_bf16_f32 v45, v46, v47
    v_mfma_f32_32x32x16_bf16 v[68:83], v[24:27], v[8:11], v[68:83]
    v_cvt_pk_bf16_f32 v46, v48, v49
    v_cvt_pk_bf16_f32 v47, v50, v51
    v_exp_f32 v52, v52
    v_exp_f32 v53, v53
    v_exp_f32 v54, v54
    v_exp_f32 v55, v55
    s_waitcnt lgkmcnt(0)
    v_mfma_f32_32x32x16_bf16 v[100:115], v[32:35], v[44:47], v[100:115]
    v_exp_f32 v56, v56
    v_exp_f32 v57, v57
    v_exp_f32 v58, v58
    v_exp_f32 v59, v59
    v_cvt_pk_bf16_f32 v52, v52, v53
    v_cvt_pk_bf16_f32 v53, v54, v55
    v_mfma_f32_32x32x16_bf16 v[84:99], v[24:27], v[12:15], v[84:99]
    ds_read_b128 v[24:27], v2 offset:39936
    v_cvt_pk_bf16_f32 v54, v56, v57
    v_cvt_pk_bf16_f32 v55, v58, v59
    v_exp_f32 v60, v60
    v_exp_f32 v61, v61
    v_exp_f32 v62, v62
    v_exp_f32 v63, v63
    v_mfma_f32_32x32x16_bf16 v[116:131], v[28:31], v[52:55], v[116:131]
    ds_read_b128 v[28:31], v3 offset:39104
    v_exp_f32 v64, v64
    v_exp_f32 v65, v65
    v_exp_f32 v66, v66
    v_exp_f32 v67, v67
    v_cvt_pk_bf16_f32 v60, v60, v61
    v_cvt_pk_bf16_f32 v61, v62, v63
    v_cvt_pk_bf16_f32 v62, v64, v65
    v_cvt_pk_bf16_f32 v63, v66, v67
    v_exp_f32 v68, v68
    v_exp_f32 v69, v69
    v_mfma_f32_32x32x16_bf16 v[116:131], v[32:35], v[60:63], v[116:131]
    ds_read_b128 v[32:35], v3 offset:39712
    v_exp_f32 v70, v70
    v_exp_f32 v71, v71
    v_exp_f32 v72, v72
    v_mfma_f32_32x32x4_2b_bf16 v[36:67], v[22:23], v[16:17], 0
    v_exp_f32 v73, v73
    v_exp_f32 v74, v74
    v_exp_f32 v75, v75
    v_cvt_pk_bf16_f32 v68, v68, v69
    v_cvt_pk_bf16_f32 v69, v70, v71
    v_cvt_pk_bf16_f32 v70, v72, v73
    v_cvt_pk_bf16_f32 v71, v74, v75
    v_exp_f32 v76, v76
    v_exp_f32 v77, v77
    v_exp_f32 v78, v78
    s_waitcnt lgkmcnt(1)
    v_mfma_f32_32x32x16_bf16 v[100:115], v[28:31], v[68:71], v[100:115]
    v_exp_f32 v79, v79
    v_exp_f32 v80, v80
    v_exp_f32 v81, v81
    v_exp_f32 v82, v82
    v_exp_f32 v83, v83
    v_cvt_pk_bf16_f32 v76, v76, v77
    v_cvt_pk_bf16_f32 v77, v78, v79
    v_mfma_f32_32x32x16_bf16 v[36:51], v[24:27], v[8:11], v[36:51]
    v_cvt_pk_bf16_f32 v78, v80, v81
    v_cvt_pk_bf16_f32 v79, v82, v83
    v_exp_f32 v84, v84
    v_exp_f32 v85, v85
    v_exp_f32 v86, v86
    v_exp_f32 v87, v87
    s_waitcnt lgkmcnt(0)
    v_mfma_f32_32x32x16_bf16 v[100:115], v[32:35], v[76:79], v[100:115]
    v_exp_f32 v88, v88
    v_exp_f32 v89, v89
    v_exp_f32 v90, v90
    v_exp_f32 v91, v91
    v_cvt_pk_bf16_f32 v84, v84, v85
    v_cvt_pk_bf16_f32 v85, v86, v87
    v_mfma_f32_32x32x16_bf16 v[52:67], v[24:27], v[12:15], v[52:67]
    ds_read_b128 v[24:27], v2 offset:40960
    v_cvt_pk_bf16_f32 v86, v88, v89
    v_cvt_pk_bf16_f32 v87, v90, v91
    v_exp_f32 v92, v92
    v_exp_f32 v93, v93
    v_exp_f32 v94, v94
    v_exp_f32 v95, v95
    v_mfma_f32_32x32x16_bf16 v[116:131], v[28:31], v[84:87], v[116:131]
    ds_read_b128 v[28:31], v3 offset:40320
    v_exp_f32 v96, v96
    v_exp_f32 v97, v97
    v_exp_f32 v98, v98
    v_exp_f32 v99, v99
    v_cvt_pk_bf16_f32 v92, v92, v93
    v_cvt_pk_bf16_f32 v93, v94, v95
    v_cvt_pk_bf16_f32 v94, v96, v97
    v_cvt_pk_bf16_f32 v95, v98, v99
    v_exp_f32 v36, v36
    v_exp_f32 v37, v37
    v_mfma_f32_32x32x16_bf16 v[116:131], v[32:35], v[92:95], v[116:131]
    ds_read_b128 v[32:35], v3 offset:40928
    ds_read_b32 v5, v1
    v_exp_f32 v38, v38
    v_exp_f32 v39, v39
    v_exp_f32 v40, v40
    v_mfma_f32_32x32x4_2b_bf16 v[68:99], v[22:23], v[18:19], 0
    v_exp_f32 v41, v41
    v_exp_f32 v42, v42
    v_exp_f32 v43, v43
    v_cvt_pk_bf16_f32 v36, v36, v37
    v_cvt_pk_bf16_f32 v37, v38, v39
    v_cvt_pk_bf16_f32 v38, v40, v41
    v_cvt_pk_bf16_f32 v39, v42, v43
    v_exp_f32 v44, v44
    v_exp_f32 v45, v45
    v_exp_f32 v46, v46
    s_waitcnt lgkmcnt(2)
    v_mfma_f32_32x32x16_bf16 v[100:115], v[28:31], v[36:39], v[100:115]
    v_exp_f32 v47, v47
    v_exp_f32 v48, v48
    v_exp_f32 v49, v49
    v_exp_f32 v50, v50
    v_exp_f32 v51, v51
    v_cvt_pk_bf16_f32 v44, v44, v45
    v_cvt_pk_bf16_f32 v45, v46, v47
    v_mfma_f32_32x32x16_bf16 v[68:83], v[24:27], v[8:11], v[68:83]
    v_cvt_pk_bf16_f32 v46, v48, v49
    v_cvt_pk_bf16_f32 v47, v50, v51
    v_exp_f32 v52, v52
    v_exp_f32 v53, v53
    v_exp_f32 v54, v54
    v_exp_f32 v55, v55
    s_waitcnt lgkmcnt(1)
    v_mfma_f32_32x32x16_bf16 v[100:115], v[32:35], v[44:47], v[100:115]
    v_exp_f32 v56, v56
    v_exp_f32 v57, v57
    v_exp_f32 v58, v58
    v_exp_f32 v59, v59
    v_cvt_pk_bf16_f32 v52, v52, v53
    v_cvt_pk_bf16_f32 v53, v54, v55
    s_waitcnt lgkmcnt(0)
    v_cmp_gt_u32 vcc, s72, v5
    s_bitcmp1_b32 vcc_lo, 11
    s_cbranch_scc1 L_slow13
L_back14:
    s_bitcmp1_b32 vcc_lo, s73
    s_cbranch_scc0 L_pr15
    s_setprio 0
L_pr15:
    v_mfma_f32_32x32x16_bf16 v[84:99], v[24:27], v[12:15], v[84:99]
    ds_read_b128 v[24:27], v2 offset:56832
    ds_read_b32 v20, v4 offset:56832
    ds_read_b32 v21, v4 offset:56960
    v_cvt_pk_bf16_f32 v54, v56, v57
    v_cvt_pk_bf16_f32 v55, v58, v59
    v_exp_f32 v60, v60
    v_exp_f32 v61, v61
    v_exp_f32 v62, v62
    v_exp_f32 v63, v63
    v_mfma_f32_32x32x16_bf16 v[116:131], v[28:31], v[52:55], v[116:131]
    ds_read_b128 v[28:31], v3 offset:41536
    v_exp_f32 v64, v64
    v_exp_f32 v65, v65
    v_exp_f32 v66, v66
    v_exp_f32 v67, v67
    v_cvt_pk_bf16_f32 v60, v60, v61
    v_cvt_pk_bf16_f32 v61, v62, v63
    v_cvt_pk_bf16_f32 v62, v64, v65
    v_cvt_pk_bf16_f32 v63, v66, v67
    v_exp_f32 v68, v68
    v_exp_f32 v69, v69
    v_mfma_f32_32x32x16_bf16 v[116:131], v[32:35], v[60:63], v[116:131]
    ds_read_b128 v[32:35], v3 offset:42144
    ds_read_b32 v22, v4 offset:57088
    ds_read_b32 v23, v4 offset:57216
    v_exp_f32 v70, v70
    v_exp_f32 v71, v71
    v_exp_f32 v72, v72
    s_waitcnt lgkmcnt(5)
    v_mfma_f32_32x32x4_2b_bf16 v[36:67], v[20:21], v[16:17], 0
    v_exp_f32 v73, v73
    v_exp_f32 v74, v74
    v_exp_f32 v75, v75
    v_cvt_pk_bf16_f32 v68, v68, v69
    v_cvt_pk_bf16_f32 v69, v70, v71
    v_cvt_pk_bf16_f32 v70, v72, v73
    v_cvt_pk_bf16_f32 v71, v74, v75
    v_exp_f32 v76, v76
    v_exp_f32 v77, v77
    v_exp_f32 v78, v78
    s_waitcnt lgkmcnt(3)
    v_mfma_f32_32x32x16_bf16 v[100:115], v[28:31], v[68:71], v[100:115]
    v_exp_f32 v79, v79
    v_exp_f32 v80, v80
    v_exp_f32 v81, v81
    v_exp_f32 v82, v82
    v_exp_f32 v83, v83
    v_cvt_pk_bf16_f32 v76, v76, v77
    v_cvt_pk_bf16_f32 v77, v78, v79
    v_mfma_f32_32x32x16_bf16 v[36:51], v[24:27], v[8:11], v[36:51]
    v_cvt_pk_bf16_f32 v78, v80, v81
    v_cvt_pk_bf16_f32 v79, v82, v83
    v_exp_f32 v84, v84
    v_exp_f32 v85, v85
    v_exp_f32 v86, v86
    v_exp_f32 v87, v87
    s_waitcnt lgkmcnt(2)
    v_mfma_f32_32x32x16_bf16 v[100:115], v[32:35], v[76:79], v[100:115]
    v_mov_b32 v5, s72
    s_lshl_b64 exec, 1, s3
    ds_write_b32 v1, v5
    s_mov_b64 exec, -1
    s_add_u32 s72, s72, 1
    v_exp_f32 v88, v88
    v_exp_f32 v89, v89
    v_exp_f32 v90, v90
    v_exp_f32 v91, v91
    v_cvt_pk_bf16_f32 v84, v84, v85
    v_cvt_pk_bf16_f32 v85, v86, v87
    s_bitcmp1_b32 vcc_lo, s73
    s_cbranch_scc0 L_pr16
    s_setprio 2
L_pr16:
    v_mfma_f32_32x32x16_bf16 v[52:67], v[24:27], v[12:15], v[52:67]
    ds_read_b128 v[24:27], v2 offset:57856
    v_cvt_pk_bf16_f32 v86, v88, v89
    v_cvt_pk_bf16_f32 v87, v90, v91
    v_exp_f32 v92, v92
    v_exp_f32 v93, v93
    v_exp_f32 v94, v94
    v_exp_f32 v95, v95
    v_mfma_f32_32x32x16_bf16 v[116:131], v[28:31], v[84:87], v[116:131]
    ds_read_b128 v[28:31], v3 offset:56832
    v_exp_f32 v96, v96
    v_exp_f32 v97, v97
    v_exp_f32 v98, v98
    v_exp_f32 v99, v99
    v_cvt_pk_bf16_f32 v92, v92, v93
    v_cvt_pk_bf16_f32 v93, v94, v95
    v_cvt_pk_bf16_f32 v94, v96, v97
    v_cvt_pk_bf16_f32 v95, v98, v99
    v_exp_f32 v36, v36
    v_exp_f32 v37, v37
    v_mfma_f32_32x32x16_bf16 v[116:131], v[32:35], v[92:95], v[116:131]
    ds_read_b128 v[32:35], v3 offset:57440
    v_exp_f32 v38, v38
    v_exp_f32 v39, v39
    v_exp_f32 v40, v40
    v_mfma_f32_32x32x4_2b_bf16 v[68:99], v[20:21], v[18:19], 0
    v_exp_f32 v41, v41
    v_exp_f32 v42, v42
    v_exp_f32 v43, v43
    v_cvt_pk_bf16_f32 v36, v36, v37
    v_cvt_pk_bf16_f32 v37, v38, v39
    v_cvt_pk_bf16_f32 v38, v40, v41
    v_cvt_pk_bf16_f32 v39, v42, v43
    v_exp_f32 v44, v44
    v_exp_f32 v45, v45
    v_exp_f32 v46, v46
    s_waitcnt lgkmcnt(1)
    v_mfma_f32_32x32x16_bf16 v[100:115], v[28:31], v[36:39], v[100:115]
    v_exp_f32 v47, v47
    v_exp_f32 v48, v48
    v_exp_f32 v49, v49
    v_exp_f32 v50, v50
    v_exp_f32 v51, v51
    v_cvt_pk_bf16_f32 v44, v44, v45
    v_cvt_pk_bf16_f32 v45, v46, v47
    v_mfma_f32_32x32x16_bf16 v[68:83], v[24:27], v[8:11], v[68:83]
    v_cvt_pk_bf16_f32 v46, v48, v49
    v_cvt_pk_bf16_f32 v47, v50, v51
    v_exp_f32 v52, v52
    v_exp_f32 v53, v53
    v_exp_f32 v54, v54
    v_exp_f32 v55, v55
    s_waitcnt lgkmcnt(0)
    v_mfma_f32_32x32x16_bf16 v[100:115], v[32:35], v[44:47], v[100:115]
    v_exp_f32 v56, v56
    v_exp_f32 v57, v57
    v_exp_f32 v58, v58
    v_exp_f32 v59, v59
    v_cvt_pk_bf16_f32 v52, v52, v53
    v_cvt_pk_bf16_f32 v53, v54, v55
    v_mfma_f32_32x32x16_bf16 v[84:99], v[24:27], v[12:15], v[84:99]
    ds_read_b128 v[24:27], v2 offset:58880
    v_cvt_pk_bf16_f32 v54, v56, v57
    v_cvt_pk_bf16_f32 v55, v58, v59
    v_exp_f32 v60, v60
    v_exp_f32 v61, v61
    v_exp_f32 v62, v62
    v_exp_f32 v63, v63
    v_mfma_f32_32x32x16_bf16 v[116:131], v[28:31], v[52:55], v[116:131]
    ds_read_b128 v[28:31], v3 offset:58048
    v_exp_f32 v64, v64
    v_exp_f32 v65, v65
    v_exp_f32 v66, v66
    v_exp_f32 v67, v67
    v_cvt_pk_bf16_f32 v60, v60, v61
    v_cvt_pk_bf16_f32 v61, v62, v63
    v_cvt_pk_bf16_f32 v62, v64, v65
    v_cvt_pk_bf16_f32 v63, v66, v67
    v_exp_f32 v68, v68
    v_exp_f32 v69, v69
    v_mfma_f32_32x32x16_bf16 v[116:131], v[32:35], v[60:63], v[116:131]
    ds_read_b128 v[32:35], v3 offset:58656
    v_exp_f32 v70, v70
    v_exp_f32 v71, v71
    v_exp_f32 v72, v72
    v_mfma_f32_32x32x4_2b_bf16 v[36:67], v[22:23], v[16:17], 0
    v_exp_f32 v73, v73
    v_exp_f32 v74, v74
    v_exp_f32 v75, v75
    v_cvt_pk_bf16_f32 v68, v68, v69
    v_cvt_pk_bf16_f32 v69, v70, v71
    v_cvt_pk_bf16_f32 v70, v72, v73
    v_cvt_pk_bf16_f32 v71, v74, v75
    v_exp_f32 v76, v76
    v_exp_f32 v77, v77
    v_exp_f32 v78, v78
    s_waitcnt lgkmcnt(1)
    v_mfma_f32_32x32x16_bf16 v[100:115], v[28:31], v[68:71], v[100:115]
    v_exp_f32 v79, v79
    v_exp_f32 v80, v80
    v_exp_f32 v81, v81
    v_exp_f32 v82, v82
    v_exp_f32 v83, v83
    v_cvt_pk_bf16_f32 v76, v76, v77
    v_cvt_pk_bf16_f32 v77, v78, v79
    v_mfma_f32_32x32x16_bf16 v[36:51], v[24:27], v[8:11], v[36:51]
    v_cvt_pk_bf16_f32 v78, v80, v81
    v_cvt_pk_bf16_f32 v79, v82, v83
    v_exp_f32 v84, v84
    v_exp_f32 v85, v85
    v_exp_f32 v86, v86
    v_exp_f32 v87, v87
    s_waitcnt lgkmcnt(0)
    v_mfma_f32_32x32x16_bf16 v[100:115], v[32:35], v[76:79], v[100:115]
    v_exp_f32 v88, v88
    v_exp_f32 v89, v89
    v_exp_f32 v90, v90
    v_exp_f32 v91, v91
    v_cvt_pk_bf16_f32 v84, v84, v85
    v_cvt_pk_bf16_f32 v85, v86, v87
    v_mfma_f32_32x32x16_bf16 v[52:67], v[24:27], v[12:15], v[52:67]
    ds_read_b128 v[24:27], v2 offset:59904
    v_cvt_pk_bf16_f32 v86, v88, v89
    v_cvt_pk_bf16_f32 v87, v90, v91
    v_exp_f32 v92, v92
    v_exp_f32 v93, v93
    v_exp_f32 v94, v94
    v_exp_f32 v95, v95
    v_mfma_f32_32x32x16_bf16 v[116:131], v[28:31], v[84:87], v[116:131]
    ds_read_b128 v[28:31], v3 offset:59264
    v_exp_f32 v96, v96
    v_exp_f32 v97, v97
    v_exp_f32 v98, v98
    v_exp_f32 v99, v99
    v_cvt_pk_bf16_f32 v92, v92, v93
    v_cvt_pk_bf16_f32 v93, v94, v95
    v_cvt_pk_bf16_f32 v94, v96, v97
    v_cvt_pk_bf16_f32 v95, v98, v99
    v_exp_f32 v36, v36
    v_exp_f32 v37, v37
    v_mfma_f32_32x32x16_bf16 v[116:131], v[32:35], v[92:95], v[116:131]
    ds_read_b128 v[32:35], v3 offset:59872
    ds_read_b32 v5, v1
    v_exp_f32 v38, v38
    v_exp_f32 v39, v39
    v_exp_f32 v40, v40
    v_mfma_f32_32x32x4_2b_bf16 v[68:99], v[22:23], v[18:19], 0
    v_exp_f32 v41, v41
    v_exp_f32 v42, v42
    v_exp_f32 v43, v43
    v_cvt_pk_bf16_f32 v36, v36, v37
    v_cvt_pk_bf16_f32 v37, v38, v39
    v_cvt_pk_bf16_f32 v38, v40, v41
    v_cvt_pk_bf16_f32 v39, v42, v43
    v_exp_f32 v44, v44
    v_exp_f32 v45, v45
    v_exp_f32 v46, v46
    s_waitcnt lgkmcnt(2)
    v_mfma_f32_32x32x16_bf16 v[100:115], v[28:31], v[36:39], v[100:115]
    v_exp_f32 v47, v47
    v_exp_f32 v48, v48
    v_exp_f32 v49, v49
    v_exp_f32 v50, v50
    v_exp_f32 v51, v51
    v_cvt_pk_bf16_f32 v44, v44, v45
    v_cvt_pk_bf16_f32 v45, v46, v47
    v_mfma_f32_32x32x16_bf16 v[68:83], v[24:27], v[8:11], v[68:83]
    v_cvt_pk_bf16_f32 v46, v48, v49
    v_cvt_pk_bf16_f32 v47, v50, v51
    v_exp_f32 v52, v52
    v_exp_f32 v53, v53
    v_exp_f32 v54, v54
    v_exp_f32 v55, v55
    s_waitcnt lgkmcnt(1)
    v_mfma_f32_32x32x16_bf16 v[100:115], v[32:35], v[44:47], v[100:115]
    v_exp_f32 v56, v56
    v_exp_f32 v57, v57
    v_exp_f32 v58, v58
    v_exp_f32 v59, v59
    v_cvt_pk_bf16_f32 v52, v52, v53
    v_cvt_pk_bf16_f32 v53, v54, v55
    s_waitcnt lgkmcnt(0)
    v_cmp_gt_u32 vcc, s72, v5
    s_bitcmp1_b32 vcc_lo, 11
    s_cbranch_scc1 L_slow17
L_back18:
    s_bitcmp1_b32 vcc_lo, s73
    s_cbranch_scc0 L_pr19
    s_setprio 0
L_pr19:
    v_mfma_f32_32x32x16_bf16 v[84:99], v[24:27], v[12:15], v[84:99]
    ds_read_b128 v[24:27], v2 offset:0
    ds_read_b32 v20, v4 offset:0
    ds_read_b32 v21, v4 offset:128
    v_cvt_pk_bf16_f32 v54, v56, v57
    v_cvt_pk_bf16_f32 v55, v58, v59
    v_exp_f32 v60, v60
    v_exp_f32 v61, v61
    v_exp_f32 v62, v62
    v_exp_f32 v63, v63
    v_mfma_f32_32x32x16_bf16 v[116:131], v[28:31], v[52:55], v[116:131]
    ds_read_b128 v[28:31], v3 offset:60480
    v_exp_f32 v64, v64
    v_exp_f32 v65, v65
    v_exp_f32 v66, v66
    v_exp_f32 v67, v67
    v_cvt_pk_bf16_f32 v60, v60, v61
    v_cvt_pk_bf16_f32 v61, v62, v63
    v_cvt_pk_bf16_f32 v62, v64, v65
    v_cvt_pk_bf16_f32 v63, v66, v67
    v_exp_f32 v68, v68
    v_exp_f32 v69, v69
    v_mfma_f32_32x32x16_bf16 v[116:131], v[32:35], v[60:63], v[116:131]
    ds_read_b128 v[32:35], v3 offset:61088
    ds_read_b32 v22, v4 offset:256
    ds_read_b32 v23, v4 offset:384
    v_exp_f32 v70, v70
    v_exp_f32 v71, v71
    v_exp_f32 v72, v72
    s_waitcnt lgkmcnt(5)
    v_mfma_f32_32x32x4_2b_bf16 v[36:67], v[20:21], v[16:17], 0
    v_exp_f32 v73, v73
    v_exp_f32 v74, v74
    v_exp_f32 v75, v75
    v_cvt_pk_bf16_f32 v68, v68, v69
    v_cvt_pk_bf16_f32 v69, v70, v71
    v_cvt_pk_bf16_f32 v70, v72, v73
    v_cvt_pk_bf16_f32 v71, v74, v75
    v_exp_f32 v76, v76
    v_exp_f32 v77, v77
    v_exp_f32 v78, v78
    s_waitcnt lgkmcnt(3)
    v_mfma_f32_32x32x16_bf16 v[100:115], v[28:31], v[68:71], v[100:115]
    v_exp_f32 v79, v79
    v_exp_f32 v80, v80
    v_exp_f32 v81, v81
    v_exp_f32 v82, v82
    v_exp_f32 v83, v83
    v_cvt_pk_bf16_f32 v76, v76, v77
    v_cvt_pk_bf16_f32 v77, v78, v79
    v_mfma_f32_32x32x16_bf16 v[36:51], v[24:27], v[8:11], v[36:51]
    v_cvt_pk_bf16_f32 v78, v80, v81
    v_cvt_pk_bf16_f32 v79, v82, v83
    v_exp_f32 v84, v84
    v_exp_f32 v85, v85
    v_exp_f32 v86, v86
    v_exp_f32 v87, v87
    s_waitcnt lgkmcnt(2)
    v_mfma_f32_32x32x16_bf16 v[100:115], v[32:35], v[76:79], v[100:115]
    v_mov_b32 v5, s72
    s_lshl_b64 exec, 1, s3
    ds_write_b32 v1, v5
    s_mov_b64 exec, -1
    s_add_u32 s72, s72, 1
    v_exp_f32 v88, v88
    v_exp_f32 v89, v89
    v_exp_f32 v90, v90
    v_exp_f32 v91, v91
    v_cvt_pk_bf16_f32 v84, v84, v85
    v_cvt_pk_bf16_f32 v85, v86, v87
    s_bitcmp1_b32 vcc_lo, s73
    s_cbranch_scc0 L_pr20
    s_setprio 2
L_pr20:
    v_mfma_f32_32x32x16_bf16 v[52:67], v[24:27], v[12:15], v[52:67]
    ds_read_b128 v[24:27], v2 offset:1024
    v_cvt_pk_bf16_f32 v86, v88, v89
    v_cvt_pk_bf16_f32 v87, v90, v91
    v_exp_f32 v92, v92
    v_exp_f32 v93, v93
    v_exp_f32 v94, v94
    v_exp_f32 v95, v95
    v_mfma_f32_32x32x16_bf16 v[116:131], v[28:31], v[84:87], v[116:131]
    ds_read_b128 v[28:31], v3 offset:0
    v_exp_f32 v96, v96
    v_exp_f32 v97, v97
    v_exp_f32 v98, v98
    v_exp_f32 v99, v99
    v_cvt_pk_bf16_f32 v92, v92, v93
    v_cvt_pk_bf16_f32 v93, v94, v95
    v_cvt_pk_bf16_f32 v94, v96, v97
    v_cvt_pk_bf16_f32 v95, v98, v99
    s_bitcmp1_b32 s72, 2
    s_cbranch_scc1 L_aloop
    v_mfma_f32_32x32x16_bf16 v[116:131], v[32:35], v[92:95], v[116:131]
    s_setprio 3
L_pr0:
    ds_read_b32 v5, v1
    ds_read_b128 v[68:71], v6
    ds_read_b128 v[72:75], v6 offset:1024
    ds_read2st64_b32 v[76:77], v7 offset0:0 offset1:1
    ds_read_b32 v78, v7 offset:128
    s_sub_u32 s73, s72, 2
    s_xor_b32 s76, s3, 4
    s_lshl_b32 s77, 1, s76
    s_movk_i32 s76, 9728
    s_cmp_eq_u32 s7, 0
    s_cselect_b32 s76, 4294957568, s76
    v_add_u32 v80, s76, v6
    v_add_u32 v81, s76, v7
    s_mul_i32 s74, s35, 73728
    s_add_u32 s74, s74, s66
    s_mul_i32 s75, s5, 2304
    s_add_u32 s75, s75, s74
    s_lshl_b32 s76, s7, 7
    s_add_u32 s75, s75, s76
    v_bfe_u32 v2, v0, 6, 3
    v_bfe_u32 v3, v0, 4, 2
    v_lshrrev_b32 v4, 9, v0
    v_lshl_add_u32 v3, v3, 1, v4
    v_lshlrev_b32 v3, 8, v3
    v_lshl_add_u32 v3, v2, 4, v3
    v_lshrrev_b32 v4, 2, v0
    s_mov_b32 s9, 0x53800000
    s_waitcnt lgkmcnt(4)
    v_cmp_gt_u32 vcc, s73, v5
    s_and_b32 s79, vcc_lo, 0x20ff
    s_cbranch_scc1 L_prs
L_pr2:
    ds_write_b128 v80, v[116:119]
    ds_write_b128 v80, v[120:123] offset:1024
    s_mov_b32 exec_hi, 0
    ds_write2st64_b32 v81, v124, v125 offset0:0 offset1:1
    ds_write_b32 v81, v126 offset:128
    s_add_u32 s79, s3, 0
    s_lshl_b64 exec, 1, s79
    v_mov_b32 v82, s72
    ds_write_b32 v1, v82
    s_mov_b64 exec, -1
    v_readlane_b32 s10, v5, 12
    s_cmp_eq_u32 s35, 0
    s_cbranch_scc1 L_att_nosel
    v_readlane_b32 s73, v5, 46
    s_and_b32 s67, s73, 0x7ff
    s_xor_b32 s67, s67, 0x7ff
    s_lshl_b32 s18, s4, 6
    s_lshl_b32 s19, s6, 4
    s_add_u32 s18, s18, s19
    s_sub_u32 s18, s67, s18
    s_cmp_lt_u32 s18, 16
    s_cbranch_scc1 L_prx
L_att_nosel:
    v_cmp_gt_u32 vcc, s72, v5
    s_and_b32 s79, vcc_lo, s77
    s_cbranch_scc1 L_prp
L_pr1:
    s_add_u32 s72, s72, 1
    s_add_u32 s79, s3, 0
    s_lshl_b64 exec, 1, s79
    v_mov_b32 v82, s72
    ds_write_b32 v1, v82
    s_mov_b64 exec, -1
    s_waitcnt lgkmcnt(6)
    v_add_f32 v110, v110, v78
    v_pk_add_f32 v[100:101], v[100:101], v[68:69]
    v_pk_add_f32 v[102:103], v[102:103], v[70:71]
    v_mov_b32 v6, v110
    v_pk_add_f32 v[104:105], v[104:105], v[72:73]
    v_pk_add_f32 v[106:107], v[106:107], v[74:75]
    v_permlane32_swap_b32 v110, v6
    v_pk_add_f32 v[108:109], v[108:109], v[76:77]
    v_rcp_f32 v6, v110
    s_nop 0
    v_pk_mul_f32 v[100:101], v[100:101], v[6:7] op_sel_hi:[1,0]
    v_pk_mul_f32 v[102:103], v[102:103], v[6:7] op_sel_hi:[1,0]
    v_pk_mul_f32 v[104:105], v[104:105], v[6:7] op_sel_hi:[1,0]
    v_pk_mul_f32 v[106:107], v[106:107], v[6:7] op_sel_hi:[1,0]
    v_pk_mul_f32 v[108:109], v[108:109], v[6:7] op_sel_hi:[1,0]
    v_cvt_pk_bf16_f32 v36, v100, v101
    v_cvt_pk_bf16_f32 v37, v102, v103
    v_cvt_pk_bf16_f32 v38, v104, v105
    v_cvt_pk_bf16_f32 v39, v106, v107
    v_cvt_pk_bf16_f32 v40, v108, v109
    v_dot2c_f32_bf16 v110, 0, v36
    v_dot2c_f32_bf16 v110, 0, v37
    v_dot2c_f32_bf16 v110, 0, v38
    v_dot2c_f32_bf16 v110, 0, v39
    s_mov_b32 exec_hi, 0
    v_dot2c_f32_bf16 v110, 0, v40
    s_mov_b32 exec_hi, -1
    s_nop 1
    v_cmp_nge_f32 s[18:19], s9, v110
    v_cmp_nle_f32 vcc, 0x2b800000, v110
    s_or_b64 vcc, vcc, s[18:19]
    s_cbranch_scc1 L_fallback
L_att_st:
    s_cmp_eq_u32 s10, 0
    s_cbranch_scc1 L_sl21
    buffer_store_dwordx4 v[36:39], v3, s[36:39], s75 offen
    s_mov_b32 exec_hi, 0
    buffer_store_dword v40, v4, s[36:39], s75 offen offset:2048
    s_mov_b64 exec, -1
L_sb22:
    s_mov_b32 s69, -2
    s_cmp_lg_u32 s7, 0
    s_cbranch_scc1 L_B_post
    s_setprio 1
    s_lshl_b32 s18, s4, 6
    s_lshl_b32 s19, s6, 4
    s_add_u32 s18, s18, s19
    s_sub_u32 s18, s67, s18
    s_sub_u32 s8, 12784640, s74
    v_bfe_u32 v2, v0, 4, 4
    v_cmp_eq_u32 vcc, s18, v2
    v_and_b32 v5, 0x300, v0
    v_add_u32 v5, s8, v5
    v_cndmask_b32 v6, v0, v5, vcc
    v_cndmask_b32 v142, v142, 1.0, vcc
    v_cndmask_b32 v143, v143, 0, vcc
    s_add_u32 s75, s74, 4096
    s_add_u32 s76, s74, 8192
    s_add_u32 s77, s74, 12288
    s_add_u32 s78, s74, 16384
    s_add_u32 s8, s28, 56320
    s_lshl_b32 s9, s6, 9
    s_add_u32 s9, s9, 160000
    v_add_u32 v128, s8, v0
    v_add_u32 v129, s9, v0
    s_add_u32 s8, s35, 1
    v_and_b32 v2, 0x300, v0
    v_lshlrev_b32 v2, 2, v2
    v_and_b32 v7, 0xc0, v0
    v_lshl_add_u32 v2, v7, 1, v2
    v_bfe_u32 v7, v0, 4, 2
    v_lshl_add_u32 v2, v7, 3, v2
    v_lshrrev_b32 v7, 2, v0
    v_and_b32 v7, 0x60, v7
    v_add_u32 v2, v2, v7
    v_add_u32 v2, s29, v2
    v_xor_b32 v3, 32, v2
    v_xor_b32 v4, 64, v2
    v_xor_b32 v5, 96, v2
L_w23:
    ds_read_b32 v7, v1
    s_waitcnt lgkmcnt(0)
    v_cmp_gt_u32 vcc, s8, v7
    s_and_b32 s79, vcc_lo, 0x400000
    s_cbranch_scc0 L_wd24
    s_sub_i32 s34, s34, 1
    s_cmp_gt_i32 s34, 0
    s_cbranch_scc1 L_w23
L_wd24:
    s_mov_b32 exec_lo, 0
    ds_read_b128 v[124:127], v129
    s_mov_b32 exec_lo, -1
    ds_read_b64_tr_b16 v[56:57], v2 offset:0
    ds_read_b64_tr_b16 v[58:59], v2 offset:512
    ds_read_b64_tr_b16 v[60:61], v3 offset:0
    ds_read_b64_tr_b16 v[62:63], v3 offset:512
    ds_read_b64_tr_b16 v[64:65], v4 offset:0
    ds_read_b64_tr_b16 v[66:67], v4 offset:512
    ds_read_b64_tr_b16 v[68:69], v5 offset:0
    ds_read_b64_tr_b16 v[70:71], v5 offset:512
    ds_read_b128 v[72:75], v128 offset:9216
    ds_read_b64_tr_b16 v[76:77], v2 offset:4096
    ds_read_b64_tr_b16 v[78:79], v2 offset:4608
    ds_read_b64_tr_b16 v[92:93], v3 offset:4096
    ds_read_b64_tr_b16 v[94:95], v3 offset:4608
    ds_read_b64_tr_b16 v[96:97], v4 offset:4096
    ds_read_b64_tr_b16 v[98:99], v4 offset:4608
    ds_read_b64_tr_b16 v[100:101], v5 offset:4096
    ds_read_b64_tr_b16 v[102:103], v5 offset:4608
    ds_read_b128 v[104:107], v128 offset:10240
    ds_read_b128 v[144:147], v128 offset:3072
    ds_read_b128 v[148:151], v128 offset:4096
    ds_read_b128 v[152:155], v128 offset:5120
    ds_read_b128 v[156:159], v128 offset:6144
    ds_read_b128 v[160:163], v128 offset:7168
    ds_read_b128 v[164:167], v128 offset:8192
    s_waitcnt vmcnt(2)
    v_lshlrev_b32 v108, 16, v132
    v_and_b32 v109, 0xffff0000, v132
    v_fma_f32 v108, v108, v142, -v143
    v_fma_f32 v109, v109, v142, -v143
    v_lshlrev_b32 v110, 16, v133
    v_and_b32 v111, 0xffff0000, v133
    v_fma_f32 v110, v110, v142, -v143
    v_fma_f32 v111, v111, v142, -v143
    v_lshlrev_b32 v112, 16, v134
    v_and_b32 v113, 0xffff0000, v134
    v_fma_f32 v112, v112, v142, -v143
    v_fma_f32 v113, v113, v142, -v143
    v_lshlrev_b32 v114, 16, v135
    v_and_b32 v115, 0xffff0000, v135
    v_fma_f32 v114, v114, v142, -v143
    v_fma_f32 v115, v115, v142, -v143
    v_lshlrev_b32 v116, 16, v136
    v_and_b32 v117, 0xffff0000, v136
    v_fma_f32 v116, v116, v142, -v143
    v_fma_f32 v117, v117, v142, -v143
    v_lshlrev_b32 v118, 16, v137
    v_and_b32 v119, 0xffff0000, v137
    v_fma_f32 v118, v118, v142, -v143
    v_fma_f32 v119, v119, v142, -v143
    v_lshlrev_b32 v120, 16, v138
    v_and_b32 v121, 0xffff0000, v138
    v_fma_f32 v120, v120, v142, -v143
    v_fma_f32 v121, v121, v142, -v143
    v_lshlrev_b32 v122, 16, v139
    v_and_b32 v123, 0xffff0000, v139
    v_fma_f32 v122, v122, v142, -v143
    v_fma_f32 v123, v123, v142, -v143
    s_mov_b32 exec_hi, 0
    v_lshlrev_b32 v124, 16, v140
    v_and_b32 v125, 0xffff0000, v140
    v_fma_f32 v124, v124, v142, -v143
    v_fma_f32 v125, v125, v142, -v143
    v_lshlrev_b32 v126, 16, v141
    v_and_b32 v127, 0xffff0000, v141
    v_fma_f32 v126, v126, v142, -v143
    v_fma_f32 v127, v127, v142, -v143
    s_mov_b32 exec_hi, -1
    ds_read_b128 v[132:135], v128 offset:0
    ds_read_b128 v[136:139], v128 offset:1024
    ds_read_b128 v[140:143], v128 offset:2048
    ds_read_b64_tr_b16 v[80:81], v2 offset:8192
    ds_read_b64_tr_b16 v[82:83], v2 offset:8704
    ds_read_b64_tr_b16 v[84:85], v3 offset:8192
    ds_read_b64_tr_b16 v[86:87], v3 offset:8704
    ds_read_b64_tr_b16 v[88:89], v4 offset:8192
    ds_read_b64_tr_b16 v[90:91], v4 offset:8704
    buffer_load_dwordx4 v[8:11], v6, s[36:39], s74 offen offset:0 sc1
    buffer_load_dwordx4 v[12:15], v6, s[36:39], s74 offen offset:1024 sc1
    buffer_load_dwordx4 v[16:19], v6, s[36:39], s74 offen offset:2048 sc1
    buffer_load_dwordx4 v[20:23], v6, s[36:39], s74 offen offset:3072 sc1
    buffer_load_dwordx4 v[24:27], v6, s[36:39], s75 offen offset:0 sc1
    buffer_load_dwordx4 v[28:31], v6, s[36:39], s75 offen offset:1024 sc1
    buffer_load_dwordx4 v[32:35], v6, s[36:39], s75 offen offset:2048 sc1
    buffer_load_dwordx4 v[36:39], v6, s[36:39], s75 offen offset:3072 sc1
    buffer_load_dwordx4 v[40:43], v6, s[36:39], s76 offen offset:0 sc1
    buffer_load_dwordx4 v[44:47], v6, s[36:39], s76 offen offset:1024 sc1
    buffer_load_dwordx4 v[48:51], v6, s[36:39], s76 offen offset:2048 sc1
    buffer_load_dwordx4 v[52:55], v6, s[36:39], s76 offen offset:3072 sc1
    s_mov_b32 s16, 0
    s_waitcnt vmcnt(9)
    v_max3_u32 v7, v8, v9, v10
    v_max3_u32 v7, v7, v11, v12
    v_max3_u32 v7, v7, v13, v14
    v_max3_u32 v7, v7, v15, v16
    v_max3_u32 v7, v7, v17, v18
    v_max_u32 v7, v7, v19
    v_cmp_lt_u32 vcc, s69, v7
    s_cbranch_vccnz L_cr26
L_cg25:
    s_waitcnt lgkmcnt(13)
    v_mfma_f32_16x16x32_bf16 v[108:111], v[56:59], v[8:11], v[108:111]
    v_mfma_f32_16x16x32_bf16 v[112:115], v[60:63], v[8:11], v[112:115]
    buffer_load_dwordx4 v[56:59], v6, s[36:39], s77 offen offset:0 sc1
    v_mfma_f32_16x16x32_bf16 v[116:119], v[64:67], v[8:11], v[116:119]
    v_mfma_f32_16x16x32_bf16 v[120:123], v[68:71], v[8:11], v[120:123]
    v_mfma_f32_16x16x32_bf16 v[124:127], v[72:75], v[8:11], v[124:127]
    ds_read_b64_tr_b16 v[8:9], v5 offset:8192
    ds_read_b64_tr_b16 v[10:11], v5 offset:8704
    buffer_load_dwordx4 v[60:63], v6, s[36:39], s77 offen offset:1024 sc1
    v_mfma_f32_16x16x32_bf16 v[108:111], v[76:79], v[12:15], v[108:111]
    s_waitcnt lgkmcnt(8)
    v_mfma_f32_16x16x32_bf16 v[112:115], v[92:95], v[12:15], v[112:115]
    ds_read_b128 v[92:95], v128 offset:11264
    v_mfma_f32_16x16x32_bf16 v[116:119], v[96:99], v[12:15], v[116:119]
    ds_read_b64_tr_b16 v[96:97], v2 offset:12288
    ds_read_b64_tr_b16 v[98:99], v2 offset:12800
    buffer_load_dwordx4 v[64:67], v6, s[36:39], s77 offen offset:2048 sc1
    v_mfma_f32_16x16x32_bf16 v[120:123], v[100:103], v[12:15], v[120:123]
    ds_read_b64_tr_b16 v[100:101], v3 offset:12288
    ds_read_b64_tr_b16 v[102:103], v3 offset:12800
    v_mfma_f32_16x16x32_bf16 v[124:127], v[104:107], v[12:15], v[124:127]
    ds_read_b64_tr_b16 v[104:105], v4 offset:12288
    ds_read_b64_tr_b16 v[106:107], v4 offset:12800
    s_waitcnt vmcnt(9)
    v_max_u32 v7, v20, v21
    s_waitcnt lgkmcnt(7)
    v_mfma_f32_16x16x32_bf16 v[108:111], v[80:83], v[16:19], v[108:111]
    ds_read_b64_tr_b16 v[12:13], v5 offset:12288
    ds_read_b64_tr_b16 v[14:15], v5 offset:12800
    v_max3_u32 v7, v7, v22, v23
    v_mfma_f32_16x16x32_bf16 v[112:115], v[84:87], v[16:19], v[112:115]
    ds_read_b128 v[80:83], v128 offset:12288
    v_max3_u32 v7, v7, v24, v25
    v_mfma_f32_16x16x32_bf16 v[116:119], v[88:91], v[16:19], v[116:119]
    ds_read_b64_tr_b16 v[84:85], v2 offset:16384
    ds_read_b64_tr_b16 v[86:87], v2 offset:16896
    v_max3_u32 v7, v7, v26, v27
    v_mfma_f32_16x16x32_bf16 v[120:123], v[8:11], v[16:19], v[120:123]
    ds_read_b64_tr_b16 v[88:89], v3 offset:16384
    ds_read_b64_tr_b16 v[90:91], v3 offset:16896
    v_max3_u32 v7, v7, v28, v29
    s_waitcnt lgkmcnt(13)
    v_mfma_f32_16x16x32_bf16 v[124:127], v[92:95], v[16:19], v[124:127]
    ds_read_b64_tr_b16 v[8:9], v4 offset:16384
    ds_read_b64_tr_b16 v[10:11], v4 offset:16896
    v_max3_u32 v7, v7, v30, v31
    v_cmp_lt_u32 vcc, s69, v7
    s_bitcmp1_b32 s16, 1
    s_cbranch_scc1 L_cr28b
    s_cbranch_vccnz L_cr28
L_cg27:
    s_waitcnt lgkmcnt(7)
    v_mfma_f32_16x16x32_bf16 v[108:111], v[96:99], v[20:23], v[108:111]
    ds_read_b64_tr_b16 v[92:93], v5 offset:16384
    ds_read_b64_tr_b16 v[94:95], v5 offset:16896
    v_mfma_f32_16x16x32_bf16 v[112:115], v[100:103], v[20:23], v[112:115]
    ds_read_b128 v[16:19], v128 offset:13312
    buffer_load_dwordx4 v[68:71], v6, s[36:39], s77 offen offset:3072 sc1
    v_mfma_f32_16x16x32_bf16 v[116:119], v[104:107], v[20:23], v[116:119]
    ds_read_b64_tr_b16 v[96:97], v2 offset:20480
    ds_read_b64_tr_b16 v[98:99], v2 offset:20992
    v_mfma_f32_16x16x32_bf16 v[120:123], v[12:15], v[20:23], v[120:123]
    ds_read_b64_tr_b16 v[100:101], v3 offset:20480
    ds_read_b64_tr_b16 v[102:103], v3 offset:20992
    s_waitcnt lgkmcnt(13)
    v_mfma_f32_16x16x32_bf16 v[124:127], v[80:83], v[20:23], v[124:127]
    ds_read_b64_tr_b16 v[104:105], v4 offset:20480
    ds_read_b64_tr_b16 v[106:107], v4 offset:20992
    buffer_load_dwordx4 v[72:75], v6, s[36:39], s78 offen offset:0 sc1
    s_waitcnt lgkmcnt(7)
    v_mfma_f32_16x16x32_bf16 v[108:111], v[84:87], v[24:27], v[108:111]
    ds_read_b64_tr_b16 v[12:13], v5 offset:20480
    ds_read_b64_tr_b16 v[14:15], v5 offset:20992
    v_mfma_f32_16x16x32_bf16 v[112:115], v[88:91], v[24:27], v[112:115]
    ds_read_b128 v[80:83], v128 offset:14336
    v_mfma_f32_16x16x32_bf16 v[116:119], v[8:11], v[24:27], v[116:119]
    ds_read_b64_tr_b16 v[20:21], v2 offset:24576
    ds_read_b64_tr_b16 v[22:23], v2 offset:25088
    buffer_load_dwordx4 v[76:79], v6, s[36:39], s78 offen offset:1024 sc1
    v_mfma_f32_16x16x32_bf16 v[120:123], v[92:95], v[24:27], v[120:123]
    ds_read_b64_tr_b16 v[84:85], v3 offset:24576
    ds_read_b64_tr_b16 v[86:87], v3 offset:25088
    s_waitcnt lgkmcnt(13)
    v_mfma_f32_16x16x32_bf16 v[124:127], v[16:19], v[24:27], v[124:127]
    ds_read_b64_tr_b16 v[88:89], v4 offset:24576
    ds_read_b64_tr_b16 v[90:91], v4 offset:25088
    s_waitcnt vmcnt(9)
    v_max_u32 v7, v32, v33
    s_waitcnt lgkmcnt(7)
    v_mfma_f32_16x16x32_bf16 v[108:111], v[96:99], v[28:31], v[108:111]
    ds_read_b64_tr_b16 v[8:9], v5 offset:24576
    ds_read_b64_tr_b16 v[10:11], v5 offset:25088
    v_max3_u32 v7, v7, v34, v35
    v_mfma_f32_16x16x32_bf16 v[112:115], v[100:103], v[28:31], v[112:115]
    ds_read_b128 v[92:95], v128 offset:15360
    v_max3_u32 v7, v7, v36, v37
    v_mfma_f32_16x16x32_bf16 v[116:119], v[104:107], v[28:31], v[116:119]
    ds_read_b64_tr_b16 v[16:17], v2 offset:28672
    ds_read_b64_tr_b16 v[18:19], v2 offset:29184
    v_max3_u32 v7, v7, v38, v39
    v_mfma_f32_16x16x32_bf16 v[120:123], v[12:15], v[28:31], v[120:123]
    ds_read_b64_tr_b16 v[24:25], v3 offset:28672
    ds_read_b64_tr_b16 v[26:27], v3 offset:29184
    v_max3_u32 v7, v7, v40, v41
    s_waitcnt lgkmcnt(13)
    v_mfma_f32_16x16x32_bf16 v[124:127], v[80:83], v[28:31], v[124:127]
    ds_read_b64_tr_b16 v[96:97], v4 offset:28672
    ds_read_b64_tr_b16 v[98:99], v4 offset:29184
    v_max3_u32 v7, v7, v42, v43
    v_cmp_lt_u32 vcc, s69, v7
    s_bitcmp1_b32 s16, 2
    s_cbranch_scc1 L_cr30b
    s_cbranch_vccnz L_cr30
L_cg29:
    s_waitcnt lgkmcnt(7)
    v_mfma_f32_16x16x32_bf16 v[108:111], v[20:23], v[32:35], v[108:111]
    ds_read_b64_tr_b16 v[100:101], v5 offset:28672
    ds_read_b64_tr_b16 v[102:103], v5 offset:29184
    v_mfma_f32_16x16x32_bf16 v[112:115], v[84:87], v[32:35], v[112:115]
    ds_read_b128 v[104:107], v128 offset:16384
    v_mfma_f32_16x16x32_bf16 v[116:119], v[88:91], v[32:35], v[116:119]
    ds_read_b64_tr_b16 v[12:13], v2 offset:32768
    ds_read_b64_tr_b16 v[14:15], v2 offset:33280
    v_mfma_f32_16x16x32_bf16 v[120:123], v[8:11], v[32:35], v[120:123]
    ds_read_b64_tr_b16 v[80:81], v3 offset:32768
    ds_read_b64_tr_b16 v[82:83], v3 offset:33280
    s_waitcnt lgkmcnt(13)
    v_mfma_f32_16x16x32_bf16 v[124:127], v[92:95], v[32:35], v[124:127]
    ds_read_b64_tr_b16 v[28:29], v4 offset:32768
    ds_read_b64_tr_b16 v[30:31], v4 offset:33280
    s_waitcnt lgkmcnt(7)
    v_mfma_f32_16x16x32_bf16 v[108:111], v[16:19], v[36:39], v[108:111]
    ds_read_b64_tr_b16 v[20:21], v5 offset:32768
    ds_read_b64_tr_b16 v[22:23], v5 offset:33280
    v_mfma_f32_16x16x32_bf16 v[112:115], v[24:27], v[36:39], v[112:115]
    ds_read_b128 v[84:87], v128 offset:17408
    s_add_u32 s79, s6, 24
    s_lshl_b64 exec, 1, s79
    v_mov_b32 v7, 11
    ds_write_b32 v1, v7
    s_mov_b64 exec, -1
    v_mfma_f32_16x16x32_bf16 v[116:119], v[96:99], v[36:39], v[116:119]
    ds_read_b64_tr_b16 v[88:89], v2 offset:36864
    ds_read_b64_tr_b16 v[90:91], v2 offset:37376
    v_mfma_f32_16x16x32_bf16 v[120:123], v[100:103], v[36:39], v[120:123]
    ds_read_b64_tr_b16 v[8:9], v3 offset:36864
    ds_read_b64_tr_b16 v[10:11], v3 offset:37376
    s_waitcnt lgkmcnt(13)
    v_mfma_f32_16x16x32_bf16 v[124:127], v[104:107], v[36:39], v[124:127]
    ds_read_b64_tr_b16 v[92:93], v4 offset:36864
    ds_read_b64_tr_b16 v[94:95], v4 offset:37376
    s_waitcnt vmcnt(6)
    v_max_u32 v7, v44, v45
    s_waitcnt lgkmcnt(7)
    v_mfma_f32_16x16x32_bf16 v[108:111], v[12:15], v[40:43], v[108:111]
    ds_read_b64_tr_b16 v[32:33], v5 offset:36864
    ds_read_b64_tr_b16 v[34:35], v5 offset:37376
    v_max3_u32 v7, v7, v46, v47
    v_mfma_f32_16x16x32_bf16 v[112:115], v[80:83], v[40:43], v[112:115]
    ds_read_b64_tr_b16 v[16:17], v2 offset:40960
    ds_read_b64_tr_b16 v[18:19], v2 offset:41472
    v_max3_u32 v7, v7, v48, v49
    v_mfma_f32_16x16x32_bf16 v[116:119], v[28:31], v[40:43], v[116:119]
    ds_read_b64_tr_b16 v[24:25], v3 offset:40960
    ds_read_b64_tr_b16 v[26:27], v3 offset:41472
    v_max3_u32 v7, v7, v50, v51
    v_mfma_f32_16x16x32_bf16 v[120:123], v[20:23], v[40:43], v[120:123]
    ds_read_b64_tr_b16 v[96:97], v4 offset:40960
    ds_read_b64_tr_b16 v[98:99], v4 offset:41472
    v_max3_u32 v7, v7, v52, v53
    s_waitcnt lgkmcnt(14)
    v_mfma_f32_16x16x32_bf16 v[124:127], v[84:87], v[40:43], v[124:127]
    ds_read_b64_tr_b16 v[100:101], v5 offset:40960
    ds_read_b64_tr_b16 v[102:103], v5 offset:41472
    v_max3_u32 v7, v7, v54, v55
    v_cmp_lt_u32 vcc, s69, v7
    s_bitcmp1_b32 s16, 3
    s_cbranch_scc1 L_cr32b
    s_cbranch_vccnz L_cr32
L_cg31:
    s_waitcnt lgkmcnt(8)
    v_mfma_f32_16x16x32_bf16 v[108:111], v[88:91], v[44:47], v[108:111]
    ds_read_b64_tr_b16 v[104:105], v2 offset:45056
    ds_read_b64_tr_b16 v[106:107], v2 offset:45568
    v_mfma_f32_16x16x32_bf16 v[112:115], v[8:11], v[44:47], v[112:115]
    ds_read_b64_tr_b16 v[36:37], v3 offset:45056
    ds_read_b64_tr_b16 v[38:39], v3 offset:45568
    v_mfma_f32_16x16x32_bf16 v[116:119], v[92:95], v[44:47], v[116:119]
    ds_read_b64_tr_b16 v[12:13], v4 offset:45056
    ds_read_b64_tr_b16 v[14:15], v4 offset:45568
    v_mfma_f32_16x16x32_bf16 v[120:123], v[32:35], v[44:47], v[120:123]
    ds_read_b64_tr_b16 v[80:81], v5 offset:45056
    ds_read_b64_tr_b16 v[82:83], v5 offset:45568
    v_mfma_f32_16x16x32_bf16 v[124:127], v[132:135], v[44:47], v[124:127]
    ds_read_b64_tr_b16 v[28:29], v2 offset:49152
    ds_read_b64_tr_b16 v[30:31], v2 offset:49664
    s_waitcnt lgkmcnt(10)
    v_mfma_f32_16x16x32_bf16 v[108:111], v[16:19], v[48:51], v[108:111]
    ds_read_b64_tr_b16 v[20:21], v3 offset:49152
    ds_read_b64_tr_b16 v[22:23], v3 offset:49664
    v_mfma_f32_16x16x32_bf16 v[112:115], v[24:27], v[48:51], v[112:115]
    ds_read_b64_tr_b16 v[84:85], v4 offset:49152
    ds_read_b64_tr_b16 v[86:87], v4 offset:49664
    v_mfma_f32_16x16x32_bf16 v[116:119], v[96:99], v[48:51], v[116:119]
    ds_read_b64_tr_b16 v[40:41], v5 offset:49152
    ds_read_b64_tr_b16 v[42:43], v5 offset:49664
    v_mfma_f32_16x16x32_bf16 v[120:123], v[100:103], v[48:51], v[120:123]
    ds_read_b64_tr_b16 v[88:89], v2 offset:53248
    ds_read_b64_tr_b16 v[90:91], v2 offset:53760
    v_mfma_f32_16x16x32_bf16 v[124:127], v[136:139], v[48:51], v[124:127]
    ds_read_b64_tr_b16 v[8:9], v3 offset:53248
    ds_read_b64_tr_b16 v[10:11], v3 offset:53760
    s_waitcnt vmcnt(3)
    v_max_u32 v7, v56, v57
    s_waitcnt lgkmcnt(12)
    v_mfma_f32_16x16x32_bf16 v[108:111], v[104:107], v[52:55], v[108:111]
    ds_read_b64_tr_b16 v[92:93], v4 offset:53248
    ds_read_b64_tr_b16 v[94:95], v4 offset:53760
    v_max3_u32 v7, v7, v58, v59
    v_mfma_f32_16x16x32_bf16 v[112:115], v[36:39], v[52:55], v[112:115]
    ds_read_b64_tr_b16 v[32:33], v5 offset:53248
    ds_read_b64_tr_b16 v[34:35], v5 offset:53760
    v_max3_u32 v7, v7, v60, v61
    v_mfma_f32_16x16x32_bf16 v[116:119], v[12:15], v[52:55], v[116:119]
    ds_read_b64_tr_b16 v[44:45], v2 offset:57344
    ds_read_b64_tr_b16 v[46:47], v2 offset:57856
    v_max3_u32 v7, v7, v62, v63
    v_mfma_f32_16x16x32_bf16 v[120:123], v[80:83], v[52:55], v[120:123]
    ds_read_b64_tr_b16 v[16:17], v3 offset:57344
    ds_read_b64_tr_b16 v[18:19], v3 offset:57856
    v_max3_u32 v7, v7, v64, v65
    v_mfma_f32_16x16x32_bf16 v[124:127], v[140:143], v[52:55], v[124:127]
    ds_read_b64_tr_b16 v[24:25], v4 offset:57344
    ds_read_b64_tr_b16 v[26:27], v4 offset:57856
    v_max3_u32 v7, v7, v66, v67
    v_cmp_lt_u32 vcc, s69, v7
    s_bitcmp1_b32 s16, 4
    s_cbranch_scc1 L_cr34b
    s_cbranch_vccnz L_cr34
L_cg33:
    s_waitcnt lgkmcnt(14)
    v_mfma_f32_16x16x32_bf16 v[108:111], v[28:31], v[56:59], v[108:111]
    ds_read_b64_tr_b16 v[96:97], v5 offset:57344
    ds_read_b64_tr_b16 v[98:99], v5 offset:57856
    v_mfma_f32_16x16x32_bf16 v[112:115], v[20:23], v[56:59], v[112:115]
    ds_read_b64_tr_b16 v[100:101], v2 offset:61440
    ds_read_b64_tr_b16 v[102:103], v2 offset:61952
    v_mfma_f32_16x16x32_bf16 v[116:119], v[84:87], v[56:59], v[116:119]
    ds_read_b64_tr_b16 v[48:49], v3 offset:61440
    ds_read_b64_tr_b16 v[50:51], v3 offset:61952
    v_mfma_f32_16x16x32_bf16 v[120:123], v[40:43], v[56:59], v[120:123]
    ds_read_b64_tr_b16 v[104:105], v4 offset:61440
    ds_read_b64_tr_b16 v[106:107], v4 offset:61952
    v_mfma_f32_16x16x32_bf16 v[124:127], v[144:147], v[56:59], v[124:127]
    ds_read_b64_tr_b16 v[36:37], v5 offset:61440
    ds_read_b64_tr_b16 v[38:39], v5 offset:61952
    s_waitcnt lgkmcnt(14)
    v_mfma_f32_16x16x32_bf16 v[108:111], v[88:91], v[60:63], v[108:111]
    v_add_u32 v2, 8192, v2
    v_add_u32 v3, 8192, v3
    v_add_u32 v4, 8192, v4
    v_add_u32 v5, 8192, v5
    ds_read_b64_tr_b16 v[12:13], v2 offset:57344
    ds_read_b64_tr_b16 v[14:15], v2 offset:57856
    v_mfma_f32_16x16x32_bf16 v[112:115], v[8:11], v[60:63], v[112:115]
    ds_read_b64_tr_b16 v[80:81], v3 offset:57344
    ds_read_b64_tr_b16 v[82:83], v3 offset:57856
    v_mfma_f32_16x16x32_bf16 v[116:119], v[92:95], v[60:63], v[116:119]
    ds_read_b64_tr_b16 v[52:53], v4 offset:57344
    ds_read_b64_tr_b16 v[54:55], v4 offset:57856
    v_mfma_f32_16x16x32_bf16 v[120:123], v[32:35], v[60:63], v[120:123]
    ds_read_b64_tr_b16 v[28:29], v5 offset:57344
    ds_read_b64_tr_b16 v[30:31], v5 offset:57856
    v_mfma_f32_16x16x32_bf16 v[124:127], v[148:151], v[60:63], v[124:127]
    ds_read_b64_tr_b16 v[20:21], v2 offset:61440
    ds_read_b64_tr_b16 v[22:23], v2 offset:61952
    s_waitcnt vmcnt(0)
    v_max_u32 v7, v68, v69
    v_mfma_f32_16x16x32_bf16 v[108:111], v[44:47], v[64:67], v[108:111]
    ds_read_b64_tr_b16 v[84:85], v3 offset:61440
    ds_read_b64_tr_b16 v[86:87], v3 offset:61952
    v_max3_u32 v7, v7, v70, v71
    s_waitcnt lgkmcnt(14)
    v_mfma_f32_16x16x32_bf16 v[112:115], v[16:19], v[64:67], v[112:115]
    ds_read_b64_tr_b16 v[40:41], v4 offset:61440
    ds_read_b64_tr_b16 v[42:43], v4 offset:61952
    v_max3_u32 v7, v7, v72, v73
    v_mfma_f32_16x16x32_bf16 v[116:119], v[24:27], v[64:67], v[116:119]
    ds_read_b64_tr_b16 v[56:57], v5 offset:61440
    ds_read_b64_tr_b16 v[58:59], v5 offset:61952
    v_max3_u32 v7, v7, v74, v75
    v_mfma_f32_16x16x32_bf16 v[120:123], v[96:99], v[64:67], v[120:123]
    v_max3_u32 v7, v7, v76, v77
    v_mfma_f32_16x16x32_bf16 v[124:127], v[152:155], v[64:67], v[124:127]
    v_max3_u32 v7, v7, v78, v79
    v_cmp_lt_u32 vcc, s69, v7
    s_bitcmp1_b32 s16, 5
    s_cbranch_scc1 L_cr36b
    s_cbranch_vccnz L_cr36
L_cg35:
    v_mfma_f32_16x16x32_bf16 v[108:111], v[100:103], v[68:71], v[108:111]
    v_mfma_f32_16x16x32_bf16 v[112:115], v[48:51], v[68:71], v[112:115]
    v_mfma_f32_16x16x32_bf16 v[116:119], v[104:107], v[68:71], v[116:119]
    s_waitcnt lgkmcnt(14)
    v_mfma_f32_16x16x32_bf16 v[120:123], v[36:39], v[68:71], v[120:123]
    v_mfma_f32_16x16x32_bf16 v[124:127], v[156:159], v[68:71], v[124:127]
    v_mfma_f32_16x16x32_bf16 v[108:111], v[12:15], v[72:75], v[108:111]
    s_waitcnt lgkmcnt(8)
    v_mfma_f32_16x16x32_bf16 v[112:115], v[80:83], v[72:75], v[112:115]
    v_mfma_f32_16x16x32_bf16 v[116:119], v[52:55], v[72:75], v[116:119]
    v_mfma_f32_16x16x32_bf16 v[120:123], v[28:31], v[72:75], v[120:123]
    v_mfma_f32_16x16x32_bf16 v[124:127], v[160:163], v[72:75], v[124:127]
    s_waitcnt lgkmcnt(6)
    v_mfma_f32_16x16x32_bf16 v[108:111], v[20:23], v[76:79], v[108:111]
    s_waitcnt lgkmcnt(4)
    v_mfma_f32_16x16x32_bf16 v[112:115], v[84:87], v[76:79], v[112:115]
    s_waitcnt lgkmcnt(2)
    v_mfma_f32_16x16x32_bf16 v[116:119], v[40:43], v[76:79], v[116:119]
    s_waitcnt lgkmcnt(0)
    v_mfma_f32_16x16x32_bf16 v[120:123], v[56:59], v[76:79], v[120:123]
    v_mfma_f32_16x16x32_bf16 v[124:127], v[164:167], v[76:79], v[124:127]
    s_setprio 3
    v_bfe_u32 v2, v0, 8, 1
    v_lshrrev_b32 v3, 9, v0
    v_lshl_add_u32 v3, v2, 1, v3
    v_lshlrev_b32 v4, 4, v3
    v_add_u32 v4, 159296, v4
    ds_read_b128 v[20:23], v4
    ds_read_b128 v[24:27], v4 offset:64
    v_lshlrev_b32 v4, 3, v2
    v_add_u32 v5, 159296, v4
    ds_read_b64 v[28:29], v5 offset:128
    v_and_b32 v5, 0xf0, v0
    v_lshl_add_u32 v3, v3, 8, v5
    v_add_u32 v4, v4, v5
    s_mul_i32 s75, s5, 2304
    s_add_u32 s75, s75, s74
    s_add_u32 s75, s75, 147456
    v_mov_b32 v30, 0
    v_mov_b32 v31, 0
    v_mov_b32 v32, 0
    v_mov_b32 v33, 0x3f803f80
    v_cvt_pk_bf16_f32 v8, v108, v109
    v_cvt_pk_bf16_f32 v9, v110, v111
    v_cvt_pk_bf16_f32 v10, v112, v113
    v_cvt_pk_bf16_f32 v11, v114, v115
    v_cvt_pk_bf16_f32 v12, v116, v117
    v_cvt_pk_bf16_f32 v13, v118, v119
    v_cvt_pk_bf16_f32 v14, v120, v121
    v_cvt_pk_bf16_f32 v15, v122, v123
    v_permlane16_swap_b32 v8, v10
    v_permlane16_swap_b32 v9, v11
    v_permlane16_swap_b32 v12, v14
    v_permlane16_swap_b32 v13, v15
    s_cmp_lg_u32 s35, 0
    s_cbranch_scc1 L_nox1
    s_cmp_eq_u32 s10, 0
    s_cbranch_scc1 L_sl37
    buffer_store_dwordx4 v[8:11], v3, s[36:39], s75 offen
    buffer_store_dwordx4 v[12:15], v3, s[36:39], s75 offen offset:1024
L_sb38:
L_nox1:
    v_mov_b32 v16, 0
    v_mov_b32 v17, 0
    s_mov_b32 exec_hi, 0
    v_cvt_pk_bf16_f32 v16, v124, v125
    v_cvt_pk_bf16_f32 v17, v126, v127
    s_cmp_lg_u32 s35, 0
    s_cbranch_scc1 L_nox2
    s_cmp_eq_u32 s10, 0
    s_cbranch_scc1 L_sl39
    buffer_store_dwordx2 v[16:17], v4, s[36:39], s75 offen offset:2048
L_sb40:
L_nox2:
    s_add_u32 s8, s35, 2
    s_add_u32 s79, s6, 42
    s_lshl_b64 exec, 1, s79
    v_mov_b32 v7, s8
    ds_write_b32 v1, v7
    s_mov_b64 exec, -1
    s_waitcnt lgkmcnt(1)
    v_dot2c_f32_bf16 v30, v8, v33
    v_dot2c_f32_bf16 v31, v8, v8
    v_dot2c_f32_bf16 v32, v8, v20
    v_dot2c_f32_bf16 v30, v9, v33
    v_dot2c_f32_bf16 v31, v9, v9
    v_dot2c_f32_bf16 v32, v9, v21
    v_dot2c_f32_bf16 v30, v10, v33
    v_dot2c_f32_bf16 v31, v10, v10
    v_dot2c_f32_bf16 v32, v10, v22
    v_dot2c_f32_bf16 v30, v11, v33
    v_dot2c_f32_bf16 v31, v11, v11
    v_dot2c_f32_bf16 v32, v11, v23
    v_dot2c_f32_bf16 v30, v12, v33
    v_dot2c_f32_bf16 v31, v12, v12
    v_dot2c_f32_bf16 v32, v12, v24
    v_dot2c_f32_bf16 v30, v13, v33
    v_dot2c_f32_bf16 v31, v13, v13
    v_dot2c_f32_bf16 v32, v13, v25
    v_dot2c_f32_bf16 v30, v14, v33
    v_dot2c_f32_bf16 v31, v14, v14
    v_dot2c_f32_bf16 v32, v14, v26
    v_dot2c_f32_bf16 v30, v15, v33
    v_dot2c_f32_bf16 v31, v15, v15
    v_dot2c_f32_bf16 v32, v15, v27
    v_dot2c_f32_bf16 v30, v16, v33
    v_dot2c_f32_bf16 v31, v16, v16
    v_dot2c_f32_bf16 v32, v16, v28
    v_dot2c_f32_bf16 v30, v17, v33
    v_dot2c_f32_bf16 v31, v17, v17
    v_dot2c_f32_bf16 v32, v17, v29
    s_nop 0
    v_mov_b32 v34, v30
    v_mov_b32 v35, v31
    v_mov_b32 v36, v32
    v_permlane16_swap_b32 v30, v34
    v_permlane16_swap_b32 v31, v35
    v_permlane16_swap_b32 v32, v36
    v_add_f32 v30, v30, v34
    v_add_f32 v31, v31, v35
    v_add_f32 v32, v32, v36
    v_mov_b32 v34, v30
    v_mov_b32 v35, v31
    v_mov_b32 v36, v32
    v_permlane32_swap_b32 v30, v34
    v_permlane32_swap_b32 v31, v35
    v_permlane32_swap_b32 v32, v36
    v_add_f32 v30, v30, v34
    v_add_f32 v31, v31, v35
    v_add_f32 v32, v32, v36
    s_lshl_b32 s75, s35, 13
    s_add_u32 s75, s75, s65
    s_lshl_b32 s76, s6, 11
    s_add_u32 s75, s75, s76
    s_add_u32 s75, s75, 221184
    s_lshl_b32 s76, s5, 8
    s_add_u32 s76, s76, s75
    s_mov_b64 exec, 0xffff
    s_cmp_eq_u32 s10, 0
    s_cbranch_scc1 L_sl41
    buffer_store_dwordx3 v[30:32], v0, s[36:39], s76 offen
L_sb42:
    s_mov_b64 exec, -1
    v_mov_b32 v2, 159456
    ds_read_b32 v33, v2
    s_cmp_lg_u32 s35, 0
    s_cbranch_scc1 L_A_st
    buffer_load_dwordx3 v[36:38], v0, s[36:39], s75 offen sc1
    buffer_load_dwordx3 v[40:42], v0, s[36:39], s75 offen offset:1024 sc1
    s_lshl_b32 s15, s6, 9
    s_add_u32 s15, s15, 160512
    s_lshl_b32 s74, s4, 3
    s_add_u32 s74, s74, s5
    s_lshl_b32 s74, s74, 4
    s_add_u32 s74, s74, s6
    s_lshl_b32 s74, s74, 3
    s_add_u32 s68, s74, 360448
    v_lshrrev_b32 v75, 8, v0
    v_lshlrev_b32 v75, 4, v75
    v_add_u32 v75, 163584, v75
    ds_read_b128 v[76:79], v75
    s_lshr_b32 s11, s4, 1
    s_mul_i32 s11, s11, 9472
    s_and_b32 s14, s4, 1
    s_lshl_b32 s14, s14, 2
    s_add_u32 s14, s14, s6
    v_lshrrev_b32 v71, 8, v0
    v_and_b32 v72, 0xf0, v0
    v_mul_u32_u24 v74, 2, v72
    v_lshl_add_u32 v74, v71, 3, v74
    v_add_u32 v74, s15, v74
    v_bfe_u32 v73, v0, 6, 3
    v_mul_u32_u24 v73, 32, v73
    v_bfe_u32 v70, v0, 4, 2
    v_lshl_add_u32 v73, v70, 3, v73
    v_add_u32 v73, s15, v73
    v_and_b32 v71, 1, v71
    s_add_u32 s11, s11, 163840
    s_cmp_eq_u32 s5, 4
    s_cbranch_scc1 L_akva_kb
    s_cmp_ge_u32 s5, 2
    s_cbranch_scc1 L_akva_v
    s_lshr_b32 s15, s14, 1
    s_lshl_b32 s15, s15, 10
    s_add_u32 s11, s11, s15
    s_lshl_b32 s15, s5, 9
    s_add_u32 s11, s11, s15
    s_and_b32 s15, s14, 1
    s_lshl_b32 s15, s15, 8
    s_add_u32 s11, s11, s15
    v_lshl_add_u32 v72, v71, 3, v72
    s_branch L_akva_done
L_akva_kb:
    s_lshl_b32 s15, s14, 6
    s_add_u32 s11, s11, s15
    s_add_u32 s11, s11, 8960
    v_lshrrev_b32 v72, 2, v72
    s_branch L_akva_done
L_akva_v:
    s_mul_i32 s15, s14, 608
    s_add_u32 s11, s11, s15
    s_add_u32 s11, s11, 4096
    v_mul_u32_u24 v71, 304, v71
    s_cmp_eq_u32 s5, 5
    s_cbranch_scc1 L_akva_v5
    v_lshl_add_u32 v71, v70, 4, v71
    v_bfe_u32 v70, v0, 6, 1
    v_lshl_add_u32 v72, v70, 7, v71
    s_and_b32 s15, s5, 1
    s_lshl_b32 s15, s15, 6
    s_add_u32 s11, s11, s15
    s_mov_b32 s12, 0xff00ff00
    s_mov_b32 s13, 0
    s_branch L_akva_done
L_akva_v5:
    v_add3_u32 v72, v71, v72, 32
    s_mov_b64 exec, 0x20002000
    v_add_u32 v72, 48, v72
    s_mov_b64 exec, -1
    s_mov_b32 s12, 0xe000e000
    s_mov_b32 s13, 0x20002000
L_akva_done:
    v_cvt_pk_bf16_f32 v132, v108, v109
    v_cvt_pk_bf16_f32 v133, v110, v111
    v_cvt_pk_bf16_f32 v134, v112, v113
    v_cvt_pk_bf16_f32 v135, v114, v115
    v_cvt_pk_bf16_f32 v136, v116, v117
    v_cvt_pk_bf16_f32 v137, v118, v119
    v_cvt_pk_bf16_f32 v138, v120, v121
    v_cvt_pk_bf16_f32 v139, v122, v123
    v_mov_b32 v140, v16
    v_mov_b32 v141, v17
    s_branch L_A_st2
L_A_st:
    buffer_load_dwordx3 v[36:38], v0, s[36:39], s75 offen sc1
    buffer_load_dwordx3 v[40:42], v0, s[36:39], s75 offen offset:1024 sc1
L_A_st2:
    s_waitcnt vmcnt(0)
    v_max3_u32 v7, v36, v37, v38
    v_max3_u32 v7, v7, v40, v41
    v_max_u32 v7, v7, v42
    v_cmp_eq_u32 vcc, -1, v7
    s_cbranch_vccz L_rd43
    s_sleep 1
    s_sub_i32 s34, s34, 16
    s_cmp_gt_i32 s34, 0
    s_cbranch_scc1 L_A_st
L_rd43:
    v_add_f32 v36, v36, v40
    v_add_f32 v37, v37, v41
    v_add_f32 v38, v38, v42
    v_mov_b32 v40, v36
    v_mov_b32 v41, v37
    v_mov_b32 v42, v38
    v_permlane16_swap_b32 v36, v40
    v_permlane16_swap_b32 v37, v41
    v_permlane16_swap_b32 v38, v42
    v_add_f32 v36, v36, v40
    v_add_f32 v37, v37, v41
    v_add_f32 v38, v38, v42
    v_mov_b32 v40, v36
    v_mov_b32 v41, v37
    v_mov_b32 v42, v38
    v_permlane32_swap_b32 v36, v40
    v_permlane32_swap_b32 v37, v41
    v_permlane32_swap_b32 v38, v42
    v_add_f32 v36, v36, v40
    v_add_f32 v37, v37, v41
    v_add_f32 v38, v38, v42
    v_mul_f32 v36, 0x3ae38e39, v36
    v_mul_f32 v37, 0x3ae38e39, v37
    v_fma_f32 v37, -v36, v36, v37
    v_max_f32 v37, 0, v37
    v_add_f32 v40, 0x3727c5ac, v37
    v_rsq_f32 v40, v40
    s_waitcnt lgkmcnt(0)
    v_fma_f32 v41, -v36, v33, v38
    v_add_f32 v38, 1.0, v40
    v_mul_f32 v39, v36, v40
    s_cmp_lg_u32 s35, 0
    s_cbranch_scc1 L_A_key
    v_mul_f32 v37, v37, v38
    v_mov_b32 v42, 0x3727c5ac
    v_fma_f32 v37, v37, v38, v42
    v_rsq_f32 v37, v37
    v_fma_f32 v124, -v36, v76, v124
    v_fma_f32 v125, -v36, v77, v125
    v_fma_f32 v126, -v36, v78, v126
    v_fma_f32 v127, -v36, v79, v127
    v_mul_f32 v37, v37, v38
    v_mul_f32 v124, v124, v37
    v_mul_f32 v125, v125, v37
    v_mul_f32 v126, v126, v37
    v_mul_f32 v127, v127, v37
    v_cvt_pk_bf16_f32 v130, v124, v125
    v_cvt_pk_bf16_f32 v131, v126, v127
    s_cmp_ge_u32 s5, 6
    s_cbranch_scc1 L_akv_done
    s_cmp_eq_u32 s5, 4
    s_cbranch_scc1 L_akv_kb
    s_cmp_ge_u32 s5, 2
    s_cbranch_scc1 L_akv_v
    s_mov_b32 exec_lo, 0
    buffer_store_dwordx2 v[130:131], v72, s[36:39], s11 offen sc1
    s_branch L_akv_done
L_akv_kb:
    s_mov_b32 exec_lo, 0
    s_mov_b32 exec_hi, 0xffff0000
    buffer_store_dword v131, v72, s[36:39], s11 offen sc1
    s_branch L_akv_done
L_akv_v:
    ds_write_b64 v74, v[130:131] offset:0
    ds_read_b64_tr_b16 v[124:125], v73 offset:0
    ds_read_b64_tr_b16 v[126:127], v73 offset:256
    s_mov_b32 exec_hi, 0
    s_mov_b32 exec_lo, s13
    s_waitcnt lgkmcnt(0)
    v_mov_b32 v124, 0x3f803f80
    v_mov_b32 v125, 0x3f803f80
    v_mov_b32 v126, 0x3f803f80
    v_mov_b32 v127, 0x3f803f80
    s_mov_b32 exec_lo, s12
    buffer_store_dwordx4 v[124:127], v72, s[36:39], s11 offen sc1
L_akv_done:
    s_lshl_b32 s19, s6, 8
    s_add_u32 s19, s19, 159488
    s_mov_b64 exec, 0xffff
    v_add_u32 v6, s19, v0
    v_mul_f32 v37, 0x3eae1a93, v37
    ds_write_b128 v6, v[36:39]
    s_add_u32 s79, s6, 52
    s_lshl_b64 exec, 1, s79
    v_mov_b32 v7, 2
    ds_write_b32 v1, v7
    s_mov_b64 exec, -1
L_A_key:
    v_mul_f32 v41, v41, v40
    v_cvt_pk_bf16_f32 v41, v41, v41
    v_ashrrev_i32 v42, 31, v41
    v_or_b32 v42, 0x80000000, v42
    v_xor_b32 v41, v41, v42
    v_and_b32 v41, 0xffff0000, v41
    s_lshl_b32 s18, s4, 6
    s_lshl_b32 s19, s6, 4
    s_add_u32 s18, s18, s19
    s_sub_u32 s19, 0xffff, s18
    v_bfe_u32 v2, v0, 4, 4
    v_sub_u32 v42, s19, v2
    v_or_b32 v41, v41, v42
    v_mov_b32 v43, v41
    s_nop 0
    v_max_u32_dpp v41, v41, v41 quad_perm:[1,0,3,2] row_mask:0xf bank_mask:0xf
    s_nop 1
    v_max_u32_dpp v41, v41, v41 quad_perm:[2,3,0,1] row_mask:0xf bank_mask:0xf
    s_nop 1
    v_max_u32_dpp v41, v41, v41 row_half_mirror row_mask:0xf bank_mask:0xf
    s_nop 1
    v_max_u32_dpp v41, v41, v41 row_mirror row_mask:0xf bank_mask:0xf
    s_cmp_lg_u32 s5, 7
    s_cbranch_scc1 L_nokey
    s_lshl_b32 s19, s18, 3
    s_lshl_b32 s76, s35, 14
    s_add_u32 s19, s19, s76
    s_add_u32 s19, s19, 393216
    s_mov_b64 exec, 1
    buffer_store_dword v41, off, s[36:39], s19 sc1
    s_mov_b64 exec, -1
L_nokey:
    v_cmp_eq_u32 s[8:9], v41, v43
    s_add_u32 s19, s35, 2
    s_add_u32 s79, s6, 38
    s_lshl_b64 exec, 1, s79
    v_mov_b32 v7, s19
    ds_write_b32 v1, v7
    s_mov_b64 exec, -1
    v_lshrrev_b32 v3, 8, v3
    v_lshlrev_b32 v3, 4, v3
    v_and_b32 v4, 8, v4
    s_mul_i32 s75, s35, 9216
    s_mul_i32 s76, s6, 2304
    s_add_u32 s75, s75, s76
    s_add_u32 s75, s75, s65
    s_add_u32 s75, s75, s64
    s_add_u32 s75, s75, 237568
    v_lshlrev_b32 v20, 16, v8
    v_and_b32 v21, 0xffff0000, v8
    v_fma_f32 v22, v20, v40, -v39
    v_fma_f32 v23, v21, v40, -v39
    v_cvt_pk_bf16_f32 v44, v22, v23
    v_add_f32 v20, v20, v22
    v_add_f32 v21, v21, v23
    v_cvt_pk_bf16_f32 v56, v20, v21
    v_lshlrev_b32 v20, 16, v9
    v_and_b32 v21, 0xffff0000, v9
    v_fma_f32 v22, v20, v40, -v39
    v_fma_f32 v23, v21, v40, -v39
    v_cvt_pk_bf16_f32 v45, v22, v23
    v_add_f32 v20, v20, v22
    v_add_f32 v21, v21, v23
    v_cvt_pk_bf16_f32 v57, v20, v21
    v_lshlrev_b32 v20, 16, v10
    v_and_b32 v21, 0xffff0000, v10
    v_fma_f32 v22, v20, v40, -v39
    v_fma_f32 v23, v21, v40, -v39
    v_cvt_pk_bf16_f32 v46, v22, v23
    v_add_f32 v20, v20, v22
    v_add_f32 v21, v21, v23
    v_cvt_pk_bf16_f32 v58, v20, v21
    v_lshlrev_b32 v20, 16, v11
    v_and_b32 v21, 0xffff0000, v11
    v_fma_f32 v22, v20, v40, -v39
    v_fma_f32 v23, v21, v40, -v39
    v_cvt_pk_bf16_f32 v47, v22, v23
    v_add_f32 v20, v20, v22
    v_add_f32 v21, v21, v23
    v_cvt_pk_bf16_f32 v59, v20, v21
    v_lshlrev_b32 v20, 16, v12
    v_and_b32 v21, 0xffff0000, v12
    v_fma_f32 v22, v20, v40, -v39
    v_fma_f32 v23, v21, v40, -v39
    v_cvt_pk_bf16_f32 v48, v22, v23
    v_add_f32 v20, v20, v22
    v_add_f32 v21, v21, v23
    v_cvt_pk_bf16_f32 v60, v20, v21
    v_lshlrev_b32 v20, 16, v13
    v_and_b32 v21, 0xffff0000, v13
    v_fma_f32 v22, v20, v40, -v39
    v_fma_f32 v23, v21, v40, -v39
    v_cvt_pk_bf16_f32 v49, v22, v23
    v_add_f32 v20, v20, v22
    v_add_f32 v21, v21, v23
    v_cvt_pk_bf16_f32 v61, v20, v21
    v_lshlrev_b32 v20, 16, v14
    v_and_b32 v21, 0xffff0000, v14
    v_fma_f32 v22, v20, v40, -v39
    v_fma_f32 v23, v21, v40, -v39
    v_cvt_pk_bf16_f32 v50, v22, v23
    v_add_f32 v20, v20, v22
    v_add_f32 v21, v21, v23
    v_cvt_pk_bf16_f32 v62, v20, v21
    v_lshlrev_b32 v20, 16, v15
    v_and_b32 v21, 0xffff0000, v15
    v_fma_f32 v22, v20, v40, -v39
    v_fma_f32 v23, v21, v40, -v39
    v_cvt_pk_bf16_f32 v51, v22, v23
    v_add_f32 v20, v20, v22
    v_add_f32 v21, v21, v23
    v_cvt_pk_bf16_f32 v63, v20, v21
    v_lshlrev_b32 v20, 16, v16
    v_and_b32 v21, 0xffff0000, v16
    v_fma_f32 v22, v20, v40, -v39
    v_fma_f32 v23, v21, v40, -v39
    v_cvt_pk_bf16_f32 v52, v22, v23
    v_add_f32 v20, v20, v22
    v_add_f32 v21, v21, v23
    v_cvt_pk_bf16_f32 v64, v20, v21
    v_lshlrev_b32 v20, 16, v17
    v_and_b32 v21, 0xffff0000, v17
    v_fma_f32 v22, v20, v40, -v39
    v_fma_f32 v23, v21, v40, -v39
    v_cvt_pk_bf16_f32 v53, v22, v23
    v_add_f32 v20, v20, v22
    v_add_f32 v21, v21, v23
    v_cvt_pk_bf16_f32 v65, v20, v21
    s_mov_b64 exec, s[8:9]
    buffer_store_dwordx4 v[44:47], v3, s[36:39], s75 offen sc1
    buffer_store_dwordx4 v[48:51], v3, s[36:39], s75 offen offset:64 sc1
    buffer_store_dwordx4 v[8:11], v3, s[36:39], s75 offen offset:1152 sc1
    buffer_store_dwordx4 v[12:15], v3, s[36:39], s75 offen offset:1216 sc1
    s_mov_b32 exec_hi, 0
    buffer_store_dwordx2 v[52:53], v4, s[36:39], s75 offen offset:128 sc1
    buffer_store_dwordx2 v[16:17], v4, s[36:39], s75 offen offset:1280 sc1
    s_mov_b64 exec, -1
    s_cmp_lg_u32 s35, 0
    s_cbranch_scc1 L_A_tail
    s_mov_b64 exec, 1
    v_sub_u32 v7, 0, v41
    s_waitcnt vmcnt(6)
    buffer_store_dword v7, off, s[36:39], s68 sc1
    s_mov_b64 exec, -1
    s_mov_b32 s35, 1
    s_mov_b32 s28, 0
    s_mov_b32 s29, 82944
    v_mov_b32 v142, v38
    v_mov_b32 v143, v39
    s_setprio 0
    s_branch L_A_att
L_A_tail:
    v_add_u32 v5, s18, v2
    v_mul_u32_u24 v5, 1152, v5
    v_add_u32 v3, v3, v5
    v_add_u32 v4, v4, v5
    s_not_b64 exec, s[8:9]
    buffer_store_dwordx4 v[56:59], v3, s[52:55], s64 offen
    buffer_store_dwordx4 v[60:63], v3, s[52:55], s64 offen offset:64
    s_mov_b32 exec_hi, 0
    buffer_store_dwordx2 v[64:65], v4, s[52:55], s64 offen offset:128
    s_mov_b64 exec, -1
L_w44:
    ds_read_b32 v7, v1
    s_waitcnt lgkmcnt(0)
    v_cmp_gt_u32 vcc, 1, v7
    s_and_b32 s79, vcc_hi, 0x8000
    s_cbranch_scc0 L_wd45
    s_sleep 1
    s_sub_i32 s34, s34, 5
    s_cmp_gt_i32 s34, 0
    s_cbranch_scc1 L_w44
L_wd45:
    v_readlane_b32 s73, v7, 47
    s_nop 1
    v_cmp_ne_u32 vcc, s73, v43
    s_and_b64 exec, vcc, s[8:9]
    s_cbranch_scc0 L_end
    buffer_store_dwordx4 v[56:59], v3, s[52:55], s64 offen
    buffer_store_dwordx4 v[60:63], v3, s[52:55], s64 offen offset:64
    s_mov_b32 exec_hi, 0
    buffer_store_dwordx2 v[64:65], v4, s[52:55], s64 offen offset:128
    s_branch L_end
L_B_start:
    s_setprio 2
    s_lshl_b32 s74, s4, 6
    s_lshl_b32 s75, s6, 4
    s_add_u32 s74, s74, s75
    s_mul_i32 s75, s74, 1152
    v_lshrrev_b32 v2, 6, v0
    v_mul_u32_u24 v2, 1152, v2
    v_lshrrev_b32 v3, 4, v0
    v_xor_b32 v4, v0, v3
    v_and_b32 v4, 0x30, v4
    v_add_u32 v2, v2, v4
    s_lshl_b32 s74, s4, 3
    s_add_u32 s74, s74, s5
    s_lshl_b32 s74, s74, 4
    s_add_u32 s74, s74, s6
    s_lshl_b32 s74, s74, 3
    s_add_u32 s68, s74, 327680
    s_mul_i32 s76, s6, 14336
    s_add_u32 s76, s76, 82944
    s_mul_i32 s77, s6, 3072
    s_add_u32 s77, s77, 140288
    s_lshl_b32 s78, s6, 10
    s_add_u32 s78, s78, 152576
    v_lshrrev_b32 v4, 2, v0
    v_xor_b32 v3, v3, v4
    v_and_b32 v3, 0x30, v3
    v_and_b32 v4, 0xf0, v0
    v_lshl_add_u32 v3, v4, 2, v3
    v_add_u32 v100, s76, v3
    v_add_u32 v101, s77, v3
    v_add_u32 v102, s78, v3
    s_mov_b32 m0, s76
    v_mov_b32 v117, v2
    s_waitcnt lgkmcnt(0)
    s_mov_b64 s[40:41], s[8:9]
    buffer_load_dwordx4 v117, s[40:43], s75 offen offset:0 lds
    s_add_u32 m0, s76, 960
    s_nop 0
    buffer_load_dwordx4 v117, s[40:43], s75 offen offset:64 lds
    s_mov_b64 s[36:37], s[32:33]
    s_mov_b64 s[44:45], s[10:11]
    s_mov_b64 s[48:49], s[16:17]
    s_mov_b64 s[52:53], s[28:29]
    s_mov_b64 s[56:57], s[20:21]
    s_mov_b64 s[60:61], s[26:27]
    s_mov_b64 s[20:21], s[22:23]
    s_mov_b32 s22, 5308416
    s_mov_b32 s23, s39
    s_mov_b32 s26, 5308416
    s_mov_b32 s27, s39
    s_mov_b32 s28, 82944
    s_mov_b32 s29, 0
    s_mul_i32 s15, s6, 3072
    s_add_u32 s15, s15, 140288
    s_lshr_b32 s11, s4, 1
    s_mul_i32 s11, s11, 9472
    s_and_b32 s14, s4, 1
    s_lshl_b32 s14, s14, 2
    s_add_u32 s14, s14, s6
    v_lshrrev_b32 v109, 8, v0
    v_and_b32 v110, 0xf0, v0
    v_mul_u32_u24 v112, 10, v110
    v_lshl_add_u32 v112, v109, 3, v112
    v_add_u32 v112, s15, v112
    v_bfe_u32 v111, v0, 6, 3
    v_mul_u32_u24 v111, 160, v111
    v_bfe_u32 v108, v0, 4, 2
    v_lshl_add_u32 v111, v108, 3, v111
    v_add_u32 v111, s15, v111
    v_and_b32 v109, 1, v109
    s_cmp_eq_u32 s5, 4
    s_cbranch_scc1 L_bkva_kb
    s_cmp_ge_u32 s5, 2
    s_cbranch_scc1 L_bkva_v
    s_lshr_b32 s15, s14, 1
    s_lshl_b32 s15, s15, 10
    s_add_u32 s11, s11, s15
    s_lshl_b32 s15, s5, 9
    s_add_u32 s11, s11, s15
    s_and_b32 s15, s14, 1
    s_lshl_b32 s15, s15, 8
    s_add_u32 s11, s11, s15
    v_lshl_add_u32 v110, v109, 3, v110
    s_branch L_bkva_done
L_bkva_kb:
    s_lshl_b32 s15, s14, 6
    s_add_u32 s11, s11, s15
    s_add_u32 s11, s11, 8960
    v_lshrrev_b32 v110, 2, v110
    s_branch L_bkva_done
L_bkva_v:
    s_mul_i32 s15, s14, 608
    s_add_u32 s11, s11, s15
    s_add_u32 s11, s11, 4096
    v_mul_u32_u24 v109, 304, v109
    s_cmp_eq_u32 s5, 5
    s_cbranch_scc1 L_bkva_v5
    v_lshl_add_u32 v109, v108, 4, v109
    v_bfe_u32 v108, v0, 6, 1
    v_lshl_add_u32 v110, v108, 7, v109
    s_and_b32 s15, s5, 1
    s_lshl_b32 s15, s15, 6
    s_add_u32 s11, s11, s15
    s_mov_b32 s12, 0xff00ff00
    s_mov_b32 s13, 0
    s_branch L_bkva_done
L_bkva_v5:
    v_add3_u32 v110, v109, v110, 32
    s_mov_b64 exec, 0x20002000
    v_add_u32 v110, 48, v110
    s_mov_b64 exec, -1
    s_mov_b32 s12, 0xe000e000
    s_mov_b32 s13, 0x20002000
L_bkva_done:
    v_lshrrev_b32 v6, 1, v0
    v_add_u32 v6, 73728, v6
    v_and_b32 v2, 0x300, v0
    v_lshlrev_b32 v2, 2, v2
    v_and_b32 v7, 0xc0, v0
    v_lshl_add_u32 v2, v7, 1, v2
    v_bfe_u32 v7, v0, 4, 2
    v_lshl_add_u32 v2, v7, 3, v2
    v_lshrrev_b32 v7, 2, v0
    v_and_b32 v7, 0x60, v7
    v_add_u32 v2, v2, v7
    v_add_u32 v2, s29, v2
    v_xor_b32 v3, 32, v2
    v_xor_b32 v4, 64, v2
    v_xor_b32 v5, 96, v2
    s_mov_b32 s17, 1
    s_lshl_b32 s15, s6, 8
    s_add_u32 s15, s15, 159488
    v_and_b32 v113, 0xf0, v0
    v_add_u32 v113, s15, v113
    v_add_u32 v114, 4294958080, v6
    v_lshrrev_b32 v115, 8, v0
    v_lshlrev_b32 v115, 4, v115
    v_add_u32 v115, 163584, v115
    s_lshl_b32 s15, s6, 9
    s_add_u32 s15, s15, 160000
    v_add_u32 v116, s15, v0
    v_mov_b32 v84, 0
    s_mov_b32 s8, 0xaaaaaaaa
    s_mov_b32 s9, s8
    s_mov_b32 s14, 0xcccccccc
    s_mov_b32 s15, s14
    s_mov_b32 s18, 0x00f0000f
    s_mov_b32 s19, 0xf0000f00
    v_mov_b32 v80, 0x3f803f80
    v_mov_b32 v81, 0x3f803f80
    v_mov_b32 v82, 0x3f803f80
    v_mov_b32 v83, 0x3f803f80
    s_add_u32 m0, s76, 1920
    s_nop 0
    buffer_load_dwordx4 v117, s[40:43], s75 offen offset:128 lds
    s_add_u32 m0, s76, 2880
    s_nop 0
    buffer_load_dwordx4 v117, s[40:43], s75 offen offset:192 lds
    s_add_u32 m0, s76, 3840
    s_nop 0
    buffer_load_dwordx4 v117, s[40:43], s75 offen offset:256 lds
    s_add_u32 m0, s76, 4800
    s_nop 0
    buffer_load_dwordx4 v117, s[40:43], s75 offen offset:320 lds
    s_add_u32 m0, s76, 5760
    s_nop 0
    buffer_load_dwordx4 v117, s[40:43], s75 offen offset:384 lds
    s_add_u32 m0, s76, 6720
    s_nop 0
    buffer_load_dwordx4 v117, s[40:43], s75 offen offset:448 lds
    s_add_u32 m0, s76, 7680
    s_nop 0
    buffer_load_dwordx4 v117, s[40:43], s75 offen offset:512 lds
    s_add_u32 m0, s76, 8640
    s_nop 0
    buffer_load_dwordx4 v117, s[40:43], s75 offen offset:576 lds
    s_add_u32 m0, s76, 9600
    s_nop 0
    buffer_load_dwordx4 v117, s[40:43], s75 offen offset:640 lds
    s_add_u32 m0, s76, 10560
    s_nop 0
    buffer_load_dwordx4 v117, s[40:43], s75 offen offset:704 lds
    s_add_u32 m0, s76, 11520
    s_nop 0
    buffer_load_dwordx4 v117, s[40:43], s75 offen offset:768 lds
    s_add_u32 m0, s76, 12480
    s_nop 0
    buffer_load_dwordx4 v117, s[40:43], s75 offen offset:832 lds
    s_add_u32 m0, s77, 4294966400
    s_nop 0
    buffer_load_dwordx4 v117, s[40:43], s75 offen offset:896 lds
    s_add_u32 m0, s77, 64
    s_nop 0
    buffer_load_dwordx4 v117, s[40:43], s75 offen offset:960 lds
    s_add_u32 m0, s77, 1024
    s_nop 0
    buffer_load_dwordx4 v117, s[40:43], s75 offen offset:1024 lds
    s_add_u32 m0, s78, 4294966208
    s_nop 0
    buffer_load_dwordx4 v117, s[40:43], s75 offen offset:1088 lds
    s_barrier
    s_mov_b64 exec, 1
    buffer_load_dword v103, off, s[36:39], s68 offset:4 sc1
    s_mov_b64 exec, -1
    ds_read_b64_tr_b16 v[132:133], v114 offset:0
    ds_read_b64_tr_b16 v[134:135], v114 offset:512
    ds_read_b64_tr_b16 v[136:137], v114 offset:1024
    ds_read_b64_tr_b16 v[138:139], v114 offset:1536
    ds_read_b64_tr_b16 v[140:141], v114 offset:2048
    ds_read_b64_tr_b16 v[142:143], v114 offset:2560
    ds_read_b64_tr_b16 v[144:145], v114 offset:3072
    ds_read_b64_tr_b16 v[146:147], v114 offset:3584
    ds_read_b64_tr_b16 v[148:149], v114 offset:4096
    ds_read_b64_tr_b16 v[150:151], v114 offset:4608
    ds_read_b64_tr_b16 v[152:153], v114 offset:5120
    ds_read_b64_tr_b16 v[154:155], v114 offset:5632
    ds_read_b64_tr_b16 v[156:157], v114 offset:6144
    ds_read_b64_tr_b16 v[158:159], v114 offset:6656
    ds_read_b64_tr_b16 v[160:161], v114 offset:7168
    ds_read_b64_tr_b16 v[162:163], v114 offset:7680
    ds_read_b64_tr_b16 v[164:165], v114 offset:8192
    ds_read_b64_tr_b16 v[166:167], v114 offset:8704
    s_add_u32 s79, s6, 56
    s_lshl_b64 exec, 1, s79
    v_mov_b32 v7, 1
    ds_write_b32 v1, v7
    s_mov_b64 exec, -1
    s_waitcnt vmcnt(18)
    ds_read_b128 v[8:11], v100 offset:0
    s_waitcnt vmcnt(17)
    ds_read_b128 v[12:15], v100 offset:1024
    s_waitcnt vmcnt(16)
    ds_read_b128 v[16:19], v100 offset:2048
    s_waitcnt vmcnt(15)
    ds_read_b128 v[20:23], v100 offset:3072
    s_waitcnt lgkmcnt(4)
    v_mfma_f32_16x16x32_bf16 v[92:95], v[132:135], v[80:83], 0
    v_mfma_f32_16x16x32_bf16 v[92:95], v[136:139], v[80:83], v[92:95]
    v_mfma_f32_16x16x32_bf16 v[92:95], v[140:143], v[80:83], v[92:95]
    v_mfma_f32_16x16x32_bf16 v[92:95], v[144:147], v[80:83], v[92:95]
    v_mfma_f32_16x16x32_bf16 v[92:95], v[148:151], v[80:83], v[92:95]
    v_mfma_f32_16x16x32_bf16 v[92:95], v[152:155], v[80:83], v[92:95]
    v_mfma_f32_16x16x32_bf16 v[92:95], v[156:159], v[80:83], v[92:95]
    v_mfma_f32_16x16x32_bf16 v[92:95], v[160:163], v[80:83], v[92:95]
    v_mfma_f32_16x16x32_bf16 v[92:95], v[164:167], v[80:83], v[92:95]
    s_waitcnt vmcnt(14)
    ds_read_b128 v[24:27], v100 offset:4096
    s_waitcnt lgkmcnt(4)
    v_mfma_f32_16x16x32_bf16 v[124:127], v[132:135], v[8:11], 0
    v_mfma_f32_16x16x32_bf16 v[88:91], v[8:11], v[8:11], 0
    v_mfma_f32_16x16x32_bf16 v[84:87], v[80:83], v[8:11], 0
    s_waitcnt vmcnt(13)
    ds_read_b128 v[28:31], v100 offset:5120
    s_waitcnt lgkmcnt(4)
    v_mfma_f32_16x16x32_bf16 v[128:131], v[132:135], v[12:15], 0
    v_mfma_f32_16x16x32_bf16 v[88:91], v[12:15], v[12:15], v[88:91]
    v_mfma_f32_16x16x32_bf16 v[84:87], v[80:83], v[12:15], v[84:87]
    s_waitcnt vmcnt(12)
    ds_read_b128 v[32:35], v100 offset:6144
    s_waitcnt lgkmcnt(4)
    v_mfma_f32_16x16x32_bf16 v[124:127], v[136:139], v[16:19], v[124:127]
    v_mfma_f32_16x16x32_bf16 v[88:91], v[16:19], v[16:19], v[88:91]
    v_mfma_f32_16x16x32_bf16 v[84:87], v[80:83], v[16:19], v[84:87]
    v_mov_b32 v96, v92
    v_mov_b32 v97, v93
    v_mov_b32 v98, v94
    v_mov_b32 v99, v95
    v_permlane32_swap_b32 v92, v96
    v_permlane32_swap_b32 v93, v97
    v_permlane32_swap_b32 v94, v98
    v_permlane32_swap_b32 v95, v99
    v_add_f32 v92, v92, v96
    v_add_f32 v93, v93, v97
    v_add_f32 v94, v94, v98
    v_add_f32 v95, v95, v99
    s_waitcnt vmcnt(11)
    ds_read_b128 v[36:39], v100 offset:7168
    s_waitcnt lgkmcnt(4)
    v_mfma_f32_16x16x32_bf16 v[128:131], v[136:139], v[20:23], v[128:131]
    v_mfma_f32_16x16x32_bf16 v[88:91], v[20:23], v[20:23], v[88:91]
    v_mfma_f32_16x16x32_bf16 v[84:87], v[80:83], v[20:23], v[84:87]
    s_waitcnt vmcnt(10)
    ds_read_b128 v[40:43], v100 offset:8192
    s_waitcnt lgkmcnt(4)
    v_mfma_f32_16x16x32_bf16 v[124:127], v[140:143], v[24:27], v[124:127]
    v_mfma_f32_16x16x32_bf16 v[88:91], v[24:27], v[24:27], v[88:91]
    v_mfma_f32_16x16x32_bf16 v[84:87], v[80:83], v[24:27], v[84:87]
    s_waitcnt vmcnt(9)
    ds_read_b128 v[44:47], v100 offset:9216
    s_waitcnt lgkmcnt(4)
    v_mfma_f32_16x16x32_bf16 v[128:131], v[140:143], v[28:31], v[128:131]
    v_mfma_f32_16x16x32_bf16 v[88:91], v[28:31], v[28:31], v[88:91]
    v_mfma_f32_16x16x32_bf16 v[84:87], v[80:83], v[28:31], v[84:87]
    s_waitcnt vmcnt(8)
    ds_read_b128 v[48:51], v100 offset:10240
    s_waitcnt lgkmcnt(4)
    v_mfma_f32_16x16x32_bf16 v[124:127], v[144:147], v[32:35], v[124:127]
    v_mfma_f32_16x16x32_bf16 v[88:91], v[32:35], v[32:35], v[88:91]
    v_mfma_f32_16x16x32_bf16 v[84:87], v[80:83], v[32:35], v[84:87]
    s_waitcnt vmcnt(7)
    ds_read_b128 v[52:55], v100 offset:11264
    s_waitcnt lgkmcnt(4)
    v_mfma_f32_16x16x32_bf16 v[128:131], v[144:147], v[36:39], v[128:131]
    v_mfma_f32_16x16x32_bf16 v[88:91], v[36:39], v[36:39], v[88:91]
    v_mfma_f32_16x16x32_bf16 v[84:87], v[80:83], v[36:39], v[84:87]
    s_waitcnt vmcnt(6)
    ds_read_b128 v[56:59], v100 offset:12288
    s_waitcnt lgkmcnt(4)
    v_mfma_f32_16x16x32_bf16 v[124:127], v[148:151], v[40:43], v[124:127]
    v_mfma_f32_16x16x32_bf16 v[88:91], v[40:43], v[40:43], v[88:91]
    v_mfma_f32_16x16x32_bf16 v[84:87], v[80:83], v[40:43], v[84:87]
    s_waitcnt vmcnt(5)
    ds_read_b128 v[60:63], v100 offset:13312
    s_waitcnt lgkmcnt(4)
    v_mfma_f32_16x16x32_bf16 v[128:131], v[148:151], v[44:47], v[128:131]
    v_mfma_f32_16x16x32_bf16 v[88:91], v[44:47], v[44:47], v[88:91]
    v_mfma_f32_16x16x32_bf16 v[84:87], v[80:83], v[44:47], v[84:87]
    s_waitcnt vmcnt(4)
    ds_read_b128 v[64:67], v101 offset:0
    s_waitcnt lgkmcnt(4)
    v_mfma_f32_16x16x32_bf16 v[124:127], v[152:155], v[48:51], v[124:127]
    v_mfma_f32_16x16x32_bf16 v[88:91], v[48:51], v[48:51], v[88:91]
    v_mfma_f32_16x16x32_bf16 v[84:87], v[80:83], v[48:51], v[84:87]
    s_waitcnt vmcnt(3)
    ds_read_b128 v[68:71], v101 offset:1024
    s_waitcnt lgkmcnt(4)
    v_mfma_f32_16x16x32_bf16 v[128:131], v[152:155], v[52:55], v[128:131]
    v_mfma_f32_16x16x32_bf16 v[88:91], v[52:55], v[52:55], v[88:91]
    v_mfma_f32_16x16x32_bf16 v[84:87], v[80:83], v[52:55], v[84:87]
    s_waitcnt vmcnt(2)
    ds_read_b128 v[72:75], v101 offset:2048
    s_waitcnt lgkmcnt(4)
    v_mfma_f32_16x16x32_bf16 v[124:127], v[156:159], v[56:59], v[124:127]
    v_mfma_f32_16x16x32_bf16 v[88:91], v[56:59], v[56:59], v[88:91]
    v_mfma_f32_16x16x32_bf16 v[84:87], v[80:83], v[56:59], v[84:87]
    s_waitcnt vmcnt(1)
    ds_read_b128 v[76:79], v102 offset:0
    s_waitcnt lgkmcnt(4)
    v_mfma_f32_16x16x32_bf16 v[128:131], v[156:159], v[60:63], v[128:131]
    v_mfma_f32_16x16x32_bf16 v[88:91], v[60:63], v[60:63], v[88:91]
    v_mfma_f32_16x16x32_bf16 v[84:87], v[80:83], v[60:63], v[84:87]
    s_waitcnt lgkmcnt(3)
    v_mfma_f32_16x16x32_bf16 v[124:127], v[160:163], v[64:67], v[124:127]
    v_mfma_f32_16x16x32_bf16 v[88:91], v[64:67], v[64:67], v[88:91]
    v_mfma_f32_16x16x32_bf16 v[84:87], v[80:83], v[64:67], v[84:87]
    s_waitcnt lgkmcnt(2)
    v_mfma_f32_16x16x32_bf16 v[128:131], v[160:163], v[68:71], v[128:131]
    v_mfma_f32_16x16x32_bf16 v[88:91], v[68:71], v[68:71], v[88:91]
    v_mfma_f32_16x16x32_bf16 v[84:87], v[80:83], v[68:71], v[84:87]
    s_waitcnt lgkmcnt(1)
    v_mfma_f32_16x16x32_bf16 v[124:127], v[164:167], v[72:75], v[124:127]
    v_mfma_f32_16x16x32_bf16 v[88:91], v[72:75], v[72:75], v[88:91]
    v_mfma_f32_16x16x32_bf16 v[84:87], v[80:83], v[72:75], v[84:87]
    s_waitcnt lgkmcnt(0)
    v_mfma_f32_16x16x32_bf16 v[128:131], v[164:167], v[76:79], v[128:131]
    v_mfma_f32_16x16x32_bf16 v[88:91], v[76:79], v[76:79], v[88:91]
    v_mfma_f32_16x16x32_bf16 v[84:87], v[80:83], v[76:79], v[84:87]
    s_waitcnt vmcnt(0)
    v_readfirstlane_b32 s70, v103
    s_getreg_b32 s74, hwreg(HW_REG_XCC_ID, 0, 3)
    s_add_u32 s70, s70, 2654435769
    s_add_u32 s70, s70, s74
    v_permlane32_swap_b32 v96, v124
    v_permlane32_swap_b32 v97, v125
    v_permlane32_swap_b32 v98, v126
    v_permlane32_swap_b32 v99, v127
    v_cndmask_b32 v88, v88, v89, s[8:9]
    v_cndmask_b32 v90, v90, v91, s[8:9]
    v_mul_f32 v84, 0x3ae38e39, v84
    v_cndmask_b32 v88, v88, v90, s[14:15]
    v_cndmask_b32 v88, 0, v88, s[18:19]
    v_mov_b32 v89, v88
    v_add_f32 v96, v96, v128
    v_add_f32 v97, v97, v129
    v_permlane16_swap_b32 v88, v89
    v_add_f32 v88, v88, v89
    v_mov_b32 v89, v88
    v_add_f32 v98, v98, v130
    v_add_f32 v99, v99, v131
    v_permlane32_swap_b32 v88, v89
    v_add_f32 v88, v88, v89
    v_mul_f32 v88, 0x3ae38e39, v88
    v_fma_f32 v88, -v84, v84, v88
    v_max_f32 v88, 0, v88
    v_add_f32 v85, 0x3727c5ac, v88
    v_rsq_f32 v85, v85
    v_fma_f32 v124, -v84, v92, v96
    v_fma_f32 v125, -v84, v93, v97
    v_fma_f32 v126, -v84, v94, v98
    v_fma_f32 v127, -v84, v95, v99
    v_mul_f32 v124, v124, v85
    v_mul_f32 v125, v125, v85
    v_mul_f32 v126, v126, v85
    v_mul_f32 v127, v127, v85
    v_cvt_pk_bf16_f32 v130, v124, v125
    v_cvt_pk_bf16_f32 v131, v126, v127
    s_cmp_ge_u32 s5, 6
    s_cbranch_scc1 L_bkv_done
    s_cmp_eq_u32 s5, 4
    s_cbranch_scc1 L_bkv_kb
    s_cmp_ge_u32 s5, 2
    s_cbranch_scc1 L_bkv_v
    s_mov_b32 exec_lo, 0
    buffer_store_dwordx2 v[130:131], v110, s[36:39], s11 offen sc1
    s_branch L_bkv_done
L_bkv_kb:
    s_mov_b32 exec_lo, 0
    s_mov_b32 exec_hi, 0xffff0000
    buffer_store_dword v131, v110, s[36:39], s11 offen sc1
    s_branch L_bkv_done
L_bkv_v:
    ds_write_b64 v112, v[130:131] offset:128
    ds_read_b64_tr_b16 v[124:125], v111 offset:128
    ds_read_b64_tr_b16 v[126:127], v111 offset:1408
    s_mov_b32 exec_hi, 0
    s_mov_b32 exec_lo, s13
    s_waitcnt lgkmcnt(0)
    v_mov_b32 v124, 0x3f803f80
    v_mov_b32 v125, 0x3f803f80
    v_mov_b32 v126, 0x3f803f80
    v_mov_b32 v127, 0x3f803f80
    s_mov_b32 exec_lo, s12
    buffer_store_dwordx4 v[124:127], v110, s[36:39], s11 offen sc1
L_bkv_done:
    s_add_u32 s79, s6, 52
    s_lshl_b64 exec, 1, s79
    v_mov_b32 v7, 1
    ds_write_b32 v1, v7
    s_mov_b64 exec, -1
    v_mul_f32 v85, 0x3eae1a93, v85
    ds_write_b128 v115, v[92:95]
    ds_write_b64 v113, v[84:85]
    s_mov_b32 exec_lo, 0
    ds_write_b128 v116, v[96:99]
    s_mov_b32 exec_lo, -1
    s_mov_b32 s13, 0
    s_mov_b32 s14, 31
    s_branch L_B_q2
    v_mul_f32 v85, 0x3eae1a93, v85
    ds_write_b64 v3, v[84:85]
    v_lshrrev_b32 v2, 8, v0
    v_lshlrev_b32 v2, 4, v2
    v_add_u32 v2, 163584, v2
    ds_write_b128 v2, v[92:95]
    s_lshl_b32 s15, s6, 9
    s_add_u32 s15, s15, 160000
    v_add_u32 v2, s15, v0
    s_mov_b32 exec_lo, 0
    ds_write_b128 v2, v[96:99]
    s_mov_b32 exec_lo, -1
    s_mov_b32 s13, 0
    s_mov_b32 s14, 31
L_B_q:
    v_lshrrev_b32 v6, 1, v0
    v_add_u32 v6, 73728, v6
    v_and_b32 v2, 0x300, v0
    v_lshlrev_b32 v2, 2, v2
    v_and_b32 v7, 0xc0, v0
    v_lshl_add_u32 v2, v7, 1, v2
    v_bfe_u32 v7, v0, 4, 2
    v_lshl_add_u32 v2, v7, 3, v2
    v_lshrrev_b32 v7, 2, v0
    v_and_b32 v7, 0x60, v7
    v_add_u32 v2, v2, v7
    v_add_u32 v2, s29, v2
    v_xor_b32 v3, 32, v2
    v_xor_b32 v4, 64, v2
    v_xor_b32 v5, 96, v2
L_B_q2:
    s_cmp_lg_u32 s35, 0
    s_cbranch_scc1 L_q0
L_w46:
    ds_read_b32 v7, v1
    s_waitcnt lgkmcnt(0)
    v_cmp_gt_u32 vcc, 1, v7
    s_and_b32 s79, vcc_lo, 0xf0000
    s_cbranch_scc0 L_wd47
    s_sub_i32 s34, s34, 1
    s_cmp_gt_i32 s34, 0
    s_cbranch_scc1 L_w46
L_wd47:
L_q0:
    ds_read_b64_tr_b16 v[80:81], v2 offset:0
    ds_read_b64_tr_b16 v[82:83], v2 offset:512
    ds_read_b64_tr_b16 v[84:85], v3 offset:0
    ds_read_b64_tr_b16 v[86:87], v3 offset:512
    ds_read_b64_tr_b16 v[88:89], v4 offset:0
    ds_read_b64_tr_b16 v[90:91], v4 offset:512
    ds_read_b64_tr_b16 v[92:93], v5 offset:0
    ds_read_b64_tr_b16 v[94:95], v5 offset:512
    ds_read_b64_tr_b16 v[96:97], v2 offset:4096
    ds_read_b64_tr_b16 v[98:99], v2 offset:4608
    ds_read_b64_tr_b16 v[100:101], v3 offset:4096
    ds_read_b64_tr_b16 v[102:103], v3 offset:4608
    s_cmp_eq_u32 s35, 0
    s_cbranch_scc1 L_qx
L_w48:
    ds_read_b32 v7, v1
    s_waitcnt lgkmcnt(0)
    v_cmp_gt_u32 vcc, 2, v7
    s_and_b32 s79, vcc_hi, s16
    s_cbranch_scc0 L_wd49
    s_sub_i32 s34, s34, 1
    s_cmp_gt_i32 s34, 0
    s_cbranch_scc1 L_w48
L_wd49:
    s_setprio 2
    buffer_load_dwordx4 v[8:11], v0, s[36:39], s74 offen offset:0 sc1
    buffer_load_dwordx4 v[12:15], v0, s[36:39], s74 offen offset:1024 sc1
    buffer_load_dwordx4 v[16:19], v0, s[36:39], s74 offen offset:2048 sc1
    buffer_load_dwordx4 v[20:23], v0, s[36:39], s74 offen offset:3072 sc1
    buffer_load_dwordx4 v[24:27], v0, s[36:39], s75 offen offset:0 sc1
    buffer_load_dwordx4 v[28:31], v0, s[36:39], s75 offen offset:1024 sc1
    buffer_load_dwordx4 v[32:35], v0, s[36:39], s75 offen offset:2048 sc1
    buffer_load_dwordx4 v[36:39], v0, s[36:39], s75 offen offset:3072 sc1
    buffer_load_dwordx4 v[40:43], v0, s[36:39], s76 offen offset:0 sc1
    buffer_load_dwordx4 v[44:47], v0, s[36:39], s76 offen offset:1024 sc1
    buffer_load_dwordx4 v[48:51], v0, s[36:39], s76 offen offset:2048 sc1
    buffer_load_dwordx4 v[52:55], v0, s[36:39], s76 offen offset:3072 sc1
L_w50:
    ds_read_b32 v7, v1
    s_waitcnt lgkmcnt(0)
    v_cmp_gt_u32 vcc, 11, v7
    s_and_b32 s79, vcc_lo, 0xf0000ff
    s_cbranch_scc0 L_wd51
    s_sub_i32 s34, s34, 1
    s_cmp_gt_i32 s34, 0
    s_cbranch_scc1 L_w50
L_wd51:
    ds_write_b128 v105, v[132:135] offset:36864
    ds_write_b128 v105, v[136:139] offset:37888
    ds_write_b128 v105, v[140:143] offset:38912
    ds_write_b128 v105, v[144:147] offset:39936
    ds_write_b128 v105, v[148:151] offset:40960
    ds_write_b128 v105, v[152:155] offset:41984
    ds_write_b128 v105, v[156:159] offset:43008
    ds_write_b128 v105, v[160:163] offset:44032
    ds_write_b128 v105, v[164:167] offset:45056
    s_add_u32 s79, s6, 16
    s_lshl_b64 exec, 1, s79
    v_mov_b32 v7, 4
    ds_write_b32 v1, v7
    s_mov_b64 exec, -1
L_qx:
    ds_read_b64_tr_b16 v[132:133], v4 offset:4096
    ds_read_b64_tr_b16 v[134:135], v4 offset:4608
    ds_read_b64_tr_b16 v[136:137], v5 offset:4096
    ds_read_b64_tr_b16 v[138:139], v5 offset:4608
    ds_read_b64_tr_b16 v[140:141], v6 offset:0
    ds_read_b64_tr_b16 v[142:143], v6 offset:512
    ds_read_b64_tr_b16 v[144:145], v2 offset:8192
    ds_read_b64_tr_b16 v[146:147], v2 offset:8704
    s_mov_b32 s16, 0
    s_waitcnt vmcnt(9)
    v_max3_u32 v107, v8, v9, v10
    v_max3_u32 v107, v107, v11, v12
    v_max3_u32 v107, v107, v13, v14
    v_max3_u32 v107, v107, v15, v16
    v_max3_u32 v107, v107, v17, v18
    v_max_u32 v107, v107, v19
    v_cmp_lt_u32 vcc, s69, v107
    s_cbranch_vccnz L_cr53
L_cg52:
    s_waitcnt lgkmcnt(12)
    v_mfma_f32_16x16x32_bf16 v[108:111], v[80:83], v[8:11], 0
    ds_read_b64_tr_b16 v[80:81], v3 offset:8192
    ds_read_b64_tr_b16 v[82:83], v3 offset:8704
    v_mfma_f32_16x16x32_bf16 v[112:115], v[84:87], v[8:11], 0
    ds_read_b64_tr_b16 v[84:85], v4 offset:8192
    ds_read_b64_tr_b16 v[86:87], v4 offset:8704
    s_cmp_eq_u32 s35, 0
    s_cbranch_scc1 L_ql54
    buffer_load_dwordx4 v[56:59], v0, s[36:39], s77 offen offset:0 sc1
    buffer_load_dwordx4 v[60:63], v0, s[36:39], s77 offen offset:1024 sc1
    buffer_load_dwordx4 v[64:67], v0, s[36:39], s77 offen offset:2048 sc1
L_ql54:
    v_mfma_f32_16x16x32_bf16 v[116:119], v[88:91], v[8:11], 0
    ds_read_b64_tr_b16 v[88:89], v5 offset:8192
    ds_read_b64_tr_b16 v[90:91], v5 offset:8704
    v_mfma_f32_16x16x32_bf16 v[120:123], v[92:95], v[8:11], 0
    ds_read_b64_tr_b16 v[92:93], v2 offset:12288
    ds_read_b64_tr_b16 v[94:95], v2 offset:12800
    s_waitcnt lgkmcnt(10)
    v_mfma_f32_16x16x32_bf16 v[108:111], v[96:99], v[12:15], v[108:111]
    ds_read_b64_tr_b16 v[96:97], v3 offset:12288
    ds_read_b64_tr_b16 v[98:99], v3 offset:12800
    v_mfma_f32_16x16x32_bf16 v[112:115], v[100:103], v[12:15], v[112:115]
    ds_read_b64_tr_b16 v[100:101], v4 offset:12288
    ds_read_b64_tr_b16 v[102:103], v4 offset:12800
    v_mfma_f32_16x16x32_bf16 v[116:119], v[132:135], v[12:15], v[116:119]
    v_mfma_f32_16x16x32_bf16 v[120:123], v[136:139], v[12:15], v[120:123]
    v_mfma_f32_16x16x32_bf16 v[124:127], v[140:143], v[8:11], 0
    ds_read_b64_tr_b16 v[8:9], v5 offset:12288
    ds_read_b64_tr_b16 v[10:11], v5 offset:12800
    s_waitcnt vmcnt(9)
    v_max_u32 v107, v20, v21
    v_mfma_f32_16x16x32_bf16 v[128:131], v[140:143], v[12:15], 0
    ds_read_b64_tr_b16 v[12:13], v6 offset:1024
    ds_read_b64_tr_b16 v[14:15], v6 offset:1536
    v_max3_u32 v107, v107, v22, v23
    s_waitcnt lgkmcnt(10)
    v_mfma_f32_16x16x32_bf16 v[108:111], v[144:147], v[16:19], v[108:111]
    v_max3_u32 v107, v107, v24, v25
    v_mfma_f32_16x16x32_bf16 v[112:115], v[80:83], v[16:19], v[112:115]
    ds_read_b64_tr_b16 v[80:81], v2 offset:16384
    ds_read_b64_tr_b16 v[82:83], v2 offset:16896
    v_max3_u32 v107, v107, v26, v27
    v_mfma_f32_16x16x32_bf16 v[116:119], v[84:87], v[16:19], v[116:119]
    ds_read_b64_tr_b16 v[84:85], v3 offset:16384
    ds_read_b64_tr_b16 v[86:87], v3 offset:16896
    v_max3_u32 v107, v107, v28, v29
    v_mfma_f32_16x16x32_bf16 v[120:123], v[88:91], v[16:19], v[120:123]
    ds_read_b64_tr_b16 v[88:89], v4 offset:16384
    ds_read_b64_tr_b16 v[90:91], v4 offset:16896
    v_max3_u32 v107, v107, v30, v31
    v_cmp_lt_u32 vcc, s69, v107
    s_bitcmp1_b32 s16, 1
    s_cbranch_scc1 L_cr56b
    s_cbranch_vccnz L_cr56
L_cg55:
    s_waitcnt lgkmcnt(8)
    v_mfma_f32_16x16x32_bf16 v[108:111], v[92:95], v[20:23], v[108:111]
    ds_read_b64_tr_b16 v[92:93], v5 offset:16384
    ds_read_b64_tr_b16 v[94:95], v5 offset:16896
    v_mfma_f32_16x16x32_bf16 v[112:115], v[96:99], v[20:23], v[112:115]
    ds_read_b64_tr_b16 v[96:97], v2 offset:20480
    ds_read_b64_tr_b16 v[98:99], v2 offset:20992
    s_cmp_eq_u32 s35, 0
    s_cbranch_scc1 L_ql57
    buffer_load_dwordx4 v[68:71], v0, s[36:39], s77 offen offset:3072 sc1
    buffer_load_dwordx4 v[72:75], v0, s[36:39], s78 offen offset:0 sc1
    buffer_load_dwordx4 v[76:79], v0, s[36:39], s78 offen offset:1024 sc1
    buffer_load_dword v106, off, s[56:59], 0
L_ql57:
    v_mfma_f32_16x16x32_bf16 v[116:119], v[100:103], v[20:23], v[116:119]
    ds_read_b32 v104, v1
    ds_read_b64_tr_b16 v[100:101], v3 offset:20480
    ds_read_b64_tr_b16 v[102:103], v3 offset:20992
    v_mfma_f32_16x16x32_bf16 v[120:123], v[8:11], v[20:23], v[120:123]
    ds_read_b64_tr_b16 v[8:9], v4 offset:20480
    ds_read_b64_tr_b16 v[10:11], v4 offset:20992
    s_waitcnt lgkmcnt(13)
    v_mfma_f32_16x16x32_bf16 v[124:127], v[12:15], v[16:19], v[124:127]
    ds_read_b64_tr_b16 v[16:17], v5 offset:20480
    ds_read_b64_tr_b16 v[18:19], v5 offset:20992
    v_mfma_f32_16x16x32_bf16 v[128:131], v[12:15], v[20:23], v[128:131]
    ds_read_b64_tr_b16 v[12:13], v6 offset:2048
    ds_read_b64_tr_b16 v[14:15], v6 offset:2560
    s_cmp_lg_u32 s35, 0
    s_cbranch_scc1 L_qf
    s_mov_b64 exec, 1
    v_mov_b32 v7, s70
    s_waitcnt vmcnt(0)
    buffer_store_dword v7, off, s[36:39], s68 sc1
    s_mov_b64 exec, -1
L_qf:
    v_mfma_f32_16x16x32_bf16 v[108:111], v[80:83], v[24:27], v[108:111]
    s_waitcnt lgkmcnt(8)
    v_cmp_gt_u32 vcc, 2, v104
    s_and_b32 s79, vcc_lo, 0xf0000
    s_cbranch_scc1 L_gs58
L_gb59:
    ds_read_b64_tr_b16 v[20:21], v2 offset:24576
    ds_read_b64_tr_b16 v[22:23], v2 offset:25088
    v_mfma_f32_16x16x32_bf16 v[112:115], v[84:87], v[24:27], v[112:115]
    ds_read_b64_tr_b16 v[80:81], v3 offset:24576
    ds_read_b64_tr_b16 v[82:83], v3 offset:25088
    v_mfma_f32_16x16x32_bf16 v[116:119], v[88:91], v[24:27], v[116:119]
    ds_read_b64_tr_b16 v[84:85], v4 offset:24576
    ds_read_b64_tr_b16 v[86:87], v4 offset:25088
    v_mfma_f32_16x16x32_bf16 v[120:123], v[92:95], v[24:27], v[120:123]
    ds_read_b64_tr_b16 v[88:89], v5 offset:24576
    ds_read_b64_tr_b16 v[90:91], v5 offset:25088
    v_mfma_f32_16x16x32_bf16 v[108:111], v[96:99], v[28:31], v[108:111]
    ds_read_b64_tr_b16 v[92:93], v2 offset:28672
    ds_read_b64_tr_b16 v[94:95], v2 offset:29184
    s_waitcnt vmcnt(10)
    v_max_u32 v107, v32, v33
    s_waitcnt lgkmcnt(10)
    v_mfma_f32_16x16x32_bf16 v[112:115], v[100:103], v[28:31], v[112:115]
    ds_read_b64_tr_b16 v[96:97], v3 offset:28672
    ds_read_b64_tr_b16 v[98:99], v3 offset:29184
    v_max3_u32 v107, v107, v34, v35
    v_mfma_f32_16x16x32_bf16 v[116:119], v[8:11], v[28:31], v[116:119]
    ds_read_b64_tr_b16 v[100:101], v4 offset:28672
    ds_read_b64_tr_b16 v[102:103], v4 offset:29184
    v_max3_u32 v107, v107, v36, v37
    v_mfma_f32_16x16x32_bf16 v[120:123], v[16:19], v[28:31], v[120:123]
    ds_read_b64_tr_b16 v[8:9], v5 offset:28672
    ds_read_b64_tr_b16 v[10:11], v5 offset:29184
    v_max3_u32 v107, v107, v38, v39
    v_mfma_f32_16x16x32_bf16 v[124:127], v[12:15], v[24:27], v[124:127]
    ds_read_b64_tr_b16 v[16:17], v6 offset:3072
    ds_read_b64_tr_b16 v[18:19], v6 offset:3584
    v_max3_u32 v107, v107, v40, v41
    v_mfma_f32_16x16x32_bf16 v[128:131], v[12:15], v[28:31], v[128:131]
    ds_read_b32 v104, v1
    ds_read_b64_tr_b16 v[24:25], v2 offset:32768
    ds_read_b64_tr_b16 v[26:27], v2 offset:33280
    v_max3_u32 v107, v107, v42, v43
    v_cmp_lt_u32 vcc, s69, v107
    s_bitcmp1_b32 s16, 2
    s_cbranch_scc1 L_cr61b
    s_cbranch_vccnz L_cr61
L_cg60:
    s_waitcnt lgkmcnt(13)
    v_mfma_f32_16x16x32_bf16 v[108:111], v[20:23], v[32:35], v[108:111]
    ds_read_b64_tr_b16 v[12:13], v3 offset:32768
    ds_read_b64_tr_b16 v[14:15], v3 offset:33280
    v_mfma_f32_16x16x32_bf16 v[112:115], v[80:83], v[32:35], v[112:115]
    ds_read_b64_tr_b16 v[28:29], v4 offset:32768
    ds_read_b64_tr_b16 v[30:31], v4 offset:33280
    v_mfma_f32_16x16x32_bf16 v[116:119], v[84:87], v[32:35], v[116:119]
    ds_read_b64_tr_b16 v[20:21], v5 offset:32768
    ds_read_b64_tr_b16 v[22:23], v5 offset:33280
    v_mfma_f32_16x16x32_bf16 v[120:123], v[88:91], v[32:35], v[120:123]
    s_waitcnt lgkmcnt(8)
    v_cmp_gt_u32 vcc, s13, v104
    s_and_b32 s79, vcc_lo, 0xf0000
    s_cbranch_scc1 L_gs62
L_gb63:
    ds_read_b64_tr_b16 v[80:81], v2 offset:36864
    ds_read_b64_tr_b16 v[82:83], v2 offset:37376
    v_mfma_f32_16x16x32_bf16 v[108:111], v[92:95], v[36:39], v[108:111]
    ds_read_b64_tr_b16 v[84:85], v3 offset:36864
    ds_read_b64_tr_b16 v[86:87], v3 offset:37376
    v_mfma_f32_16x16x32_bf16 v[112:115], v[96:99], v[36:39], v[112:115]
    ds_read_b64_tr_b16 v[88:89], v4 offset:36864
    ds_read_b64_tr_b16 v[90:91], v4 offset:37376
    v_mfma_f32_16x16x32_bf16 v[116:119], v[100:103], v[36:39], v[116:119]
    ds_read_b64_tr_b16 v[92:93], v5 offset:36864
    ds_read_b64_tr_b16 v[94:95], v5 offset:37376
    v_mfma_f32_16x16x32_bf16 v[120:123], v[8:11], v[36:39], v[120:123]
    ds_read_b64_tr_b16 v[96:97], v6 offset:4096
    ds_read_b64_tr_b16 v[98:99], v6 offset:4608
    v_mfma_f32_16x16x32_bf16 v[124:127], v[16:19], v[32:35], v[124:127]
    ds_read_b64_tr_b16 v[100:101], v2 offset:40960
    ds_read_b64_tr_b16 v[102:103], v2 offset:41472
    s_waitcnt vmcnt(7)
    v_max_u32 v107, v44, v45
    v_mfma_f32_16x16x32_bf16 v[128:131], v[16:19], v[36:39], v[128:131]
    ds_read_b64_tr_b16 v[8:9], v3 offset:40960
    ds_read_b64_tr_b16 v[10:11], v3 offset:41472
    v_max3_u32 v107, v107, v46, v47
    s_waitcnt lgkmcnt(14)
    v_mfma_f32_16x16x32_bf16 v[108:111], v[24:27], v[40:43], v[108:111]
    ds_read_b64_tr_b16 v[32:33], v4 offset:40960
    ds_read_b64_tr_b16 v[34:35], v4 offset:41472
    v_max3_u32 v107, v107, v48, v49
    v_mfma_f32_16x16x32_bf16 v[112:115], v[12:15], v[40:43], v[112:115]
    ds_read_b64_tr_b16 v[16:17], v5 offset:40960
    ds_read_b64_tr_b16 v[18:19], v5 offset:41472
    v_max3_u32 v107, v107, v50, v51
    v_mfma_f32_16x16x32_bf16 v[116:119], v[28:31], v[40:43], v[116:119]
    ds_read_b64_tr_b16 v[36:37], v2 offset:45056
    ds_read_b64_tr_b16 v[38:39], v2 offset:45568
    v_max3_u32 v107, v107, v52, v53
    v_mfma_f32_16x16x32_bf16 v[120:123], v[20:23], v[40:43], v[120:123]
    ds_read_b32 v104, v1
    ds_read_b64_tr_b16 v[24:25], v3 offset:45056
    ds_read_b64_tr_b16 v[26:27], v3 offset:45568
    v_max3_u32 v107, v107, v54, v55
    v_cmp_lt_u32 vcc, s69, v107
    s_bitcmp1_b32 s16, 3
    s_cbranch_scc1 L_cr65b
    s_cbranch_vccnz L_cr65
L_cg64:
    s_waitcnt lgkmcnt(13)
    v_mfma_f32_16x16x32_bf16 v[108:111], v[80:83], v[44:47], v[108:111]
    ds_read_b64_tr_b16 v[12:13], v4 offset:45056
    ds_read_b64_tr_b16 v[14:15], v4 offset:45568
    v_mfma_f32_16x16x32_bf16 v[112:115], v[84:87], v[44:47], v[112:115]
    ds_read_b64_tr_b16 v[28:29], v5 offset:45056
    ds_read_b64_tr_b16 v[30:31], v5 offset:45568
    v_mfma_f32_16x16x32_bf16 v[116:119], v[88:91], v[44:47], v[116:119]
    ds_read_b64_tr_b16 v[20:21], v6 offset:5120
    ds_read_b64_tr_b16 v[22:23], v6 offset:5632
    v_mfma_f32_16x16x32_bf16 v[120:123], v[92:95], v[44:47], v[120:123]
    s_waitcnt lgkmcnt(8)
    v_cmp_gt_u32 vcc, 3, v104
    s_and_b32 s79, vcc_lo, 0xf0000
    s_cbranch_scc1 L_gs66
L_gb67:
    ds_read_b64_tr_b16 v[80:81], v2 offset:49152
    ds_read_b64_tr_b16 v[82:83], v2 offset:49664
    v_mfma_f32_16x16x32_bf16 v[124:127], v[96:99], v[40:43], v[124:127]
    ds_read_b64_tr_b16 v[84:85], v3 offset:49152
    ds_read_b64_tr_b16 v[86:87], v3 offset:49664
    v_mfma_f32_16x16x32_bf16 v[128:131], v[96:99], v[44:47], v[128:131]
    ds_read_b64_tr_b16 v[88:89], v4 offset:49152
    ds_read_b64_tr_b16 v[90:91], v4 offset:49664
    v_mfma_f32_16x16x32_bf16 v[108:111], v[100:103], v[48:51], v[108:111]
    ds_read_b64_tr_b16 v[92:93], v5 offset:49152
    ds_read_b64_tr_b16 v[94:95], v5 offset:49664
    v_mfma_f32_16x16x32_bf16 v[112:115], v[8:11], v[48:51], v[112:115]
    ds_read_b64_tr_b16 v[40:41], v2 offset:53248
    ds_read_b64_tr_b16 v[42:43], v2 offset:53760
    v_mfma_f32_16x16x32_bf16 v[116:119], v[32:35], v[48:51], v[116:119]
    ds_read_b64_tr_b16 v[96:97], v3 offset:53248
    ds_read_b64_tr_b16 v[98:99], v3 offset:53760
    v_mfma_f32_16x16x32_bf16 v[120:123], v[16:19], v[48:51], v[120:123]
    ds_read_b64_tr_b16 v[44:45], v4 offset:53248
    ds_read_b64_tr_b16 v[46:47], v4 offset:53760
    v_mfma_f32_16x16x32_bf16 v[108:111], v[36:39], v[52:55], v[108:111]
    ds_read_b64_tr_b16 v[100:101], v5 offset:53248
    ds_read_b64_tr_b16 v[102:103], v5 offset:53760
    s_waitcnt vmcnt(4)
    v_max_u32 v107, v56, v57
    s_waitcnt lgkmcnt(14)
    v_mfma_f32_16x16x32_bf16 v[112:115], v[24:27], v[52:55], v[112:115]
    ds_read_b64_tr_b16 v[8:9], v6 offset:6144
    ds_read_b64_tr_b16 v[10:11], v6 offset:6656
    v_max3_u32 v107, v107, v58, v59
    v_mfma_f32_16x16x32_bf16 v[116:119], v[12:15], v[52:55], v[116:119]
    ds_read_b64_tr_b16 v[32:33], v2 offset:57344
    ds_read_b64_tr_b16 v[34:35], v2 offset:57856
    v_max3_u32 v107, v107, v60, v61
    v_mfma_f32_16x16x32_bf16 v[120:123], v[28:31], v[52:55], v[120:123]
    ds_read_b64_tr_b16 v[16:17], v3 offset:57344
    ds_read_b64_tr_b16 v[18:19], v3 offset:57856
    v_max3_u32 v107, v107, v62, v63
    v_mfma_f32_16x16x32_bf16 v[124:127], v[20:23], v[48:51], v[124:127]
    ds_read_b64_tr_b16 v[36:37], v4 offset:57344
    ds_read_b64_tr_b16 v[38:39], v4 offset:57856
    v_max3_u32 v107, v107, v64, v65
    v_mfma_f32_16x16x32_bf16 v[128:131], v[20:23], v[52:55], v[128:131]
    ds_read_b64_tr_b16 v[24:25], v5 offset:57344
    ds_read_b64_tr_b16 v[26:27], v5 offset:57856
    v_max3_u32 v107, v107, v66, v67
    v_cmp_lt_u32 vcc, s69, v107
    s_bitcmp1_b32 s16, 4
    s_cbranch_scc1 L_cr69b
    s_cbranch_vccnz L_cr69
L_cg68:
    v_mfma_f32_16x16x32_bf16 v[108:111], v[80:83], v[56:59], v[108:111]
    ds_read_b64_tr_b16 v[12:13], v2 offset:61440
    ds_read_b64_tr_b16 v[14:15], v2 offset:61952
    s_waitcnt lgkmcnt(14)
    v_mfma_f32_16x16x32_bf16 v[112:115], v[84:87], v[56:59], v[112:115]
    ds_read_b64_tr_b16 v[28:29], v3 offset:61440
    ds_read_b64_tr_b16 v[30:31], v3 offset:61952
    v_mfma_f32_16x16x32_bf16 v[116:119], v[88:91], v[56:59], v[116:119]
    ds_read_b64_tr_b16 v[48:49], v4 offset:61440
    ds_read_b64_tr_b16 v[50:51], v4 offset:61952
    v_mfma_f32_16x16x32_bf16 v[120:123], v[92:95], v[56:59], v[120:123]
    ds_read_b64_tr_b16 v[20:21], v5 offset:61440
    ds_read_b64_tr_b16 v[22:23], v5 offset:61952
    v_mfma_f32_16x16x32_bf16 v[108:111], v[40:43], v[60:63], v[108:111]
    ds_read_b64_tr_b16 v[52:53], v6 offset:7168
    ds_read_b64_tr_b16 v[54:55], v6 offset:7680
    v_mfma_f32_16x16x32_bf16 v[112:115], v[96:99], v[60:63], v[112:115]
    v_add_u32 v2, 8192, v2
    v_add_u32 v3, 8192, v3
    v_add_u32 v4, 8192, v4
    v_add_u32 v5, 8192, v5
    ds_read_b64_tr_b16 v[80:81], v2 offset:57344
    ds_read_b64_tr_b16 v[82:83], v2 offset:57856
    v_mfma_f32_16x16x32_bf16 v[116:119], v[44:47], v[60:63], v[116:119]
    ds_read_b64_tr_b16 v[84:85], v3 offset:57344
    ds_read_b64_tr_b16 v[86:87], v3 offset:57856
    s_waitcnt lgkmcnt(14)
    v_mfma_f32_16x16x32_bf16 v[120:123], v[100:103], v[60:63], v[120:123]
    ds_read_b64_tr_b16 v[88:89], v4 offset:57344
    ds_read_b64_tr_b16 v[90:91], v4 offset:57856
    v_mfma_f32_16x16x32_bf16 v[124:127], v[8:11], v[56:59], v[124:127]
    ds_read_b64_tr_b16 v[92:93], v5 offset:57344
    ds_read_b64_tr_b16 v[94:95], v5 offset:57856
    s_waitcnt vmcnt(1)
    v_max_u32 v107, v68, v69
    v_mfma_f32_16x16x32_bf16 v[128:131], v[8:11], v[60:63], v[128:131]
    ds_read_b64_tr_b16 v[40:41], v2 offset:61440
    ds_read_b64_tr_b16 v[42:43], v2 offset:61952
    v_max3_u32 v107, v107, v70, v71
    v_mfma_f32_16x16x32_bf16 v[108:111], v[32:35], v[64:67], v[108:111]
    ds_read_b64_tr_b16 v[96:97], v3 offset:61440
    ds_read_b64_tr_b16 v[98:99], v3 offset:61952
    v_max3_u32 v107, v107, v72, v73
    v_mfma_f32_16x16x32_bf16 v[112:115], v[16:19], v[64:67], v[112:115]
    ds_read_b64_tr_b16 v[44:45], v4 offset:61440
    ds_read_b64_tr_b16 v[46:47], v4 offset:61952
    v_max3_u32 v107, v107, v74, v75
    v_mfma_f32_16x16x32_bf16 v[116:119], v[36:39], v[64:67], v[116:119]
    ds_read_b64_tr_b16 v[100:101], v5 offset:61440
    ds_read_b64_tr_b16 v[102:103], v5 offset:61952
    v_max3_u32 v107, v107, v76, v77
    v_mfma_f32_16x16x32_bf16 v[120:123], v[24:27], v[64:67], v[120:123]
    ds_read_b64_tr_b16 v[56:57], v6 offset:8192
    ds_read_b64_tr_b16 v[58:59], v6 offset:8704
    v_max3_u32 v107, v107, v78, v79
    ds_read_b32 v104, v1
    v_cmp_lt_u32 vcc, s69, v107
    s_bitcmp1_b32 s16, 5
    s_cbranch_scc1 L_cr71b
    s_cbranch_vccnz L_cr71
L_cg70:
    s_waitcnt lgkmcnt(14)
    v_mfma_f32_16x16x32_bf16 v[108:111], v[12:15], v[68:71], v[108:111]
    v_lshrrev_b32 v26, 8, v0
    v_lshlrev_b32 v24, 4, v26
    v_mfma_f32_16x16x32_bf16 v[112:115], v[28:31], v[68:71], v[112:115]
    v_add_u32 v24, 158976, v24
    s_lshl_b32 s15, s6, 8
    s_add_u32 s15, s15, 159488
    v_mfma_f32_16x16x32_bf16 v[116:119], v[48:51], v[68:71], v[116:119]
    v_and_b32 v27, 0xf0, v0
    v_add_u32 v25, s15, v27
    v_mfma_f32_16x16x32_bf16 v[120:123], v[20:23], v[68:71], v[120:123]
    s_mul_i32 s15, s6, 3072
    s_add_u32 s15, s15, 57344
    s_add_u32 s15, s15, s28
    v_mul_u32_u24 v27, 10, v27
    v_mfma_f32_16x16x32_bf16 v[124:127], v[52:55], v[64:67], v[124:127]
    v_lshl_add_u32 v26, v26, 3, v27
    v_add_u32 v26, s15, v26
    v_mfma_f32_16x16x32_bf16 v[128:131], v[52:55], v[68:71], v[128:131]
    s_waitcnt lgkmcnt(0)
    v_cmp_gt_u32 vcc, 2, v104
    s_and_b32 s79, vcc_hi, s14
    s_cbranch_scc1 L_qts
L_qtb:
    ds_read_b128 v[68:71], v24 offset:0
    ds_read_b128 v[52:55], v24 offset:64
    ds_read_b128 v[64:67], v24 offset:128
    ds_read_b128 v[20:23], v24 offset:192
    ds_read_b128 v[48:51], v24 offset:256
    ds_read_b64 v[24:25], v25
    v_mfma_f32_16x16x32_bf16 v[108:111], v[80:83], v[72:75], v[108:111]
    v_mfma_f32_16x16x32_bf16 v[112:115], v[84:87], v[72:75], v[112:115]
    v_mfma_f32_16x16x32_bf16 v[116:119], v[88:91], v[72:75], v[116:119]
    v_mfma_f32_16x16x32_bf16 v[120:123], v[92:95], v[72:75], v[120:123]
    s_waitcnt lgkmcnt(0)
    v_mul_f32 v24, v24, v25
    v_mfma_f32_16x16x32_bf16 v[108:111], v[40:43], v[76:79], v[108:111]
    v_pk_mul_f32 v[68:69], v[68:69], v[24:25] op_sel_hi:[1,0]
    v_pk_mul_f32 v[70:71], v[70:71], v[24:25] op_sel_hi:[1,0]
    v_mfma_f32_16x16x32_bf16 v[112:115], v[96:99], v[76:79], v[112:115]
    v_pk_mul_f32 v[52:53], v[52:53], v[24:25] op_sel_hi:[1,0]
    v_pk_mul_f32 v[54:55], v[54:55], v[24:25] op_sel_hi:[1,0]
    v_mfma_f32_16x16x32_bf16 v[116:119], v[44:47], v[76:79], v[116:119]
    v_pk_mul_f32 v[64:65], v[64:65], v[24:25] op_sel_hi:[1,0]
    v_pk_mul_f32 v[66:67], v[66:67], v[24:25] op_sel_hi:[1,0]
    v_mfma_f32_16x16x32_bf16 v[120:123], v[100:103], v[76:79], v[120:123]
    v_pk_mul_f32 v[20:21], v[20:21], v[24:25] op_sel_hi:[1,0]
    v_pk_mul_f32 v[22:23], v[22:23], v[24:25] op_sel_hi:[1,0]
    v_mfma_f32_16x16x32_bf16 v[124:127], v[56:59], v[72:75], v[124:127]
    v_pk_mul_f32 v[48:49], v[48:49], v[24:25] op_sel_hi:[1,0]
    v_pk_mul_f32 v[50:51], v[50:51], v[24:25] op_sel_hi:[1,0]
    v_mfma_f32_16x16x32_bf16 v[128:131], v[56:59], v[76:79], v[128:131]
    v_pk_fma_f32 v[108:109], v[108:109], v[24:25], v[68:69] op_sel:[0,1,0] neg_lo:[0,0,1] neg_hi:[0,0,1]
    v_pk_fma_f32 v[110:111], v[110:111], v[24:25], v[70:71] op_sel:[0,1,0] neg_lo:[0,0,1] neg_hi:[0,0,1]
    v_cvt_pk_bf16_f32 v68, v108, v109
    v_cvt_pk_bf16_f32 v69, v110, v111
    ds_write_b64 v26, v[68:69] offset:0
    v_pk_fma_f32 v[112:113], v[112:113], v[24:25], v[52:53] op_sel:[0,1,0] neg_lo:[0,0,1] neg_hi:[0,0,1]
    v_pk_fma_f32 v[114:115], v[114:115], v[24:25], v[54:55] op_sel:[0,1,0] neg_lo:[0,0,1] neg_hi:[0,0,1]
    v_cvt_pk_bf16_f32 v52, v112, v113
    v_cvt_pk_bf16_f32 v53, v114, v115
    ds_write_b64 v26, v[52:53] offset:32
    v_pk_fma_f32 v[116:117], v[116:117], v[24:25], v[64:65] op_sel:[0,1,0] neg_lo:[0,0,1] neg_hi:[0,0,1]
    v_pk_fma_f32 v[118:119], v[118:119], v[24:25], v[66:67] op_sel:[0,1,0] neg_lo:[0,0,1] neg_hi:[0,0,1]
    v_cvt_pk_bf16_f32 v64, v116, v117
    v_cvt_pk_bf16_f32 v65, v118, v119
    ds_write_b64 v26, v[64:65] offset:64
    v_pk_fma_f32 v[120:121], v[120:121], v[24:25], v[20:21] op_sel:[0,1,0] neg_lo:[0,0,1] neg_hi:[0,0,1]
    v_pk_fma_f32 v[122:123], v[122:123], v[24:25], v[22:23] op_sel:[0,1,0] neg_lo:[0,0,1] neg_hi:[0,0,1]
    v_cvt_pk_bf16_f32 v20, v120, v121
    v_cvt_pk_bf16_f32 v21, v122, v123
    ds_write_b64 v26, v[20:21] offset:96
    v_permlane32_swap_b32 v128, v108
    v_permlane32_swap_b32 v129, v109
    v_permlane32_swap_b32 v130, v110
    v_permlane32_swap_b32 v131, v111
    v_pk_add_f32 v[124:125], v[124:125], v[108:109]
    v_pk_add_f32 v[126:127], v[126:127], v[110:111]
    v_pk_fma_f32 v[124:125], v[124:125], v[24:25], v[48:49] op_sel:[0,1,0] neg_lo:[0,0,1] neg_hi:[0,0,1]
    v_pk_fma_f32 v[126:127], v[126:127], v[24:25], v[50:51] op_sel:[0,1,0] neg_lo:[0,0,1] neg_hi:[0,0,1]
    v_cvt_pk_bf16_f32 v48, v124, v125
    v_cvt_pk_bf16_f32 v49, v126, v127
    ds_write_b64 v26, v[48:49] offset:128
    s_add_u32 s79, s6, 28
    s_lshl_b64 exec, 1, s79
    v_mov_b32 v7, s17
    ds_write_b32 v1, v7
    s_mov_b64 exec, -1
    s_cmp_lg_u32 s35, 0
    s_cbranch_scc1 L_qp
    s_mul_i32 s15, s6, 9216
    v_add_u32 v7, s15, v0
    ds_read_b128 v[132:135], v7 offset:36864
    ds_read_b128 v[136:139], v7 offset:37888
    ds_read_b128 v[140:143], v7 offset:38912
    ds_read_b128 v[144:147], v7 offset:39936
    ds_read_b128 v[148:151], v7 offset:40960
    ds_read_b128 v[152:155], v7 offset:41984
    ds_read_b128 v[156:159], v7 offset:43008
    ds_read_b128 v[160:163], v7 offset:44032
    ds_read_b128 v[164:167], v7 offset:45056
L_qp:
    s_branch L_att
L_B_post:
    s_cmp_lg_u32 s35, 0
    s_cbranch_scc1 L_B_end
    s_setprio 0
    s_mul_i32 s15, s6, 9216
    s_add_u32 s15, s15, 82944
    v_add_u32 v105, s15, v0
L_w72:
    ds_read_b32 v5, v1
    s_waitcnt lgkmcnt(0)
    v_cmp_gt_u32 vcc, 11, v5
    s_and_b32 s79, vcc_lo, 0x800000
    s_cbranch_scc0 L_wd73
    s_sub_i32 s34, s34, 1
    s_cmp_gt_i32 s34, 0
    s_cbranch_scc1 L_w72
L_wd73:
    s_mov_b32 s35, 1
    s_mov_b32 s28, 0
    s_mov_b32 s29, 82944
    s_mov_b32 s17, 17
    s_mov_b32 s13, 4
    s_lshl_b32 s14, 1048576, s6
    s_or_b32 s14, s14, 15360
    s_add_u32 s74, s66, 147456
    s_lshl_b32 s16, 1024, s6
    s_add_u32 s75, s74, 4096
    s_add_u32 s76, s74, 8192
    s_add_u32 s77, s74, 12288
    s_add_u32 s78, s74, 16384
    s_branch L_B_q
L_B_end:
    s_lshl_b32 s74, s6, 3
    s_or_b32 s74, s74, s2
    s_cmp_ge_u32 s74, 8
    s_cbranch_scc1 L_end
    s_setprio 0
L_w74:
    ds_read_b32 v7, v1
    s_waitcnt lgkmcnt(0)
    v_cmp_gt_u32 vcc, 3, v7
    s_and_b32 s79, vcc_hi, 0x3c00
    s_cbranch_scc0 L_wd75
    s_sleep 4
    s_sub_i32 s34, s34, 17
    s_cmp_gt_i32 s34, 0
    s_cbranch_scc1 L_w74
L_wd75:
    buffer_wbl2 sc1
    s_waitcnt vmcnt(0)
    s_branch L_end
L_H_start:
    s_setprio 3
    s_lshr_b32 s66, s2, 6
    s_and_b32 s74, s2, 7
    s_lshl3_add_u32 s66, s66, s74
    s_cmp_eq_u32 s6, 2
    s_cbranch_scc1 L_H2s
    s_cmp_eq_u32 s6, 1
    s_cbranch_scc1 L_H1s
    v_lshrrev_b32 v2, 4, v0
    v_subrev_u32 v2, 42, v2
    v_cmp_gt_u32 vcc, 4, v2
    s_nop 1
    v_cndmask_b32 v2, 0, 1, vcc
    v_add_u32 v3, 159488, v0
    v_mov_b32 v4, 1.0
    v_mov_b32 v5, 0
    s_cmp_eq_u32 s6, 0
    s_cbranch_scc1 L_H0s
    ds_write_b32 v1, v2
    ds_write_b64 v3, v[4:5] offset:8
L_H0s:
    s_waitcnt lgkmcnt(0)
    s_mov_b64 s[36:37], s[32:33]
    s_mov_b64 s[40:41], s[8:9]
    s_mov_b64 s[44:45], s[10:11]
    s_mov_b64 s[48:49], s[16:17]
    s_mov_b64 s[52:53], s[28:29]
    s_mov_b64 s[56:57], s[20:21]
    s_mov_b64 s[60:61], s[26:27]
    s_mov_b64 s[20:21], s[22:23]
    s_mov_b32 s22, 5308416
    s_mov_b32 s23, s39
    s_mov_b32 s26, 5308416
    s_mov_b32 s27, s39
    s_mov_b32 s28, 82944
    s_mov_b32 s29, 0
    s_barrier
    s_branch L_H_cs
L_H1s:
    v_bfe_u32 v2, v0, 4, 1
    v_bfe_u32 v3, v0, 7, 2
    v_lshl_add_u32 v2, v2, 2, v3
    v_bfe_u32 v3, v0, 9, 1
    v_lshl_add_u32 v2, v2, 1, v3
    v_bfe_u32 v3, v0, 5, 2
    v_lshl_add_u32 v2, v2, 2, v3
    s_and_b32 s78, s5, 1
    s_lshl_b32 s78, s78, 4
    s_cmp_ge_u32 s5, 4
    s_cselect_b32 s78, 20, s78
    v_mul_u32_u24 v2, 36, v2
    v_add_u32 v2, s78, v2
    v_add_u32 v3, 2304, v2
    v_add_u32 v4, 4608, v2
    v_add_u32 v5, 6912, v2
    v_add_u32 v6, 9216, v2
    v_add_u32 v7, 11520, v2
    v_add_u32 v8, 13824, v2
    v_add_u32 v9, 16128, v2
    v_add_u32 v10, 18432, v2
    s_lshr_b32 s78, 0x2c, s5
    s_mov_b32 m0, 64512
    s_bitcmp1_b32 s78, 0
    s_waitcnt lgkmcnt(0)
    s_cselect_b64 s[76:77], s[14:15], s[12:13]
    global_load_lds_dwordx4 v2, s[76:77]
    s_mov_b32 m0, 65536
    s_nop 0
    global_load_lds_dwordx4 v3, s[76:77]
    s_mov_b32 m0, 66560
    s_nop 0
    global_load_lds_dwordx4 v4, s[76:77]
    s_mov_b32 m0, 67584
    s_nop 0
    global_load_lds_dwordx4 v5, s[76:77]
    s_mov_b32 m0, 68608
    s_nop 0
    global_load_lds_dwordx4 v6, s[76:77]
    s_mov_b32 m0, 69632
    s_nop 0
    global_load_lds_dwordx4 v7, s[76:77]
    s_mov_b32 m0, 70656
    s_nop 0
    global_load_lds_dwordx4 v8, s[76:77]
    s_mov_b32 m0, 71680
    s_nop 0
    global_load_lds_dwordx4 v9, s[76:77]
    s_mov_b32 m0, 72704
    s_nop 0
    global_load_lds_dwordx4 v10, s[76:77]
    s_waitcnt lgkmcnt(0)
    s_mov_b64 s[36:37], s[32:33]
    s_mov_b64 s[40:41], s[8:9]
    s_mov_b64 s[44:45], s[10:11]
    s_mov_b64 s[48:49], s[16:17]
    s_mov_b64 s[52:53], s[28:29]
    s_mov_b64 s[56:57], s[20:21]
    s_mov_b64 s[60:61], s[26:27]
    s_mov_b64 s[20:21], s[22:23]
    s_mov_b32 s22, 5308416
    s_mov_b32 s23, s39
    s_mov_b32 s26, 5308416
    s_mov_b32 s27, s39
    s_mov_b32 s28, 82944
    s_mov_b32 s29, 0
    s_waitcnt vmcnt(0)
    s_barrier
    s_lshl_b64 exec, 1, 20
    v_mov_b32 v5, 1
    ds_write_b32 v1, v5
    s_mov_b64 exec, -1
    s_cmp_lg_u32 s66, 31
    s_cbranch_scc1 L_H1e
    v_lshrrev_b32 v2, 1, v0
    v_add_u32 v2, 64512, v2
    v_mov_b32 v8, 0x3f803f80
    v_mov_b32 v9, 0x3f803f80
    v_mov_b32 v10, 0x3f803f80
    v_mov_b32 v11, 0x3f803f80
    ds_read_b64_tr_b16 v[60:61], v2 offset:0
    ds_read_b64_tr_b16 v[62:63], v2 offset:512
    ds_read_b64_tr_b16 v[64:65], v2 offset:1024
    ds_read_b64_tr_b16 v[66:67], v2 offset:1536
    ds_read_b64_tr_b16 v[68:69], v2 offset:2048
    ds_read_b64_tr_b16 v[70:71], v2 offset:2560
    ds_read_b64_tr_b16 v[72:73], v2 offset:3072
    ds_read_b64_tr_b16 v[74:75], v2 offset:3584
    ds_read_b64_tr_b16 v[76:77], v2 offset:4096
    ds_read_b64_tr_b16 v[78:79], v2 offset:4608
    ds_read_b64_tr_b16 v[80:81], v2 offset:5120
    ds_read_b64_tr_b16 v[82:83], v2 offset:5632
    ds_read_b64_tr_b16 v[84:85], v2 offset:6144
    ds_read_b64_tr_b16 v[86:87], v2 offset:6656
    ds_read_b64_tr_b16 v[88:89], v2 offset:7168
    ds_read_b64_tr_b16 v[90:91], v2 offset:7680
    ds_read_b64_tr_b16 v[92:93], v2 offset:8192
    ds_read_b64_tr_b16 v[94:95], v2 offset:8704
    s_waitcnt lgkmcnt(0)
    v_mfma_f32_16x16x32_bf16 v[56:59], v[60:63], v[8:11], 0
    v_mfma_f32_16x16x32_bf16 v[56:59], v[64:67], v[8:11], v[56:59]
    v_mfma_f32_16x16x32_bf16 v[56:59], v[68:71], v[8:11], v[56:59]
    v_mfma_f32_16x16x32_bf16 v[56:59], v[72:75], v[8:11], v[56:59]
    v_mfma_f32_16x16x32_bf16 v[56:59], v[76:79], v[8:11], v[56:59]
    v_mfma_f32_16x16x32_bf16 v[56:59], v[80:83], v[8:11], v[56:59]
    v_mfma_f32_16x16x32_bf16 v[56:59], v[84:87], v[8:11], v[56:59]
    v_mfma_f32_16x16x32_bf16 v[56:59], v[88:91], v[8:11], v[56:59]
    v_mfma_f32_16x16x32_bf16 v[56:59], v[92:95], v[8:11], v[56:59]
    s_nop 7
    v_mov_b32 v12, v56
    v_mov_b32 v13, v57
    v_mov_b32 v14, v58
    v_mov_b32 v15, v59
    v_permlane32_swap_b32 v56, v12
    v_permlane32_swap_b32 v57, v13
    v_permlane32_swap_b32 v58, v14
    v_permlane32_swap_b32 v59, v15
    v_add_f32 v56, v56, v12
    v_add_f32 v57, v57, v13
    v_add_f32 v58, v58, v14
    v_add_f32 v59, v59, v15
L_H1e:
    s_lshl_b64 exec, 1, 60
    v_mov_b32 v5, 1
    ds_write_b32 v1, v5
    s_mov_b64 exec, -1
    s_branch L_H_cs
L_H2s:
    s_lshr_b32 s74, s2, 3
    s_mul_i32 s76, s74, 768
    s_mul_i32 s74, s74, 20736
    v_lshlrev_b32 v2, 3, v0
    v_add_u32 v3, s76, v2
    v_min_u32 v3, 20732, v3
    s_lshl_b32 s75, s4, 3
    s_add_u32 s75, s75, s5
    s_mul_i32 s75, s75, 9216
    s_add_u32 s76, s75, 4608
    s_mov_b32 exec_hi, 0xf
    s_waitcnt lgkmcnt(0)
    s_mov_b64 s[40:41], s[8:9]
    s_mov_b64 s[44:45], s[10:11]
    buffer_load_dword v7, v2, s[40:43], s75 offen
    buffer_load_dword v8, v2, s[40:43], s76 offen
    s_mov_b64 exec, 0x3f
    global_load_dword v9, v3, s[12:13]
    global_load_dword v10, v3, s[14:15]
    s_mov_b32 exec_lo, -1
    s_mov_b32 exec_hi, 0x3fffff
    buffer_load_dword v4, v2, s[44:47], s74 offen
    s_add_u32 s74, s74, 6912
    buffer_load_dword v5, v2, s[44:47], s74 offen
    s_add_u32 s74, s74, 6912
    buffer_load_dword v6, v2, s[44:47], s74 offen
    s_add_u32 s74, s74, 6912
    s_mov_b64 exec, -1
    s_barrier
    s_mov_b64 s[36:37], s[32:33]
    s_mov_b64 s[48:49], s[16:17]
    s_mov_b64 s[52:53], s[28:29]
    s_mov_b64 s[56:57], s[20:21]
    s_mov_b64 s[60:61], s[26:27]
    s_mov_b64 s[20:21], s[22:23]
    s_mov_b32 s22, 5308416
    s_mov_b32 s23, s39
    s_mov_b32 s26, 5308416
    s_mov_b32 s27, s39
    s_mov_b32 s28, 82944
    s_mov_b32 s29, 0
    v_lshrrev_b32 v2, 1, v0
    v_add_u32 v2, 64512, v2
L_w76:
    ds_read_b32 v3, v1
    s_waitcnt lgkmcnt(0)
    v_cmp_gt_u32 vcc, 1, v3
    s_and_b32 s79, vcc_lo, 0x100000
    s_cbranch_scc0 L_wd77
    s_sub_i32 s34, s34, 1
    s_cmp_gt_i32 s34, 0
    s_cbranch_scc1 L_w76
L_wd77:
    ds_read_b64_tr_b16 v[132:133], v2 offset:0
    ds_read_b64_tr_b16 v[134:135], v2 offset:512
    ds_read_b64_tr_b16 v[136:137], v2 offset:1024
    ds_read_b64_tr_b16 v[138:139], v2 offset:1536
    ds_read_b64_tr_b16 v[140:141], v2 offset:2048
    ds_read_b64_tr_b16 v[142:143], v2 offset:2560
    ds_read_b64_tr_b16 v[144:145], v2 offset:3072
    ds_read_b64_tr_b16 v[146:147], v2 offset:3584
    ds_read_b64_tr_b16 v[148:149], v2 offset:4096
    ds_read_b64_tr_b16 v[150:151], v2 offset:4608
    ds_read_b64_tr_b16 v[152:153], v2 offset:5120
    ds_read_b64_tr_b16 v[154:155], v2 offset:5632
    ds_read_b64_tr_b16 v[156:157], v2 offset:6144
    ds_read_b64_tr_b16 v[158:159], v2 offset:6656
    ds_read_b64_tr_b16 v[160:161], v2 offset:7168
    ds_read_b64_tr_b16 v[162:163], v2 offset:7680
    ds_read_b64_tr_b16 v[164:165], v2 offset:8192
    ds_read_b64_tr_b16 v[166:167], v2 offset:8704
    s_lshl_b64 exec, 1, 61
    v_mov_b32 v3, 1
    ds_write_b32 v1, v3
    s_mov_b64 exec, -1
    s_waitcnt vmcnt(5)
    s_waitcnt vmcnt(0)
    s_branch L_H_cs
L_H_cs:
    v_and_b32 v2, 0x300, v0
    v_lshlrev_b32 v2, 2, v2
    v_and_b32 v5, 0xc0, v0
    v_lshl_add_u32 v2, v5, 1, v2
    v_bfe_u32 v5, v0, 4, 2
    v_lshl_add_u32 v2, v5, 3, v2
    v_lshrrev_b32 v5, 2, v0
    v_and_b32 v5, 0x60, v5
    v_add_u32 v2, v2, v5
    s_lshl_b32 s74, s6, 5
    v_xor_b32 v2, s74, v2
    v_lshrrev_b32 v3, 1, v0
    v_add_u32 v3, 73728, v3
    v_mov_b32 v8, 0x3f803f80
    v_mov_b32 v9, 0x3f803f80
    v_mov_b32 v10, 0x3f803f80
    v_mov_b32 v11, 0x3f803f80
L_w78:
    ds_read_b32 v5, v1
    s_waitcnt lgkmcnt(0)
    v_cmp_gt_u32 vcc, 1, v5
    s_and_b32 s79, vcc_lo, 0xf0000
    s_cbranch_scc0 L_wd79
    s_sub_i32 s34, s34, 1
    s_cmp_gt_i32 s34, 0
    s_cbranch_scc1 L_w78
L_wd79:
    ds_read_b64_tr_b16 v[16:17], v2 offset:0
    ds_read_b64_tr_b16 v[18:19], v2 offset:512
    ds_read_b64_tr_b16 v[20:21], v2 offset:4096
    ds_read_b64_tr_b16 v[22:23], v2 offset:4608
    ds_read_b64_tr_b16 v[24:25], v2 offset:8192
    ds_read_b64_tr_b16 v[26:27], v2 offset:8704
    ds_read_b64_tr_b16 v[28:29], v2 offset:12288
    ds_read_b64_tr_b16 v[30:31], v2 offset:12800
    ds_read_b64_tr_b16 v[32:33], v2 offset:16384
    ds_read_b64_tr_b16 v[34:35], v2 offset:16896
    ds_read_b64_tr_b16 v[36:37], v2 offset:20480
    ds_read_b64_tr_b16 v[38:39], v2 offset:20992
    v_add_u32 v2, 24576, v2
    s_waitcnt lgkmcnt(10)
    v_mfma_f32_16x16x32_bf16 v[12:15], v[16:19], v[8:11], 0
    s_waitcnt lgkmcnt(8)
    v_mfma_f32_16x16x32_bf16 v[12:15], v[20:23], v[8:11], v[12:15]
    s_waitcnt lgkmcnt(6)
    v_mfma_f32_16x16x32_bf16 v[12:15], v[24:27], v[8:11], v[12:15]
    s_waitcnt lgkmcnt(4)
    v_mfma_f32_16x16x32_bf16 v[12:15], v[28:31], v[8:11], v[12:15]
    s_waitcnt lgkmcnt(2)
    v_mfma_f32_16x16x32_bf16 v[12:15], v[32:35], v[8:11], v[12:15]
    s_waitcnt lgkmcnt(0)
    v_mfma_f32_16x16x32_bf16 v[12:15], v[36:39], v[8:11], v[12:15]
    s_cmp_lg_u32 s6, 3
    s_cbranch_scc1 L_H_c0
    ds_read_b64_tr_b16 v[60:61], v3 offset:0
    ds_read_b64_tr_b16 v[62:63], v3 offset:512
    ds_read_b64_tr_b16 v[64:65], v3 offset:1024
    ds_read_b64_tr_b16 v[66:67], v3 offset:1536
    ds_read_b64_tr_b16 v[68:69], v3 offset:2048
    ds_read_b64_tr_b16 v[70:71], v3 offset:2560
    s_waitcnt lgkmcnt(0)
    v_mfma_f32_16x16x32_bf16 v[56:59], v[60:63], v[8:11], 0
    v_mfma_f32_16x16x32_bf16 v[56:59], v[64:67], v[8:11], v[56:59]
    v_mfma_f32_16x16x32_bf16 v[56:59], v[68:71], v[8:11], v[56:59]
L_H_c0:
L_w80:
    ds_read_b32 v5, v1
    s_waitcnt lgkmcnt(0)
    v_cmp_gt_u32 vcc, 2, v5
    s_and_b32 s79, vcc_lo, 0xf0000
    s_cbranch_scc0 L_wd81
    s_sub_i32 s34, s34, 1
    s_cmp_gt_i32 s34, 0
    s_cbranch_scc1 L_w80
L_wd81:
    ds_read_b64_tr_b16 v[16:17], v2 offset:0
    ds_read_b64_tr_b16 v[18:19], v2 offset:512
    ds_read_b64_tr_b16 v[20:21], v2 offset:4096
    ds_read_b64_tr_b16 v[22:23], v2 offset:4608
    ds_read_b64_tr_b16 v[24:25], v2 offset:8192
    ds_read_b64_tr_b16 v[26:27], v2 offset:8704
    ds_read_b64_tr_b16 v[28:29], v2 offset:12288
    ds_read_b64_tr_b16 v[30:31], v2 offset:12800
    ds_read_b64_tr_b16 v[32:33], v2 offset:16384
    ds_read_b64_tr_b16 v[34:35], v2 offset:16896
    ds_read_b64_tr_b16 v[36:37], v2 offset:20480
    ds_read_b64_tr_b16 v[38:39], v2 offset:20992
    v_add_u32 v2, 24576, v2
    s_waitcnt lgkmcnt(10)
    v_mfma_f32_16x16x32_bf16 v[12:15], v[16:19], v[8:11], v[12:15]
    s_waitcnt lgkmcnt(8)
    v_mfma_f32_16x16x32_bf16 v[12:15], v[20:23], v[8:11], v[12:15]
    s_waitcnt lgkmcnt(6)
    v_mfma_f32_16x16x32_bf16 v[12:15], v[24:27], v[8:11], v[12:15]
    s_waitcnt lgkmcnt(4)
    v_mfma_f32_16x16x32_bf16 v[12:15], v[28:31], v[8:11], v[12:15]
    s_waitcnt lgkmcnt(2)
    v_mfma_f32_16x16x32_bf16 v[12:15], v[32:35], v[8:11], v[12:15]
    s_waitcnt lgkmcnt(0)
    v_mfma_f32_16x16x32_bf16 v[12:15], v[36:39], v[8:11], v[12:15]
    s_cmp_lg_u32 s6, 3
    s_cbranch_scc1 L_H_c1
    ds_read_b64_tr_b16 v[72:73], v3 offset:3072
    ds_read_b64_tr_b16 v[74:75], v3 offset:3584
    ds_read_b64_tr_b16 v[76:77], v3 offset:4096
    ds_read_b64_tr_b16 v[78:79], v3 offset:4608
    ds_read_b64_tr_b16 v[80:81], v3 offset:5120
    ds_read_b64_tr_b16 v[82:83], v3 offset:5632
    s_waitcnt lgkmcnt(0)
    v_mfma_f32_16x16x32_bf16 v[56:59], v[72:75], v[8:11], v[56:59]
    v_mfma_f32_16x16x32_bf16 v[56:59], v[76:79], v[8:11], v[56:59]
    v_mfma_f32_16x16x32_bf16 v[56:59], v[80:83], v[8:11], v[56:59]
L_H_c1:
L_w82:
    ds_read_b32 v5, v1
    s_waitcnt lgkmcnt(0)
    v_cmp_gt_u32 vcc, 3, v5
    s_and_b32 s79, vcc_lo, 0xf0000
    s_cbranch_scc0 L_wd83
    s_sub_i32 s34, s34, 1
    s_cmp_gt_i32 s34, 0
    s_cbranch_scc1 L_w82
L_wd83:
    ds_read_b64_tr_b16 v[16:17], v2 offset:0
    ds_read_b64_tr_b16 v[18:19], v2 offset:512
    ds_read_b64_tr_b16 v[20:21], v2 offset:4096
    ds_read_b64_tr_b16 v[22:23], v2 offset:4608
    ds_read_b64_tr_b16 v[24:25], v2 offset:8192
    ds_read_b64_tr_b16 v[26:27], v2 offset:8704
    ds_read_b64_tr_b16 v[28:29], v2 offset:12288
    ds_read_b64_tr_b16 v[30:31], v2 offset:12800
    ds_read_b64_tr_b16 v[32:33], v2 offset:16384
    ds_read_b64_tr_b16 v[34:35], v2 offset:16896
    ds_read_b64_tr_b16 v[36:37], v2 offset:20480
    ds_read_b64_tr_b16 v[38:39], v2 offset:20992
    v_add_u32 v2, 24576, v2
    s_waitcnt lgkmcnt(10)
    v_mfma_f32_16x16x32_bf16 v[12:15], v[16:19], v[8:11], v[12:15]
    s_waitcnt lgkmcnt(8)
    v_mfma_f32_16x16x32_bf16 v[12:15], v[20:23], v[8:11], v[12:15]
    s_waitcnt lgkmcnt(6)
    v_mfma_f32_16x16x32_bf16 v[12:15], v[24:27], v[8:11], v[12:15]
    s_waitcnt lgkmcnt(4)
    v_mfma_f32_16x16x32_bf16 v[12:15], v[28:31], v[8:11], v[12:15]
    s_waitcnt lgkmcnt(2)
    v_mfma_f32_16x16x32_bf16 v[12:15], v[32:35], v[8:11], v[12:15]
    s_waitcnt lgkmcnt(0)
    v_mfma_f32_16x16x32_bf16 v[12:15], v[36:39], v[8:11], v[12:15]
    s_cmp_lg_u32 s6, 3
    s_cbranch_scc1 L_H_c2
    ds_read_b64_tr_b16 v[84:85], v3 offset:6144
    ds_read_b64_tr_b16 v[86:87], v3 offset:6656
    ds_read_b64_tr_b16 v[88:89], v3 offset:7168
    ds_read_b64_tr_b16 v[90:91], v3 offset:7680
    ds_read_b64_tr_b16 v[92:93], v3 offset:8192
    ds_read_b64_tr_b16 v[94:95], v3 offset:8704
    s_waitcnt lgkmcnt(0)
    v_mfma_f32_16x16x32_bf16 v[56:59], v[84:87], v[8:11], v[56:59]
    v_mfma_f32_16x16x32_bf16 v[56:59], v[88:91], v[8:11], v[56:59]
    v_mfma_f32_16x16x32_bf16 v[56:59], v[92:95], v[8:11], v[56:59]
    s_nop 7
    v_mov_b32 v16, v56
    v_mov_b32 v17, v57
    v_mov_b32 v18, v58
    v_mov_b32 v19, v59
    v_permlane32_swap_b32 v56, v16
    v_permlane32_swap_b32 v57, v17
    v_permlane32_swap_b32 v58, v18
    v_permlane32_swap_b32 v59, v19
    v_add_f32 v56, v56, v16
    v_add_f32 v57, v57, v17
    v_add_f32 v58, v58, v18
    v_add_f32 v59, v59, v19
    s_mov_b32 s75, 4
    v_lshrrev_b32 v4, 4, v0
    s_lshl_b32 s74, s75, 6
    s_add_u32 s74, s74, 158976
    v_add_u32 v4, s74, v4
    s_mov_b32 exec_lo, 0x00010001
    s_mov_b32 exec_hi, 0x00010001
    ds_write_b128 v4, v[56:59]
    s_mov_b64 exec, -1
    s_add_u32 s79, s75, 32
    s_lshl_b64 exec, 1, s79
    v_mov_b32 v5, 64
    ds_write_b32 v1, v5
    s_mov_b64 exec, -1
L_H_c2:
    s_cmp_eq_u32 s6, 2
    s_cselect_b32 s75, 3, 4
    s_sub_u32 s74, s6, 1
    s_cmp_eq_u32 s66, 30
    s_cselect_b32 s75, s74, s75
    s_cmp_ge_u32 s66, 30
    s_cselect_b32 s75, s75, 4
    s_cmp_ge_u32 s75, 4
    s_cbranch_scc1 L_H_nokeep
    v_and_b32 v2, 0x300, v0
    v_lshlrev_b32 v2, 2, v2
    v_and_b32 v5, 0xc0, v0
    v_lshl_add_u32 v2, v5, 1, v2
    v_bfe_u32 v5, v0, 4, 2
    v_lshl_add_u32 v2, v5, 3, v2
    v_lshrrev_b32 v5, 2, v0
    v_and_b32 v5, 0x60, v5
    v_add_u32 v2, v2, v5
    s_lshl_b32 s74, s75, 5
    v_xor_b32 v2, s74, v2
    ds_read_b64_tr_b16 v[60:61], v2 offset:0
    ds_read_b64_tr_b16 v[62:63], v2 offset:512
    ds_read_b64_tr_b16 v[64:65], v2 offset:4096
    ds_read_b64_tr_b16 v[66:67], v2 offset:4608
    ds_read_b64_tr_b16 v[68:69], v2 offset:8192
    ds_read_b64_tr_b16 v[70:71], v2 offset:8704
    ds_read_b64_tr_b16 v[72:73], v2 offset:12288
    ds_read_b64_tr_b16 v[74:75], v2 offset:12800
    ds_read_b64_tr_b16 v[76:77], v2 offset:16384
    ds_read_b64_tr_b16 v[78:79], v2 offset:16896
    ds_read_b64_tr_b16 v[80:81], v2 offset:20480
    ds_read_b64_tr_b16 v[82:83], v2 offset:20992
    v_add_u32 v2, 24576, v2
    s_waitcnt lgkmcnt(0)
    ds_read_b64_tr_b16 v[84:85], v2 offset:0
    ds_read_b64_tr_b16 v[86:87], v2 offset:512
    ds_read_b64_tr_b16 v[88:89], v2 offset:4096
    ds_read_b64_tr_b16 v[90:91], v2 offset:4608
    ds_read_b64_tr_b16 v[92:93], v2 offset:8192
    ds_read_b64_tr_b16 v[94:95], v2 offset:8704
    ds_read_b64_tr_b16 v[96:97], v2 offset:12288
    ds_read_b64_tr_b16 v[98:99], v2 offset:12800
    ds_read_b64_tr_b16 v[100:101], v2 offset:16384
    ds_read_b64_tr_b16 v[102:103], v2 offset:16896
    ds_read_b64_tr_b16 v[104:105], v2 offset:20480
    ds_read_b64_tr_b16 v[106:107], v2 offset:20992
    v_add_u32 v2, 24576, v2
    s_waitcnt lgkmcnt(0)
    ds_read_b64_tr_b16 v[108:109], v2 offset:0
    ds_read_b64_tr_b16 v[110:111], v2 offset:512
    ds_read_b64_tr_b16 v[112:113], v2 offset:4096
    ds_read_b64_tr_b16 v[114:115], v2 offset:4608
    ds_read_b64_tr_b16 v[116:117], v2 offset:8192
    ds_read_b64_tr_b16 v[118:119], v2 offset:8704
    ds_read_b64_tr_b16 v[120:121], v2 offset:12288
    ds_read_b64_tr_b16 v[122:123], v2 offset:12800
    ds_read_b64_tr_b16 v[124:125], v2 offset:16384
    ds_read_b64_tr_b16 v[126:127], v2 offset:16896
    ds_read_b64_tr_b16 v[128:129], v2 offset:20480
    ds_read_b64_tr_b16 v[130:131], v2 offset:20992
    v_add_u32 v2, 24576, v2
    s_waitcnt lgkmcnt(0)
L_H_nokeep:
    v_lshrrev_b32 v4, 4, v0
    s_lshl_b32 s74, s6, 6
    s_add_u32 s74, s74, 158976
    v_add_u32 v4, s74, v4
    s_mov_b32 exec_lo, 0x00010001
    s_mov_b32 exec_hi, 0x00010001
    ds_write_b128 v4, v[12:15]
    s_mov_b64 exec, -1
    s_add_u32 s79, s6, 32
    s_lshl_b64 exec, 1, s79
    v_mov_b32 v5, 64
    ds_write_b32 v1, v5
    s_mov_b64 exec, -1
    s_cmp_lg_u32 s6, 0
    s_cbranch_scc1 L_H_work
    v_lshrrev_b32 v5, 3, v0
    v_and_b32 v5, 0x20, v5
    v_and_b32 v4, 0x70, v0
    v_xor_b32 v4, v4, v5
    v_lshrrev_b32 v5, 7, v0
    v_mul_u32_u24 v2, 1152, v5
    v_add_u32 v2, v2, v4
    v_xor_b32 v3, 64, v2
    v_lshrrev_b32 v5, 8, v0
    v_mul_u32_u24 v5, 20736, v5
    v_add_u32 v4, v4, v5
    v_bfe_u32 v5, v0, 7, 1
    v_mul_u32_u24 v5, 1152, v5
    v_add3_u32 v4, v4, v5, 0
    v_add_u32 v4, 18432, v4
    v_xor_b32 v6, 64, v4
    v_lshrrev_b32 v5, 5, v0
    v_and_b32 v7, 16, v0
    v_lshl_add_u32 v5, v5, 7, v7
    s_lshr_b32 s68, s4, 2
    s_mov_b32 s8, 2654435769
    s_mov_b32 s9, 7
L_H0_layer:
    s_lshl_b32 s72, s35, 4
    s_lshl_b32 s71, s35, 4
    s_mul_i32 s73, s35, 32768
    s_add_u32 s73, s73, 327680
    s_lshl_b32 s74, s68, 12
    s_add_u32 s74, s74, s73
    s_mov_b32 s19, 8
    s_cmp_ge_u32 0, s19
    s_addc_u32 s76, s68, 0
    s_and_b32 s76, s76, 7
    s_mul_i32 s76, s76, 18944
    s_mul_i32 s77, s35, 163840
    s_add_u32 s76, s76, s77
    s_mov_b32 s77, s28
    s_cmp_lg_u32 s35, 0
    s_cbranch_scc1 L_H0_go
L_w84:
    ds_read_b32 v7, v1
    s_waitcnt lgkmcnt(0)
    v_cmp_gt_u32 vcc, 1, v7
    s_and_b32 s79, vcc_hi, 0xf00000
    s_cbranch_scc0 L_wd85
    s_sub_i32 s34, s34, 1
    s_cmp_gt_i32 s34, 0
    s_cbranch_scc1 L_w84
L_wd85:
L_H0_f0:
    buffer_load_dwordx4 v[8:11], v5, s[36:39], s74 offen sc1
    s_waitcnt vmcnt(0)
    v_sub_u32 v8, v8, v9
    v_subrev_u32 v8, s8, v8
    v_sub_u32 v10, v10, v11
    v_subrev_u32 v10, s8, v10
    v_max_u32 v7, v8, v10
    v_cmp_lt_u32 vcc, s9, v7
    s_cbranch_vccz L_rd86
    s_sleep 1
    s_sub_i32 s34, s34, 16
    s_cmp_gt_i32 s34, 0
    s_cbranch_scc1 L_H0_f0
L_rd86:
L_H0_go:
    s_add_u32 m0, s77, 0
    s_add_u32 s79, s76, 0
    buffer_load_dwordx4 v0, s[36:39], s79 offen offset:0 sc1 lds
    buffer_load_dwordx4 v0, s[36:39], s79 offen offset:1024 sc1 lds
    buffer_load_dwordx4 v0, s[36:39], s79 offen offset:2048 sc1 lds
    buffer_load_dwordx4 v0, s[36:39], s79 offen offset:3072 sc1 lds
    s_add_u32 m0, s77, 4096
    s_add_u32 s79, s76, 4096
    buffer_load_dwordx4 v0, s[36:39], s79 offen offset:0 sc1 lds
    buffer_load_dwordx4 v0, s[36:39], s79 offen offset:1024 sc1 lds
    buffer_load_dwordx4 v0, s[36:39], s79 offen offset:2048 sc1 lds
    buffer_load_dwordx4 v0, s[36:39], s79 offen offset:3072 sc1 lds
    s_add_u32 m0, s77, 8192
    s_add_u32 s79, s76, 8192
    buffer_load_dwordx4 v0, s[36:39], s79 offen offset:0 sc1 lds
    buffer_load_dwordx4 v0, s[36:39], s79 offen offset:1024 sc1 lds
    buffer_load_dwordx4 v0, s[36:39], s79 offen offset:2048 sc1 lds
    buffer_load_dwordx4 v0, s[36:39], s79 offen offset:3072 sc1 lds
    s_add_u32 m0, s77, 12288
    s_add_u32 s79, s76, 12288
    buffer_load_dwordx4 v0, s[36:39], s79 offen offset:0 sc1 lds
    buffer_load_dwordx4 v0, s[36:39], s79 offen offset:1024 sc1 lds
    buffer_load_dwordx4 v0, s[36:39], s79 offen offset:2048 sc1 lds
    buffer_load_dwordx4 v0, s[36:39], s79 offen offset:3072 sc1 lds
    s_add_u32 m0, s77, 16384
    s_add_u32 s79, s76, 16384
    buffer_load_dwordx4 v0, s[36:39], s79 offen offset:0 sc1 lds
    buffer_load_dwordx4 v0, s[36:39], s79 offen offset:1024 sc1 lds
    s_mov_b32 exec_hi, 0
    buffer_load_dwordx4 v0, s[36:39], s79 offen offset:2048 sc1 lds
    s_mov_b32 exec_hi, -1
    s_cmp_lg_u32 s35, 0
    s_cbranch_scc1 L_H0_nx
    s_getreg_b32 s76, hwreg(HW_REG_XCC_ID, 0, 3)
    v_cmp_ne_u32 vcc, s76, v8
    v_cmp_ne_u32 s[76:77], s76, v10
    s_or_b64 vcc, vcc, s[76:77]
    s_lshl_b32 s76, s4, 4
    s_lshr_b64 vcc, vcc, s76
    s_and_b32 s76, vcc_lo, 0xffff
    s_cselect_b32 s76, 0, 1
    s_lshl_b64 exec, 1, 12
    v_mov_b32 v7, s76
    ds_write_b32 v1, v7
    s_mov_b64 exec, -1
    s_branch L_H0_n2
L_H0_nx:
    s_branch L_H0_k1c
L_H0_k1:
    buffer_load_dword v44, v42, s[36:39], s14 offen sc1
    buffer_load_dword v45, v43, s[36:39], s15 offen sc1
    s_waitcnt vmcnt(2)
    s_lshl_b64 exec, 1, 11
    v_mov_b32 v7, 17
    ds_write_b32 v1, v7
    s_mov_b64 exec, -1
    s_waitcnt vmcnt(0)
    v_max_u32 v40, v40, v44
    v_max_u32 v41, v41, v45
    v_cmp_eq_u32 vcc, 0, v40
    s_nop 1
    v_cndmask_b32 v42, v46, v42, vcc
    v_cmp_eq_u32 vcc, 0, v41
    s_nop 1
    v_cndmask_b32 v43, v46, v43, vcc
L_H0_k1c:
    v_min_u32 v10, v40, v41
    v_cmp_eq_u32 vcc, 0, v10
    s_cbranch_vccz L_rd87
    s_sleep 1
    s_sub_i32 s34, s34, 16
    s_cmp_gt_i32 s34, 0
    s_cbranch_scc1 L_H0_k1
L_rd87:
    v_max_u32 v8, v40, v41
    s_nop 1
    v_max_u32_dpp v8, v8, v8 quad_perm:[1,0,3,2] row_mask:0xf bank_mask:0xf
    s_nop 1
    v_max_u32_dpp v8, v8, v8 quad_perm:[2,3,0,1] row_mask:0xf bank_mask:0xf
    s_nop 1
    v_max_u32_dpp v8, v8, v8 row_half_mirror row_mask:0xf bank_mask:0xf
    s_nop 1
    v_max_u32_dpp v8, v8, v8 row_mirror row_mask:0xf bank_mask:0xf
    v_mov_b32 v9, v8
    s_nop 1
    v_permlane16_swap_b32 v8, v9
    v_max_u32 v8, v8, v9
    v_mov_b32 v9, v8
    s_nop 1
    v_permlane32_swap_b32 v8, v9
    v_max_u32 v8, v8, v9
    v_max_u32 v8, 2, v8
    s_lshl_b64 exec, 1, 46
    ds_write_b32 v1, v8
    s_mov_b64 exec, -1
    v_readfirstlane_b32 s74, v8
    s_not_b32 s74, s74
    s_bfe_u32 s74, s74, 0x30008
    s_sub_u32 s19, s68, s74
    s_and_b32 s19, s19, 7
    s_mov_b32 s68, s74
L_H0_n2:
    s_cmp_ge_u32 1, s19
    s_addc_u32 s76, s68, 1
    s_and_b32 s76, s76, 7
    s_lshl_b32 s75, s76, 12
    s_add_u32 s75, s75, s73
    s_mul_i32 s76, s76, 18944
    s_mul_i32 s77, s35, 163840
    s_add_u32 s76, s76, s77
    s_add_u32 s77, s28, 18944
    s_add_u32 s71, s71, 1
L_H0_f1:
    buffer_load_dwordx4 v[8:11], v5, s[36:39], s75 offen sc1
    s_waitcnt vmcnt(1)
    s_lshl_b64 exec, 1, 11
    v_mov_b32 v7, s71
    ds_write_b32 v1, v7
    s_mov_b64 exec, -1
    s_waitcnt vmcnt(0)
    v_sub_u32 v8, v8, v9
    v_subrev_u32 v8, s8, v8
    v_sub_u32 v10, v10, v11
    v_subrev_u32 v10, s8, v10
    v_max_u32 v7, v8, v10
    v_cmp_lt_u32 vcc, s9, v7
    s_cbranch_vccz L_rd88
    s_sleep 1
    s_sub_i32 s34, s34, 16
    s_cmp_gt_i32 s34, 0
    s_cbranch_scc1 L_H0_f1
L_rd88:
    s_add_u32 m0, s77, 0
    s_add_u32 s79, s76, 0
    buffer_load_dwordx4 v0, s[36:39], s79 offen offset:0 sc1 lds
    buffer_load_dwordx4 v0, s[36:39], s79 offen offset:1024 sc1 lds
    buffer_load_dwordx4 v0, s[36:39], s79 offen offset:2048 sc1 lds
    buffer_load_dwordx4 v0, s[36:39], s79 offen offset:3072 sc1 lds
    s_add_u32 m0, s77, 4096
    s_add_u32 s79, s76, 4096
    buffer_load_dwordx4 v0, s[36:39], s79 offen offset:0 sc1 lds
    buffer_load_dwordx4 v0, s[36:39], s79 offen offset:1024 sc1 lds
    buffer_load_dwordx4 v0, s[36:39], s79 offen offset:2048 sc1 lds
    buffer_load_dwordx4 v0, s[36:39], s79 offen offset:3072 sc1 lds
    s_add_u32 m0, s77, 8192
    s_add_u32 s79, s76, 8192
    buffer_load_dwordx4 v0, s[36:39], s79 offen offset:0 sc1 lds
    buffer_load_dwordx4 v0, s[36:39], s79 offen offset:1024 sc1 lds
    buffer_load_dwordx4 v0, s[36:39], s79 offen offset:2048 sc1 lds
    buffer_load_dwordx4 v0, s[36:39], s79 offen offset:3072 sc1 lds
    s_add_u32 m0, s77, 12288
    s_add_u32 s79, s76, 12288
    buffer_load_dwordx4 v0, s[36:39], s79 offen offset:0 sc1 lds
    buffer_load_dwordx4 v0, s[36:39], s79 offen offset:1024 sc1 lds
    buffer_load_dwordx4 v0, s[36:39], s79 offen offset:2048 sc1 lds
    buffer_load_dwordx4 v0, s[36:39], s79 offen offset:3072 sc1 lds
    s_add_u32 m0, s77, 16384
    s_add_u32 s79, s76, 16384
    buffer_load_dwordx4 v0, s[36:39], s79 offen offset:0 sc1 lds
    buffer_load_dwordx4 v0, s[36:39], s79 offen offset:1024 sc1 lds
    s_mov_b32 exec_hi, 0
    buffer_load_dwordx4 v0, s[36:39], s79 offen offset:2048 sc1 lds
    s_mov_b32 exec_hi, -1
    s_add_u32 s71, s71, 1
L_H0_fa:
    buffer_load_dwordx4 v[8:11], v5, s[36:39], s73 offen sc1
    s_add_u32 s79, s73, 4096
    buffer_load_dwordx4 v[12:15], v5, s[36:39], s79 offen sc1
    s_add_u32 s79, s73, 8192
    buffer_load_dwordx4 v[16:19], v5, s[36:39], s79 offen sc1
    s_add_u32 s79, s73, 12288
    buffer_load_dwordx4 v[20:23], v5, s[36:39], s79 offen sc1
    s_add_u32 s79, s73, 16384
    buffer_load_dwordx4 v[24:27], v5, s[36:39], s79 offen sc1
    s_add_u32 s79, s73, 20480
    buffer_load_dwordx4 v[28:31], v5, s[36:39], s79 offen sc1
    s_add_u32 s79, s73, 24576
    buffer_load_dwordx4 v[32:35], v5, s[36:39], s79 offen sc1
    s_add_u32 s79, s73, 28672
    buffer_load_dwordx4 v[36:39], v5, s[36:39], s79 offen sc1
    s_waitcnt vmcnt(8)
    s_lshl_b64 exec, 1, 11
    v_mov_b32 v7, s71
    ds_write_b32 v1, v7
    s_mov_b64 exec, -1
    s_waitcnt vmcnt(0)
    v_sub_u32 v8, v8, v9
    v_subrev_u32 v8, s8, v8
    v_sub_u32 v10, v10, v11
    v_subrev_u32 v10, s8, v10
    v_sub_u32 v12, v12, v13
    v_subrev_u32 v12, s8, v12
    v_sub_u32 v14, v14, v15
    v_subrev_u32 v14, s8, v14
    v_sub_u32 v16, v16, v17
    v_subrev_u32 v16, s8, v16
    v_sub_u32 v18, v18, v19
    v_subrev_u32 v18, s8, v18
    v_sub_u32 v20, v20, v21
    v_subrev_u32 v20, s8, v20
    v_sub_u32 v22, v22, v23
    v_subrev_u32 v22, s8, v22
    v_sub_u32 v24, v24, v25
    v_subrev_u32 v24, s8, v24
    v_sub_u32 v26, v26, v27
    v_subrev_u32 v26, s8, v26
    v_sub_u32 v28, v28, v29
    v_subrev_u32 v28, s8, v28
    v_sub_u32 v30, v30, v31
    v_subrev_u32 v30, s8, v30
    v_sub_u32 v32, v32, v33
    v_subrev_u32 v32, s8, v32
    v_sub_u32 v34, v34, v35
    v_subrev_u32 v34, s8, v34
    v_sub_u32 v36, v36, v37
    v_subrev_u32 v36, s8, v36
    v_sub_u32 v38, v38, v39
    v_subrev_u32 v38, s8, v38
    v_max3_u32 v7, v8, v10, v12
    v_max3_u32 v7, v7, v14, v16
    v_max3_u32 v7, v7, v18, v20
    v_max3_u32 v7, v7, v22, v24
    v_max3_u32 v7, v7, v26, v28
    v_max3_u32 v7, v7, v30, v32
    v_max3_u32 v7, v7, v34, v36
    v_max_u32 v7, v7, v38
    v_cmp_lt_u32 vcc, s9, v7
    s_cbranch_vccz L_rd89
    s_sleep 2
    s_sub_i32 s34, s34, 16
    s_cmp_gt_i32 s34, 0
    s_cbranch_scc1 L_H0_fa
L_rd89:
    s_add_u32 s72, s72, 1
L_w90:
    ds_read_b32 v7, v1
    s_waitcnt lgkmcnt(0)
    v_cmp_gt_u32 vcc, s72, v7
    s_and_b32 s79, vcc_lo, 0xff
    s_cbranch_scc0 L_wd91
    s_sleep 1
    s_sub_i32 s34, s34, 5
    s_cmp_gt_i32 s34, 0
    s_cbranch_scc1 L_w90
L_wd91:
    s_cmp_ge_u32 2, s19
    s_addc_u32 s76, s68, 2
    s_and_b32 s76, s76, 7
    s_mul_i32 s76, s76, 18944
    s_mul_i32 s77, s35, 163840
    s_add_u32 s76, s76, s77
    s_add_u32 s77, s28, 37888
    s_add_u32 m0, s77, 0
    s_add_u32 s79, s76, 0
    buffer_load_dwordx4 v0, s[36:39], s79 offen offset:0 sc1 lds
    buffer_load_dwordx4 v0, s[36:39], s79 offen offset:1024 sc1 lds
    buffer_load_dwordx4 v0, s[36:39], s79 offen offset:2048 sc1 lds
    buffer_load_dwordx4 v0, s[36:39], s79 offen offset:3072 sc1 lds
    s_add_u32 m0, s77, 4096
    s_add_u32 s79, s76, 4096
    buffer_load_dwordx4 v0, s[36:39], s79 offen offset:0 sc1 lds
    buffer_load_dwordx4 v0, s[36:39], s79 offen offset:1024 sc1 lds
    buffer_load_dwordx4 v0, s[36:39], s79 offen offset:2048 sc1 lds
    buffer_load_dwordx4 v0, s[36:39], s79 offen offset:3072 sc1 lds
    s_add_u32 m0, s77, 8192
    s_add_u32 s79, s76, 8192
    buffer_load_dwordx4 v0, s[36:39], s79 offen offset:0 sc1 lds
    buffer_load_dwordx4 v0, s[36:39], s79 offen offset:1024 sc1 lds
    buffer_load_dwordx4 v0, s[36:39], s79 offen offset:2048 sc1 lds
    buffer_load_dwordx4 v0, s[36:39], s79 offen offset:3072 sc1 lds
    s_add_u32 m0, s77, 12288
    s_add_u32 s79, s76, 12288
    buffer_load_dwordx4 v0, s[36:39], s79 offen offset:0 sc1 lds
    buffer_load_dwordx4 v0, s[36:39], s79 offen offset:1024 sc1 lds
    buffer_load_dwordx4 v0, s[36:39], s79 offen offset:2048 sc1 lds
    buffer_load_dwordx4 v0, s[36:39], s79 offen offset:3072 sc1 lds
    s_add_u32 m0, s77, 16384
    s_add_u32 s79, s76, 16384
    buffer_load_dwordx4 v0, s[36:39], s79 offen offset:0 sc1 lds
    buffer_load_dwordx4 v0, s[36:39], s79 offen offset:1024 sc1 lds
    s_mov_b32 exec_hi, 0
    buffer_load_dwordx4 v0, s[36:39], s79 offen offset:2048 sc1 lds
    s_mov_b32 exec_hi, -1
    s_cmp_ge_u32 3, s19
    s_addc_u32 s76, s68, 3
    s_and_b32 s76, s76, 7
    s_mul_i32 s76, s76, 18944
    s_mul_i32 s77, s35, 163840
    s_add_u32 s76, s76, s77
    s_add_u32 s77, s28, 56832
    s_add_u32 m0, s77, 0
    s_add_u32 s79, s76, 0
    buffer_load_dwordx4 v0, s[36:39], s79 offen offset:0 sc1 lds
    buffer_load_dwordx4 v0, s[36:39], s79 offen offset:1024 sc1 lds
    buffer_load_dwordx4 v0, s[36:39], s79 offen offset:2048 sc1 lds
    buffer_load_dwordx4 v0, s[36:39], s79 offen offset:3072 sc1 lds
    s_add_u32 m0, s77, 4096
    s_add_u32 s79, s76, 4096
    buffer_load_dwordx4 v0, s[36:39], s79 offen offset:0 sc1 lds
    buffer_load_dwordx4 v0, s[36:39], s79 offen offset:1024 sc1 lds
    buffer_load_dwordx4 v0, s[36:39], s79 offen offset:2048 sc1 lds
    buffer_load_dwordx4 v0, s[36:39], s79 offen offset:3072 sc1 lds
    s_add_u32 m0, s77, 8192
    s_add_u32 s79, s76, 8192
    buffer_load_dwordx4 v0, s[36:39], s79 offen offset:0 sc1 lds
    buffer_load_dwordx4 v0, s[36:39], s79 offen offset:1024 sc1 lds
    buffer_load_dwordx4 v0, s[36:39], s79 offen offset:2048 sc1 lds
    buffer_load_dwordx4 v0, s[36:39], s79 offen offset:3072 sc1 lds
    s_add_u32 m0, s77, 12288
    s_add_u32 s79, s76, 12288
    buffer_load_dwordx4 v0, s[36:39], s79 offen offset:0 sc1 lds
    buffer_load_dwordx4 v0, s[36:39], s79 offen offset:1024 sc1 lds
    buffer_load_dwordx4 v0, s[36:39], s79 offen offset:2048 sc1 lds
    buffer_load_dwordx4 v0, s[36:39], s79 offen offset:3072 sc1 lds
    s_add_u32 m0, s77, 16384
    s_add_u32 s79, s76, 16384
    buffer_load_dwordx4 v0, s[36:39], s79 offen offset:0 sc1 lds
    buffer_load_dwordx4 v0, s[36:39], s79 offen offset:1024 sc1 lds
    s_mov_b32 exec_hi, 0
    buffer_load_dwordx4 v0, s[36:39], s79 offen offset:2048 sc1 lds
    s_mov_b32 exec_hi, -1
    s_lshl_b64 exec, 1, 37
    v_mov_b32 v7, 1
    ds_write_b32 v1, v7
    s_mov_b64 exec, -1
    s_add_u32 s71, s71, 1
    s_waitcnt vmcnt(19)
    s_lshl_b64 exec, 1, 11
    v_mov_b32 v7, s71
    ds_write_b32 v1, v7
    s_mov_b64 exec, -1
    s_add_u32 s71, s71, 1
    s_waitcnt vmcnt(0)
    s_lshl_b64 exec, 1, 11
    v_mov_b32 v7, s71
    ds_write_b32 v1, v7
    s_mov_b64 exec, -1
    s_cmp_eq_u32 s35, 0
    s_cbranch_scc1 L_H0_ns
    s_lshl_b32 s74, s4, 3
    s_add_u32 s74, s74, s5
    s_lshl_b32 s74, s74, 7
    s_add_u32 s74, s74, 327680
    v_lshrrev_b32 v7, 1, v0
    s_mov_b64 exec, 31
    buffer_load_dword v8, v7, s[36:39], s74 offen sc1
    s_waitcnt vmcnt(0)
    buffer_store_dword v8, v7, s[36:39], s74 offen offset:4 sc1
    s_mov_b64 exec, -1
L_H0_ns:
    s_mov_b32 s18, 4
L_H0_ring:
    s_add_u32 s72, s72, 1
L_w92:
    ds_read_b32 v7, v1
    s_waitcnt lgkmcnt(0)
    v_cmp_gt_u32 vcc, s72, v7
    s_and_b32 s79, vcc_lo, 0xff
    s_cbranch_scc0 L_wd93
    s_sleep 8
    s_sub_i32 s34, s34, 33
    s_cmp_gt_i32 s34, 0
    s_cbranch_scc1 L_w92
L_wd93:
    s_cmp_lg_u32 s71, 23
    s_cbranch_scc1 L_H0_nopf
    s_mov_b32 s74, 12685312
    v_lshrrev_b32 v9, 2, v0
    v_min_u32 v9, 20, v9
L_H0_pf:
    buffer_load_dword v8, v9, s[36:39], s74 offen sc1
    s_waitcnt vmcnt(0)
    v_cmp_eq_u32 vcc, -1, v8
    s_cbranch_vccz L_rd94
    s_sleep 2
    s_sub_i32 s34, s34, 16
    s_cmp_gt_i32 s34, 0
    s_cbranch_scc1 L_H0_pf
L_rd94:
L_H0_nopf:
    s_cmp_ge_u32 s18, s19
    s_addc_u32 s76, s68, s18
    s_and_b32 s76, s76, 7
    s_mul_i32 s76, s76, 18944
    s_mul_i32 s77, s35, 163840
    s_add_u32 s76, s76, s77
    s_and_b32 s77, s18, 3
    s_mul_i32 s77, s77, 18944
    s_add_u32 s77, s77, s28
    s_add_u32 m0, s77, 0
    s_add_u32 s79, s76, 0
    buffer_load_dwordx4 v0, s[36:39], s79 offen offset:0 sc1 lds
    buffer_load_dwordx4 v0, s[36:39], s79 offen offset:1024 sc1 lds
    buffer_load_dwordx4 v0, s[36:39], s79 offen offset:2048 sc1 lds
    buffer_load_dwordx4 v0, s[36:39], s79 offen offset:3072 sc1 lds
    s_add_u32 m0, s77, 4096
    s_add_u32 s79, s76, 4096
    buffer_load_dwordx4 v0, s[36:39], s79 offen offset:0 sc1 lds
    buffer_load_dwordx4 v0, s[36:39], s79 offen offset:1024 sc1 lds
    buffer_load_dwordx4 v0, s[36:39], s79 offen offset:2048 sc1 lds
    buffer_load_dwordx4 v0, s[36:39], s79 offen offset:3072 sc1 lds
    s_add_u32 m0, s77, 8192
    s_add_u32 s79, s76, 8192
    buffer_load_dwordx4 v0, s[36:39], s79 offen offset:0 sc1 lds
    buffer_load_dwordx4 v0, s[36:39], s79 offen offset:1024 sc1 lds
    buffer_load_dwordx4 v0, s[36:39], s79 offen offset:2048 sc1 lds
    buffer_load_dwordx4 v0, s[36:39], s79 offen offset:3072 sc1 lds
    s_add_u32 m0, s77, 12288
    s_add_u32 s79, s76, 12288
    buffer_load_dwordx4 v0, s[36:39], s79 offen offset:0 sc1 lds
    buffer_load_dwordx4 v0, s[36:39], s79 offen offset:1024 sc1 lds
    buffer_load_dwordx4 v0, s[36:39], s79 offen offset:2048 sc1 lds
    buffer_load_dwordx4 v0, s[36:39], s79 offen offset:3072 sc1 lds
    s_add_u32 m0, s77, 16384
    s_add_u32 s79, s76, 16384
    buffer_load_dwordx4 v0, s[36:39], s79 offen offset:0 sc1 lds
    buffer_load_dwordx4 v0, s[36:39], s79 offen offset:1024 sc1 lds
    s_mov_b32 exec_hi, 0
    buffer_load_dwordx4 v0, s[36:39], s79 offen offset:2048 sc1 lds
    s_mov_b32 exec_hi, -1
    s_cmp_eq_u32 s18, 7
    s_addc_u32 s71, s71, 1
    s_waitcnt vmcnt(0)
    s_lshl_b64 exec, 1, 11
    v_mov_b32 v7, s71
    ds_write_b32 v1, v7
    s_mov_b64 exec, -1
    s_add_u32 s18, s18, 1
    s_cmp_lt_u32 s18, 8
    s_cbranch_scc1 L_H0_ring
    s_cmp_lg_u32 s35, 0
    s_cbranch_scc1 L_H0_nr
    v_lshlrev_b32 v16, 3, v0
L_H0_rf:
    s_mov_b32 s74, 327680
    buffer_load_dwordx2 v[8:9], v16, s[36:39], s74 offen offset:32 sc1
    s_mov_b32 s74, 335872
    buffer_load_dwordx2 v[10:11], v16, s[36:39], s74 offen offset:32 sc1
    s_mov_b32 s74, 344064
    buffer_load_dwordx2 v[12:13], v16, s[36:39], s74 offen offset:32 sc1
    s_mov_b32 s74, 352256
    buffer_load_dwordx2 v[14:15], v16, s[36:39], s74 offen offset:32 sc1
    s_waitcnt vmcnt(0)
    v_sub_u32 v8, v8, v9
    v_subrev_u32 v8, s8, v8
    v_sub_u32 v10, v10, v11
    v_subrev_u32 v10, s8, v10
    v_sub_u32 v12, v12, v13
    v_subrev_u32 v12, s8, v12
    v_sub_u32 v14, v14, v15
    v_subrev_u32 v14, s8, v14
    v_max3_u32 v7, v8, v10, v12
    v_max_u32 v7, v7, v14
    v_cmp_lt_u32 vcc, s9, v7
    s_cbranch_vccz L_rd95
    s_sleep 4
    s_sub_i32 s34, s34, 16
    s_cmp_gt_i32 s34, 0
    s_cbranch_scc1 L_H0_rf
L_rd95:
    s_lshl_b64 exec, 1, 13
    v_mov_b32 v7, 64
    ds_write_b32 v1, v7
    s_mov_b64 exec, -1
    s_mul_i32 s74, s5, 18432
    s_add_u32 s74, s74, 458752
    buffer_load_dwordx4 v[96:99], v0, s[36:39], s74 offen offset:0 sc1
    buffer_load_dwordx4 v[100:103], v0, s[36:39], s74 offen offset:1024 sc1
    buffer_load_dwordx4 v[104:107], v0, s[36:39], s74 offen offset:2048 sc1
    buffer_load_dwordx4 v[108:111], v0, s[36:39], s74 offen offset:3072 sc1
    s_add_u32 s74, s74, 4096
    buffer_load_dwordx4 v[112:115], v0, s[36:39], s74 offen offset:0 sc1
    buffer_load_dwordx4 v[116:119], v0, s[36:39], s74 offen offset:1024 sc1
    buffer_load_dwordx4 v[120:123], v0, s[36:39], s74 offen offset:2048 sc1
    buffer_load_dwordx4 v[124:127], v0, s[36:39], s74 offen offset:3072 sc1
    s_add_u32 s74, s74, 4096
    buffer_load_dwordx4 v[128:131], v0, s[36:39], s74 offen offset:0 sc1
    buffer_load_dwordx4 v[60:63], v0, s[36:39], s74 offen offset:1024 sc1
    buffer_load_dwordx4 v[64:67], v0, s[36:39], s74 offen offset:2048 sc1
    buffer_load_dwordx4 v[68:71], v0, s[36:39], s74 offen offset:3072 sc1
    s_add_u32 s74, s74, 4096
    buffer_load_dwordx4 v[72:75], v0, s[36:39], s74 offen offset:0 sc1
    buffer_load_dwordx4 v[76:79], v0, s[36:39], s74 offen offset:1024 sc1
    buffer_load_dwordx4 v[80:83], v0, s[36:39], s74 offen offset:2048 sc1
    buffer_load_dwordx4 v[84:87], v0, s[36:39], s74 offen offset:3072 sc1
    s_add_u32 s74, s74, 4096
    buffer_load_dwordx4 v[88:91], v0, s[36:39], s74 offen offset:0 sc1
    buffer_load_dwordx4 v[92:95], v0, s[36:39], s74 offen offset:1024 sc1
L_H0_nr:
    s_add_u32 s72, s72, 1
L_w96:
    ds_read_b32 v7, v1
    s_waitcnt lgkmcnt(0)
    v_cmp_gt_u32 vcc, s72, v7
    s_and_b32 s79, vcc_lo, 0x7ff
    s_cbranch_scc0 L_wd97
    s_sleep 8
    s_sub_i32 s34, s34, 33
    s_cmp_gt_i32 s34, 0
    s_cbranch_scc1 L_w96
L_wd97:
    s_mov_b32 s75, s64
    s_mov_b32 s76, s29
    s_mov_b32 s18, 4
L_H0_wo:
    s_add_u32 m0, s76, 0
    s_add_u32 s79, s75, 0
    buffer_load_dwordx4 v2, s[48:51], s79 offen lds
    s_add_u32 m0, s76, 1024
    s_add_u32 s79, s75, 9216
    buffer_load_dwordx4 v3, s[48:51], s79 offen lds
    s_add_u32 m0, s76, 2048
    s_add_u32 s79, s75, 20736
    buffer_load_dwordx4 v2, s[48:51], s79 offen lds
    s_add_u32 m0, s76, 3072
    s_add_u32 s79, s75, 29952
    buffer_load_dwordx4 v3, s[48:51], s79 offen lds
    s_add_u32 m0, s76, 4096
    s_add_u32 s79, s75, 41472
    buffer_load_dwordx4 v2, s[48:51], s79 offen lds
    s_add_u32 m0, s76, 5120
    s_add_u32 s79, s75, 50688
    buffer_load_dwordx4 v3, s[48:51], s79 offen lds
    s_add_u32 m0, s76, 6144
    s_add_u32 s79, s75, 62208
    buffer_load_dwordx4 v2, s[48:51], s79 offen lds
    s_add_u32 m0, s76, 7168
    s_add_u32 s79, s75, 71424
    buffer_load_dwordx4 v3, s[48:51], s79 offen lds
    s_add_u32 m0, s76, 8192
    s_add_u32 s79, s75, 0
    buffer_load_dwordx4 v4, s[48:51], s79 offen lds
    s_add_u32 s75, s75, 82944
    s_add_u32 s76, s76, 9216
    s_add_u32 m0, s76, 0
    s_add_u32 s79, s75, 0
    buffer_load_dwordx4 v3, s[48:51], s79 offen lds
    s_add_u32 m0, s76, 1024
    s_add_u32 s79, s75, 9216
    buffer_load_dwordx4 v2, s[48:51], s79 offen lds
    s_add_u32 m0, s76, 2048
    s_add_u32 s79, s75, 20736
    buffer_load_dwordx4 v3, s[48:51], s79 offen lds
    s_add_u32 m0, s76, 3072
    s_add_u32 s79, s75, 29952
    buffer_load_dwordx4 v2, s[48:51], s79 offen lds
    s_add_u32 m0, s76, 4096
    s_add_u32 s79, s75, 41472
    buffer_load_dwordx4 v3, s[48:51], s79 offen lds
    s_add_u32 m0, s76, 5120
    s_add_u32 s79, s75, 50688
    buffer_load_dwordx4 v2, s[48:51], s79 offen lds
    s_add_u32 m0, s76, 6144
    s_add_u32 s79, s75, 62208
    buffer_load_dwordx4 v3, s[48:51], s79 offen lds
    s_add_u32 m0, s76, 7168
    s_add_u32 s79, s75, 71424
    buffer_load_dwordx4 v2, s[48:51], s79 offen lds
    s_add_u32 m0, s76, 8192
    s_add_u32 s79, s75, 0
    buffer_load_dwordx4 v6, s[48:51], s79 offen lds
    s_add_u32 s75, s75, 82944
    s_add_u32 s76, s76, 9216
    s_waitcnt vmcnt(18)
    s_sub_u32 s18, s18, 1
    s_cmp_lg_u32 s18, 0
    s_cbranch_scc1 L_H0_wo
    s_lshl_b32 s74, s35, 4
    s_add_u32 s74, s74, 8
    s_waitcnt vmcnt(0)
    s_lshl_b64 exec, 1, 23
    v_mov_b32 v7, s74
    ds_write_b32 v1, v7
    s_mov_b64 exec, -1
    s_cmp_eq_u32 s35, 0
    s_cselect_b32 s75, 8, s2
    s_cmp_ge_u32 s75, 8
    s_cbranch_scc1 L_H0_nwb
    buffer_wbl2 sc1
L_H0_nwb:
    s_cmp_lg_u32 s35, 0
    s_cbranch_scc1 L_H0_t5
    s_mov_b32 s75, s64
    s_mov_b32 s76, 82944
L_w98:
    ds_read_b32 v7, v1
    s_waitcnt lgkmcnt(0)
    v_cmp_gt_u32 vcc, 7, v7
    s_and_b32 s79, vcc_lo, 0x7ff
    s_cbranch_scc0 L_wd99
    s_sleep 6
    s_sub_i32 s34, s34, 25
    s_cmp_gt_i32 s34, 0
    s_cbranch_scc1 L_w98
L_wd99:
L_H0_wq:
    s_add_u32 m0, s76, 0
    s_add_u32 s79, s75, 0
    buffer_load_dwordx4 v2, s[44:47], s79 offen lds
    s_add_u32 m0, s76, 1024
    s_add_u32 s79, s75, 9216
    buffer_load_dwordx4 v3, s[44:47], s79 offen lds
    s_add_u32 m0, s76, 2048
    s_add_u32 s79, s75, 18432
    buffer_load_dwordx4 v2, s[44:47], s79 offen lds
    s_add_u32 m0, s76, 3072
    s_add_u32 s79, s75, 27648
    buffer_load_dwordx4 v3, s[44:47], s79 offen lds
    s_add_u32 m0, s76, 4096
    s_add_u32 s79, s75, 36864
    buffer_load_dwordx4 v2, s[44:47], s79 offen lds
    s_add_u32 m0, s76, 5120
    s_add_u32 s79, s75, 46080
    buffer_load_dwordx4 v3, s[44:47], s79 offen lds
    s_add_u32 m0, s76, 6144
    s_add_u32 s79, s75, 55296
    buffer_load_dwordx4 v2, s[44:47], s79 offen lds
    s_add_u32 m0, s76, 7168
    s_add_u32 s79, s75, 64512
    buffer_load_dwordx4 v3, s[44:47], s79 offen lds
    s_add_u32 m0, s76, 8192
    s_add_u32 s79, s75, 73728
    buffer_load_dwordx4 v2, s[44:47], s79 offen lds
    s_add_u32 m0, s76, 9216
    s_add_u32 s79, s75, 82944
    buffer_load_dwordx4 v3, s[44:47], s79 offen lds
    s_add_u32 m0, s76, 10240
    s_add_u32 s79, s75, 92160
    buffer_load_dwordx4 v2, s[44:47], s79 offen lds
    s_add_u32 m0, s76, 11264
    s_add_u32 s79, s75, 101376
    buffer_load_dwordx4 v3, s[44:47], s79 offen lds
    s_add_u32 m0, s76, 12288
    s_add_u32 s79, s75, 110592
    buffer_load_dwordx4 v2, s[44:47], s79 offen lds
    s_add_u32 m0, s76, 13312
    s_add_u32 s79, s75, 119808
    buffer_load_dwordx4 v3, s[44:47], s79 offen lds
    s_add_u32 m0, s76, 14336
    s_add_u32 s79, s75, 129024
    buffer_load_dwordx4 v2, s[44:47], s79 offen lds
    s_add_u32 m0, s76, 15360
    s_add_u32 s79, s75, 138240
    buffer_load_dwordx4 v3, s[44:47], s79 offen lds
    s_add_u32 m0, s76, 16384
    s_add_u32 s79, s75, 147456
    buffer_load_dwordx4 v2, s[44:47], s79 offen lds
    s_add_u32 m0, s76, 17408
    s_add_u32 s79, s75, 156672
    buffer_load_dwordx4 v3, s[44:47], s79 offen lds
    s_add_u32 s75, s75, 165888
    s_add_u32 s76, s76, 18432
    s_bitcmp1_b32 s76, 11
    s_cbranch_scc1 L_H0_wq
    s_waitcnt vmcnt(0)
    s_lshl_b64 exec, 1, 23
    v_mov_b32 v7, 11
    ds_write_b32 v1, v7
    s_mov_b64 exec, -1
L_H0_t5:
    s_add_u32 s72, s72, 3
    s_add_u32 s77, s28, 56320
    v_add_u32 v8, s77, v0
    s_add_u32 s77, s35, 1
L_w100:
    ds_read_b32 v7, v1
    s_waitcnt lgkmcnt(0)
    v_cmp_gt_u32 vcc, s72, v7
    s_and_b32 s79, vcc_lo, 0xff
    s_cbranch_scc0 L_wd101
    s_sleep 4
    s_sub_i32 s34, s34, 17
    s_cmp_gt_i32 s34, 0
    s_cbranch_scc1 L_w100
L_wd101:
    ds_write_b128 v8, v[96:99] offset:9216
    ds_write_b128 v8, v[100:103] offset:10240
    ds_write_b128 v8, v[104:107] offset:11264
    ds_write_b128 v8, v[108:111] offset:12288
    ds_write_b128 v8, v[112:115] offset:13312
    ds_write_b128 v8, v[116:119] offset:14336
    ds_write_b128 v8, v[120:123] offset:15360
    ds_write_b128 v8, v[124:127] offset:16384
    ds_write_b128 v8, v[128:131] offset:17408
    ds_write_b128 v8, v[60:63] offset:0
    ds_write_b128 v8, v[64:67] offset:1024
    ds_write_b128 v8, v[68:71] offset:2048
    ds_write_b128 v8, v[72:75] offset:3072
    ds_write_b128 v8, v[76:79] offset:4096
    ds_write_b128 v8, v[80:83] offset:5120
    ds_write_b128 v8, v[84:87] offset:6144
    ds_write_b128 v8, v[88:91] offset:7168
    ds_write_b128 v8, v[92:95] offset:8192
    s_lshl_b64 exec, 1, 22
    v_mov_b32 v7, s77
    ds_write_b32 v1, v7
    s_mov_b64 exec, -1
    s_add_u32 s74, s35, 2
L_w102:
    ds_read_b32 v7, v1
    s_waitcnt lgkmcnt(0)
    v_cmp_gt_u32 vcc, s74, v7
    s_and_b32 s79, vcc_hi, 0x3c00
    s_cbranch_scc0 L_wd103
    s_sleep 6
    s_sub_i32 s34, s34, 25
    s_cmp_gt_i32 s34, 0
    s_cbranch_scc1 L_w102
L_wd103:
    s_cmp_lg_u32 s35, 0
    s_cbranch_scc1 L_H0_last
L_w104:
    ds_read_b32 v7, v1
    s_waitcnt lgkmcnt(0)
    v_cmp_gt_u32 vcc, 2, v7
    s_and_b32 s79, vcc_hi, 0x3c0
    s_cbranch_scc0 L_wd105
    s_sleep 1
    s_sub_i32 s34, s34, 5
    s_cmp_gt_i32 s34, 0
    s_cbranch_scc1 L_w104
L_wd105:
    s_mov_b32 s14, 393216
    s_mov_b32 s15, 401408
    v_lshlrev_b32 v42, 3, v0
    v_lshlrev_b32 v43, 3, v0
    v_mov_b32 v40, 0
    v_mov_b32 v41, 0
    v_mov_b32 v46, 2130706432
    s_mov_b32 s8, 1
    s_mov_b32 s9, -2
    s_mov_b32 s73, 360448
    s_mov_b32 s74, 16777216
L_H0_k0:
    buffer_load_dwordx4 v[12:15], v5, s[36:39], s74 offen sc1
    buffer_load_dword v44, v42, s[36:39], s14 offen sc1
    buffer_load_dword v45, v43, s[36:39], s15 offen sc1
    s_waitcnt vmcnt(2)
    v_min_u32 v12, v12, v14
    v_cmp_eq_u32 s[76:77], 0, v12
    s_waitcnt vmcnt(0)
    v_max_u32 v40, v40, v44
    v_max_u32 v41, v41, v45
    v_cmp_eq_u32 vcc, 0, v40
    s_nop 1
    v_cndmask_b32 v42, v46, v42, vcc
    v_cmp_eq_u32 vcc, 0, v41
    s_nop 1
    v_cndmask_b32 v43, v46, v43, vcc
    s_cmp_eq_u64 s[76:77], 0
    s_cbranch_scc1 L_H0_k0d
    v_max_u32 v8, v40, v41
    s_nop 1
    v_max_u32_dpp v8, v8, v8 quad_perm:[1,0,3,2] row_mask:0xf bank_mask:0xf
    s_nop 1
    v_max_u32_dpp v8, v8, v8 quad_perm:[2,3,0,1] row_mask:0xf bank_mask:0xf
    s_nop 1
    v_max_u32_dpp v8, v8, v8 row_half_mirror row_mask:0xf bank_mask:0xf
    s_nop 1
    v_max_u32_dpp v8, v8, v8 row_mirror row_mask:0xf bank_mask:0xf
    v_mov_b32 v9, v8
    s_nop 1
    v_permlane16_swap_b32 v8, v9
    v_max_u32 v8, v8, v9
    v_mov_b32 v9, v8
    s_nop 1
    v_permlane32_swap_b32 v8, v9
    v_max_u32 v8, v8, v9
    v_cmp_ne_u32 vcc, v40, v8
    s_nop 1
    v_cndmask_b32 v9, 0, v40, vcc
    v_cmp_ne_u32 vcc, v41, v8
    s_nop 1
    v_cndmask_b32 v10, 0, v41, vcc
    v_min_u32_dpp v9, v9, v9 quad_perm:[1,0,3,2] row_mask:0xf bank_mask:0xf
    s_nop 0
    v_min_u32_dpp v10, v10, v10 quad_perm:[1,0,3,2] row_mask:0xf bank_mask:0xf
    v_min_u32_dpp v9, v9, v9 quad_perm:[2,3,0,1] row_mask:0xf bank_mask:0xf
    s_nop 0
    v_min_u32_dpp v10, v10, v10 quad_perm:[2,3,0,1] row_mask:0xf bank_mask:0xf
    v_min_u32_dpp v9, v9, v9 row_half_mirror row_mask:0xf bank_mask:0xf
    s_nop 0
    v_min_u32_dpp v10, v10, v10 row_half_mirror row_mask:0xf bank_mask:0xf
    v_min_u32_dpp v9, v9, v9 row_mirror row_mask:0xf bank_mask:0xf
    s_nop 0
    v_min_u32_dpp v10, v10, v10 row_mirror row_mask:0xf bank_mask:0xf
    v_cmp_ne_u32 s[76:77], 0, v9
    v_cmp_ne_u32 vcc, 0, v10
    s_ff1_i32_b64 s76, s[76:77]
    s_ff1_i32_b64 s77, vcc
    s_or_b32 s77, s77, 64
    s_min_u32 s76, s76, s77
    s_bfe_u32 s77, s76, 0x30004
    s_cmp_eq_u32 s74, 16777216
    s_cselect_b32 s68, s77, s68
    s_lshl_b32 s74, s68, 12
    s_add_u32 s74, s74, s73
    s_cmp_eq_u32 s76, -1
    s_cselect_b32 s74, 16777216, s74
    s_mov_b64 vcc, 1
    s_cbranch_vccz L_rd106
    s_sleep 2
    s_sub_i32 s34, s34, 16
    s_cmp_gt_i32 s34, 0
    s_cbranch_scc1 L_H0_k0
L_rd106:
L_H0_k0d:
    s_mov_b32 s35, 1
    s_mov_b32 s28, 0
    s_mov_b32 s29, 82944
    s_branch L_H0_layer
L_H0_last:
    s_mov_b32 s14, 409600
    s_mov_b32 s15, 417792
    v_lshlrev_b32 v42, 3, v0
    v_lshlrev_b32 v43, 3, v0
    v_mov_b32 v40, 0
    v_mov_b32 v41, 0
    v_mov_b32 v46, 2130706432
L_w107:
    ds_read_b32 v7, v1
    s_waitcnt lgkmcnt(0)
    v_cmp_gt_u32 vcc, 3, v7
    s_and_b32 s79, vcc_hi, 0x3c0
    s_cbranch_scc0 L_wd108
    s_sleep 1
    s_sub_i32 s34, s34, 5
    s_cmp_gt_i32 s34, 0
    s_cbranch_scc1 L_w107
L_wd108:
L_H0_key:
    buffer_load_dword v44, v42, s[36:39], s14 offen sc1
    buffer_load_dword v45, v43, s[36:39], s15 offen sc1
    s_waitcnt vmcnt(0)
    v_max_u32 v40, v40, v44
    v_max_u32 v41, v41, v45
    v_cmp_eq_u32 vcc, 0, v40
    s_nop 1
    v_cndmask_b32 v42, v46, v42, vcc
    v_cmp_eq_u32 vcc, 0, v41
    s_nop 1
    v_cndmask_b32 v43, v46, v43, vcc
    v_min_u32 v10, v40, v41
    v_cmp_eq_u32 vcc, 0, v10
    s_cbranch_vccz L_rd109
    s_sleep 1
    s_sub_i32 s34, s34, 16
    s_cmp_gt_i32 s34, 0
    s_cbranch_scc1 L_H0_key
L_rd109:
    v_max_u32 v8, v40, v41
    s_nop 1
    v_max_u32_dpp v8, v8, v8 quad_perm:[1,0,3,2] row_mask:0xf bank_mask:0xf
    s_nop 1
    v_max_u32_dpp v8, v8, v8 quad_perm:[2,3,0,1] row_mask:0xf bank_mask:0xf
    s_nop 1
    v_max_u32_dpp v8, v8, v8 row_half_mirror row_mask:0xf bank_mask:0xf
    s_nop 1
    v_max_u32_dpp v8, v8, v8 row_mirror row_mask:0xf bank_mask:0xf
    v_mov_b32 v9, v8
    s_nop 1
    v_permlane16_swap_b32 v8, v9
    v_max_u32 v8, v8, v9
    v_mov_b32 v9, v8
    s_nop 1
    v_permlane32_swap_b32 v8, v9
    v_max_u32 v8, v8, v9
    v_max_u32 v8, 2, v8
    s_lshl_b64 exec, 1, 47
    ds_write_b32 v1, v8
    s_mov_b64 exec, -1
    s_branch L_end
L_H_work:
    s_setprio 0
    s_sub_u32 s70, s6, 1
    s_and_b32 s71, s2, 7
    s_mul_i32 s71, s71, 24
    s_lshr_b32 s74, s2, 3
    s_add_u32 s71, s71, s74
    s_mul_i32 s74, s71, 48
    s_mul_i32 s75, s70, 1769472
    s_add_u32 s74, s74, s75
    s_mul_i32 s72, s70, 24576
    s_add_u32 s72, s72, 6144
    v_lshrrev_b32 v2, 4, v0
    v_add_u32 v3, 0, v2
    v_mul_u32_u24 v4, 171, v3
    v_lshrrev_b32 v4, 9, v4
    v_mul_u32_u24 v32, 9168, v4
    v_lshl_add_u32 v32, v3, 4, v32
    v_lshrrev_b32 v4, 3, v4
    v_mul_u32_u24 v36, 768, v4
    v_lshl_add_u32 v36, v3, 4, v36
    v_add_u32 v3, 64, v2
    v_mul_u32_u24 v4, 171, v3
    v_lshrrev_b32 v4, 9, v4
    v_mul_u32_u24 v33, 9168, v4
    v_lshl_add_u32 v33, v3, 4, v33
    v_lshrrev_b32 v4, 3, v4
    v_mul_u32_u24 v37, 768, v4
    v_lshl_add_u32 v37, v3, 4, v37
    v_add_u32 v3, 128, v2
    v_mul_u32_u24 v4, 171, v3
    v_lshrrev_b32 v4, 9, v4
    v_mul_u32_u24 v34, 9168, v4
    v_lshl_add_u32 v34, v3, 4, v34
    v_lshrrev_b32 v4, 3, v4
    v_mul_u32_u24 v38, 768, v4
    v_lshl_add_u32 v38, v3, 4, v38
    v_lshrrev_b32 v2, 8, v0
    v_bfe_u32 v3, v0, 6, 2
    v_lshl_add_u32 v2, v2, 3, v3
    v_mul_u32_u24 v3, 48, v2
    v_bfe_u32 v4, v0, 4, 1
    v_lshl_add_u32 v3, v4, 3, v3
    v_bfe_u32 v4, v0, 5, 1
    v_mul_u32_u24 v4, 3072, v4
    v_add3_u32 v3, v3, v4, s72
    v_min_u32 v2, 19, v2
    v_mul_u32_u24 v2, 384, v2
    v_bfe_u32 v4, v0, 4, 2
    v_lshl_add_u32 v2, v4, 3, v2
    s_sub_u32 s17, s72, 6144
    v_add_u32 v39, s17, v2
    v_mov_b32 v35, v3
    v_lshrrev_b32 v3, 4, v0
    v_mul_u32_u24 v4, 57, v3
    v_lshrrev_b32 v4, 9, v4
    v_mul_u32_u24 v4, 8064, v4
    v_lshl_add_u32 v3, v3, 7, v4
    s_lshr_b32 s75, s2, 3
    s_mul_i32 s75, s75, 3
    s_add_u32 s75, s75, s70
    s_mul_i32 s76, s75, 55296
    s_and_b32 s77, s2, 7
    s_mul_i32 s77, s77, 1152
    s_add_u32 s76, s76, s77
    s_mul_i32 s75, s75, 6912
    v_lshlrev_b32 v2, 3, v0
    v_mov_b32 v45, 0
    v_mov_b32 v46, 0
    v_mov_b32 v47, 0
    s_cmp_lt_u32 s66, 30
    s_cselect_b32 s16, s66, 64
    s_cmp_eq_u32 s70, 1
    s_cselect_b32 s16, s16, 64
    s_cmp_ge_u32 s16, 36
    s_cbranch_scc1 L_H_w0
    v_bfe_u32 v12, v0, 7, 1
    s_lshl_b32 s18, s16, 1
    v_add3_u32 v12, s18, v12, 0
    v_mul_u32_u24 v13, 57, v12
    v_lshrrev_b32 v13, 9, v13
    v_mul_u32_u24 v14, 9, v13
    v_sub_u32 v12, v12, v14
    v_bfe_u32 v14, v0, 4, 3
    v_cmp_eq_u32 vcc, 8, v12
    s_nop 1
    v_cndmask_b32 v15, v12, v14, vcc
    v_lshrrev_b32 v16, 1, v15
    v_lshl_add_u32 v13, v13, 2, v16
    v_mul_u32_u24 v13, 18, v13
    v_and_b32 v15, 1, v15
    v_lshl_add_u32 v14, v15, 3, v14
    v_add_u32 v15, 16, v15
    v_cndmask_b32 v14, v14, v15, vcc
    v_add_u32 v13, v13, v14
    v_mul_u32_u24 v13, 1152, v13
    v_lshrrev_b32 v14, 8, v0
    v_lshl_add_u32 v45, v14, 4, v13
    v_bfe_u32 v12, v0, 7, 1
    s_lshl_b32 s18, s16, 1
    v_add3_u32 v12, s18, v12, 12
    v_mul_u32_u24 v13, 57, v12
    v_lshrrev_b32 v13, 9, v13
    v_mul_u32_u24 v14, 9, v13
    v_sub_u32 v12, v12, v14
    v_bfe_u32 v14, v0, 4, 3
    v_cmp_eq_u32 vcc, 8, v12
    s_nop 1
    v_cndmask_b32 v15, v12, v14, vcc
    v_lshrrev_b32 v16, 1, v15
    v_lshl_add_u32 v13, v13, 2, v16
    v_mul_u32_u24 v13, 18, v13
    v_and_b32 v15, 1, v15
    v_lshl_add_u32 v14, v15, 3, v14
    v_add_u32 v15, 16, v15
    v_cndmask_b32 v14, v14, v15, vcc
    v_add_u32 v13, v13, v14
    v_mul_u32_u24 v13, 1152, v13
    v_lshrrev_b32 v14, 8, v0
    v_lshl_add_u32 v46, v14, 4, v13
    v_bfe_u32 v12, v0, 4, 1
    v_lshlrev_b32 v12, 4, v12
    v_mov_b32 v14, 0x3f80
    v_lshlrev_b32 v12, v12, v14
    v_lshrrev_b32 v14, 5, v0
    v_cmp_eq_u32 vcc, 0, v14
    s_nop 1
    v_cndmask_b32 v124, 0, v12, vcc
    v_cmp_eq_u32 vcc, 1, v14
    s_nop 1
    v_cndmask_b32 v125, 0, v12, vcc
    v_cmp_eq_u32 vcc, 2, v14
    s_nop 1
    v_cndmask_b32 v126, 0, v12, vcc
    v_cmp_eq_u32 vcc, 3, v14
    s_nop 1
    v_cndmask_b32 v127, 0, v12, vcc
    v_lshrrev_b32 v12, 9, v0
    v_and_b32 v47, 0xf0, v0
    v_lshl_add_u32 v47, v12, 8, v47
    v_bfe_u32 v12, v0, 8, 1
    v_lshl_add_u32 v47, v12, 3, v47
L_H_w0:
L_w110:
    ds_read_b32 v5, v1
    s_waitcnt lgkmcnt(0)
    v_cmp_gt_u32 vcc, 1, v5
    s_and_b32 s79, vcc_hi, 0x20
    s_cbranch_scc0 L_wd111
    s_sleep 2
    s_sub_i32 s34, s34, 9
    s_cmp_gt_i32 s34, 0
    s_cbranch_scc1 L_w110
L_wd111:
    s_setprio 3
    s_mov_b32 exec_hi, 0x3fffff
    buffer_load_dword v40, v2, s[48:51], s75 offen
    buffer_load_dword v41, v3, s[20:23], s76 offen
    buffer_load_dword v42, v3, s[24:27], s76 offen
    s_mov_b64 exec, -1
    s_mov_b32 s8, s74
    s_cmp_ge_u32 s16, 36
    s_cbranch_scc1 L_H_w2
    s_add_u32 s74, s64, 128
    buffer_load_dwordx4 v[48:51], v45, s[48:51], 0 offen offset:0
    buffer_load_dwordx4 v[52:55], v45, s[48:51], 0 offen offset:64
    buffer_load_dwordx4 v[56:59], v45, s[48:51], 0 offen offset:128
    buffer_load_dwordx4 v[60:63], v45, s[48:51], 0 offen offset:192
    buffer_load_dwordx4 v[64:67], v45, s[48:51], 0 offen offset:256
    buffer_load_dwordx4 v[68:71], v45, s[48:51], 0 offen offset:320
    buffer_load_dwordx4 v[72:75], v45, s[48:51], 0 offen offset:384
    buffer_load_dwordx4 v[76:79], v45, s[48:51], 0 offen offset:448
    buffer_load_dwordx4 v[80:83], v45, s[48:51], 0 offen offset:512
    buffer_load_dwordx4 v[84:87], v45, s[48:51], 0 offen offset:576
    buffer_load_dwordx4 v[88:91], v45, s[48:51], 0 offen offset:640
    buffer_load_dwordx4 v[92:95], v45, s[48:51], 0 offen offset:704
    buffer_load_dwordx4 v[96:99], v45, s[48:51], 0 offen offset:768
    buffer_load_dwordx4 v[100:103], v45, s[48:51], 0 offen offset:832
    buffer_load_dwordx4 v[104:107], v45, s[48:51], 0 offen offset:896
    buffer_load_dwordx4 v[108:111], v45, s[48:51], 0 offen offset:960
    buffer_load_dwordx4 v[112:115], v45, s[48:51], 0 offen offset:1024
    buffer_load_dwordx4 v[116:119], v45, s[48:51], 0 offen offset:1088
    buffer_load_dwordx4 v[120:123], v45, s[48:51], s74 offen
L_H_w2:
    v_mov_b32 v8, -1
    v_mov_b32 v9, -1
    v_mov_b32 v10, -1
    v_mov_b32 v11, -1
    v_readlane_b32 s18, v5, 12
    s_lshl_b32 s9, s4, 3
    s_add_u32 s9, s9, s5
    s_lshl_b32 s75, s9, 12
    s_add_u32 s75, s75, 11763712
    s_lshl_b32 s9, s9, 7
    s_add_u32 s9, s9, 327680
    buffer_load_dword v28, off, s[36:39], s9 offset:36 sc1
    s_lshl_b32 s74, s5, 15
    s_add_u32 s74, s74, s65
    s_mul_i32 s76, s70, 12
    s_add_u32 s77, s76, 12
    s_cmp_eq_u32 s5, 7
    s_cselect_b32 s19, 8, 32
    s_mul_i32 s18, s18, s19
L_H_rst:
    s_cmp_lt_u32 s76, 32
    s_cselect_b32 s78, s74, s75
    s_lshl_b32 s79, s76, 10
    s_add_u32 s78, s78, s79
    s_cmp_lt_u32 s76, s18
    s_cbranch_scc1 L_H_rp
    buffer_store_dwordx4 v[8:11], v0, s[36:39], s78 offen sc1
    s_branch L_H_rn
L_H_rp:
    buffer_store_dwordx4 v[8:11], v0, s[36:39], s78 offen
L_H_rn:
    s_add_u32 s76, s76, 1
    s_cmp_lt_u32 s76, s77
    s_cbranch_scc1 L_H_rst
    s_cmp_ge_u32 s16, 36
    s_cbranch_scc1 L_H_w5
L_H_w6:
    s_waitcnt vmcnt(0)
    v_mfma_f32_16x16x32_bf16 v[16:19], v[48:51], v[132:135], 0
    v_mfma_f32_16x16x32_bf16 v[20:23], v[52:55], v[132:135], 0
    v_mfma_f32_16x16x32_bf16 v[16:19], v[56:59], v[136:139], v[16:19]
    v_mfma_f32_16x16x32_bf16 v[20:23], v[60:63], v[136:139], v[20:23]
    v_mfma_f32_16x16x32_bf16 v[16:19], v[64:67], v[140:143], v[16:19]
    v_mfma_f32_16x16x32_bf16 v[20:23], v[68:71], v[140:143], v[20:23]
    v_mfma_f32_16x16x32_bf16 v[16:19], v[72:75], v[144:147], v[16:19]
    v_mfma_f32_16x16x32_bf16 v[20:23], v[76:79], v[144:147], v[20:23]
    v_mfma_f32_16x16x32_bf16 v[16:19], v[80:83], v[148:151], v[16:19]
    v_mfma_f32_16x16x32_bf16 v[20:23], v[84:87], v[148:151], v[20:23]
    v_mfma_f32_16x16x32_bf16 v[16:19], v[88:91], v[152:155], v[16:19]
    v_mfma_f32_16x16x32_bf16 v[20:23], v[92:95], v[152:155], v[20:23]
    v_mfma_f32_16x16x32_bf16 v[16:19], v[96:99], v[156:159], v[16:19]
    v_mfma_f32_16x16x32_bf16 v[20:23], v[100:103], v[156:159], v[20:23]
    v_mfma_f32_16x16x32_bf16 v[16:19], v[104:107], v[160:163], v[16:19]
    v_mfma_f32_16x16x32_bf16 v[20:23], v[108:111], v[160:163], v[20:23]
    v_mfma_f32_16x16x32_bf16 v[16:19], v[112:115], v[164:167], v[16:19]
    v_mfma_f32_16x16x32_bf16 v[20:23], v[116:119], v[164:167], v[20:23]
    v_mfma_f32_16x16x32_bf16 v[24:27], v[120:123], v[124:127], 0
    s_mul_i32 s74, s5, 18432
    s_lshl_b32 s75, s16, 9
    s_add_u32 s74, s74, s75
    s_add_u32 s75, s74, 458752
    s_nop 3
    v_add_f32_dpp v24, v16, v20 row_shr:8 row_mask:0xf bank_mask:0xc
    v_add_f32_dpp v25, v17, v21 row_shr:8 row_mask:0xf bank_mask:0xc
    v_add_f32_dpp v26, v18, v22 row_shr:8 row_mask:0xf bank_mask:0xc
    v_add_f32_dpp v27, v19, v23 row_shr:8 row_mask:0xf bank_mask:0xc
    v_cvt_pk_bf16_f32 v24, v24, v25
    v_cvt_pk_bf16_f32 v25, v26, v27
    buffer_store_dwordx2 v[24:25], v47, s[36:39], s75 offen sc1
    s_add_u32 s16, s16, 6
    s_cmp_lt_u32 s16, 30
    s_cselect_b32 s16, 64, s16
    s_cmp_ge_u32 s16, 36
    s_cbranch_scc1 L_H_w5
    v_mov_b32 v45, v46
    s_add_u32 s74, s64, 128
    buffer_load_dwordx4 v[48:51], v45, s[48:51], 0 offen offset:0
    buffer_load_dwordx4 v[52:55], v45, s[48:51], 0 offen offset:64
    buffer_load_dwordx4 v[56:59], v45, s[48:51], 0 offen offset:128
    buffer_load_dwordx4 v[60:63], v45, s[48:51], 0 offen offset:192
    buffer_load_dwordx4 v[64:67], v45, s[48:51], 0 offen offset:256
    buffer_load_dwordx4 v[68:71], v45, s[48:51], 0 offen offset:320
    buffer_load_dwordx4 v[72:75], v45, s[48:51], 0 offen offset:384
    buffer_load_dwordx4 v[76:79], v45, s[48:51], 0 offen offset:448
    buffer_load_dwordx4 v[80:83], v45, s[48:51], 0 offen offset:512
    buffer_load_dwordx4 v[84:87], v45, s[48:51], 0 offen offset:576
    buffer_load_dwordx4 v[88:91], v45, s[48:51], 0 offen offset:640
    buffer_load_dwordx4 v[92:95], v45, s[48:51], 0 offen offset:704
    buffer_load_dwordx4 v[96:99], v45, s[48:51], 0 offen offset:768
    buffer_load_dwordx4 v[100:103], v45, s[48:51], 0 offen offset:832
    buffer_load_dwordx4 v[104:107], v45, s[48:51], 0 offen offset:896
    buffer_load_dwordx4 v[108:111], v45, s[48:51], 0 offen offset:960
    buffer_load_dwordx4 v[112:115], v45, s[48:51], 0 offen offset:1024
    buffer_load_dwordx4 v[116:119], v45, s[48:51], 0 offen offset:1088
    buffer_load_dwordx4 v[120:123], v45, s[48:51], s74 offen
    s_branch L_H_w6
L_H_w5:
    s_cmp_lg_u32 s70, 2
    s_cbranch_scc1 L_H_r2
    buffer_load_dwordx4 v[12:15], v0, s[56:59], 0 offen
    buffer_load_dwordx4 v[16:19], v0, s[56:59], 0 offen offset:1024
    buffer_load_dwordx4 v[20:23], v0, s[56:59], s64 offen
    v_mov_b32 v24, 0
    v_mov_b32 v25, 0
    v_mov_b32 v26, 0
    v_mov_b32 v27, 0
    s_add_u32 s76, s9, 32768
    s_lshl_b32 s74, s4, 9
    s_add_u32 s74, s74, 393216
    s_add_u32 s75, s74, 16384
    s_mov_b64 exec, 0xff
    buffer_store_dwordx4 v[24:27], v0, s[36:39], s76 offen sc1
    s_cmp_lg_u32 s5, 7
    s_cbranch_scc1 L_H3k
    s_mov_b32 exec_lo, -1
    buffer_store_dwordx4 v[24:27], v0, s[36:39], s74 offen sc1
    buffer_store_dwordx4 v[24:27], v0, s[36:39], s75 offen sc1
L_H3k:
    s_mov_b64 exec, -1
    v_mov_b32 v6, 0x3f803f80
    v_mov_b32 v7, 0
    s_waitcnt vmcnt(0)
    v_dot2c_f32_bf16 v7, v12, v6
    v_dot2c_f32_bf16 v7, v13, v6
    v_dot2c_f32_bf16 v7, v14, v6
    v_dot2c_f32_bf16 v7, v15, v6
    v_dot2c_f32_bf16 v7, v16, v6
    v_dot2c_f32_bf16 v7, v17, v6
    v_dot2c_f32_bf16 v7, v18, v6
    v_dot2c_f32_bf16 v7, v19, v6
    s_nop 2
    v_add_f32_dpp v7, v7, v7 quad_perm:[1,0,3,2] row_mask:0xf bank_mask:0xf
    s_nop 1
    v_add_f32_dpp v7, v7, v7 quad_perm:[2,3,0,1] row_mask:0xf bank_mask:0xf
    s_nop 1
    v_add_f32_dpp v7, v7, v7 row_half_mirror row_mask:0xf bank_mask:0xf
    s_nop 1
    v_add_f32_dpp v7, v7, v7 row_mirror row_mask:0xf bank_mask:0xf
    v_mov_b32 v5, v7
    s_nop 1
    v_permlane16_swap_b32 v7, v5
    v_add_f32 v7, v7, v5
    v_mov_b32 v5, v7
    s_nop 1
    v_permlane32_swap_b32 v7, v5
    v_add_f32 v7, v7, v5
    v_add_u32 v2, 159296, v0
    v_mov_b32 v3, 159456
    s_mov_b64 exec, 0x1ff
    ds_write_b128 v2, v[20:23]
    ds_write_b32 v3, v7
    s_mov_b64 exec, -1
L_H_r2:
    s_waitcnt vmcnt(0)
    s_cmp_ge_u32 s66, 24
    s_cselect_b32 s74, 64, 1
    s_add_u32 s79, s70, 8
    s_lshl_b64 exec, 1, s79
    v_mov_b32 v5, s74
    ds_write_b32 v1, v5
    s_mov_b64 exec, -1
    s_cmp_lg_u32 s70, 1
    s_cbranch_scc1 L_H_r3
L_w112:
    ds_read_b32 v5, v1
    s_waitcnt lgkmcnt(0)
    v_cmp_gt_u32 vcc, 1, v5
    s_and_b32 s79, vcc_lo, 0x700
    s_cbranch_scc0 L_wd113
    s_sleep 4
    s_sub_i32 s34, s34, 17
    s_cmp_gt_i32 s34, 0
    s_cbranch_scc1 L_w112
L_wd113:
    v_add_u32 v28, 2654435769, v28
    s_mov_b64 exec, 1
    buffer_store_dword v28, off, s[36:39], s9 offset:32 sc1
    s_mov_b64 exec, -1
L_H_r3:
    s_cmp_ge_u32 s66, 24
    s_cbranch_scc1 L_H_free
    s_mov_b32 s74, s8
    s_add_u32 m0, s72, 0
    s_nop 0
    buffer_load_dwordx4 v32, s[20:23], s74 offen lds
    s_add_u32 m0, s72, 3072
    s_nop 0
    buffer_load_dwordx4 v32, s[24:27], s74 offen lds
    s_add_u32 m0, s72, 1024
    s_nop 0
    buffer_load_dwordx4 v33, s[20:23], s74 offen lds
    s_add_u32 m0, s72, 4096
    s_nop 0
    buffer_load_dwordx4 v33, s[24:27], s74 offen lds
    s_add_u32 m0, s72, 2048
    s_nop 0
    buffer_load_dwordx4 v34, s[20:23], s74 offen lds
    s_add_u32 m0, s72, 5120
    s_nop 0
    buffer_load_dwordx4 v34, s[24:27], s74 offen lds
    s_add_u32 s74, s74, 589824
    s_add_u32 m0, s72, 6144
    s_nop 0
    buffer_load_dwordx4 v32, s[20:23], s74 offen lds
    s_add_u32 m0, s72, 9216
    s_nop 0
    buffer_load_dwordx4 v32, s[24:27], s74 offen lds
    s_add_u32 m0, s72, 7168
    s_nop 0
    buffer_load_dwordx4 v33, s[20:23], s74 offen lds
    s_add_u32 m0, s72, 10240
    s_nop 0
    buffer_load_dwordx4 v33, s[24:27], s74 offen lds
    s_add_u32 m0, s72, 8192
    s_nop 0
    buffer_load_dwordx4 v34, s[20:23], s74 offen lds
    s_add_u32 m0, s72, 11264
    s_nop 0
    buffer_load_dwordx4 v34, s[24:27], s74 offen lds
    s_add_u32 s74, s74, 589824
    s_add_u32 m0, s72, 12288
    s_nop 0
    buffer_load_dwordx4 v32, s[20:23], s74 offen lds
    s_add_u32 m0, s72, 15360
    s_nop 0
    buffer_load_dwordx4 v32, s[24:27], s74 offen lds
    s_add_u32 m0, s72, 13312
    s_nop 0
    buffer_load_dwordx4 v33, s[20:23], s74 offen lds
    s_add_u32 m0, s72, 16384
    s_nop 0
    buffer_load_dwordx4 v33, s[24:27], s74 offen lds
    s_add_u32 m0, s72, 14336
    s_nop 0
    buffer_load_dwordx4 v34, s[20:23], s74 offen lds
    s_add_u32 m0, s72, 17408
    s_nop 0
    buffer_load_dwordx4 v34, s[24:27], s74 offen lds
    s_mul_i32 s74, s71, 27648
    s_mul_i32 s76, s70, 384
    s_add_u32 s74, s74, s76
    s_add_u32 m0, s17, 0
    s_nop 0
    buffer_load_dwordx4 v36, s[60:63], s74 offen nt lds
    s_add_u32 m0, s17, 1024
    s_nop 0
    buffer_load_dwordx4 v37, s[60:63], s74 offen nt lds
    s_add_u32 m0, s17, 2048
    s_nop 0
    buffer_load_dwordx4 v38, s[60:63], s74 offen nt lds
    s_add_u32 s74, s74, 9216
    s_add_u32 m0, s17, 3072
    s_nop 0
    buffer_load_dwordx4 v36, s[60:63], s74 offen nt lds
    s_add_u32 m0, s17, 4096
    s_nop 0
    buffer_load_dwordx4 v37, s[60:63], s74 offen nt lds
    s_add_u32 m0, s17, 5120
    s_nop 0
    buffer_load_dwordx4 v38, s[60:63], s74 offen nt lds
    s_waitcnt vmcnt(18)
    ds_read_b64_tr_b16 v[48:49], v35 offset:0
    ds_read_b64_tr_b16 v[50:51], v35 offset:192
    ds_read_b64_tr_b16 v[52:53], v35 offset:16
    ds_read_b64_tr_b16 v[54:55], v35 offset:208
    ds_read_b64_tr_b16 v[56:57], v35 offset:32
    ds_read_b64_tr_b16 v[58:59], v35 offset:224
    ds_read_b64_tr_b16 v[60:61], v35 offset:1536
    ds_read_b64_tr_b16 v[62:63], v35 offset:1728
    ds_read_b64_tr_b16 v[64:65], v35 offset:1552
    ds_read_b64_tr_b16 v[66:67], v35 offset:1744
    ds_read_b64_tr_b16 v[68:69], v35 offset:1568
    ds_read_b64_tr_b16 v[70:71], v35 offset:1760
    s_waitcnt lgkmcnt(0)
    s_add_u32 s74, s74, 9216
    s_add_u32 m0, s17, 6144
    s_nop 0
    buffer_load_dwordx4 v36, s[60:63], s74 offen nt lds
    s_add_u32 m0, s17, 7168
    s_nop 0
    buffer_load_dwordx4 v37, s[60:63], s74 offen nt lds
    s_add_u32 m0, s17, 8192
    s_nop 0
    buffer_load_dwordx4 v38, s[60:63], s74 offen nt lds
    s_waitcnt vmcnt(15)
    ds_read_b64_tr_b16 v[72:73], v35 offset:6144
    ds_read_b64_tr_b16 v[74:75], v35 offset:6336
    ds_read_b64_tr_b16 v[76:77], v35 offset:6160
    ds_read_b64_tr_b16 v[78:79], v35 offset:6352
    ds_read_b64_tr_b16 v[80:81], v35 offset:6176
    ds_read_b64_tr_b16 v[82:83], v35 offset:6368
    ds_read_b64_tr_b16 v[84:85], v35 offset:7680
    ds_read_b64_tr_b16 v[86:87], v35 offset:7872
    ds_read_b64_tr_b16 v[88:89], v35 offset:7696
    ds_read_b64_tr_b16 v[90:91], v35 offset:7888
    ds_read_b64_tr_b16 v[92:93], v35 offset:7712
    ds_read_b64_tr_b16 v[94:95], v35 offset:7904
    s_waitcnt lgkmcnt(0)
    s_waitcnt vmcnt(9)
    ds_read_b64_tr_b16 v[96:97], v35 offset:12288
    ds_read_b64_tr_b16 v[98:99], v35 offset:12480
    ds_read_b64_tr_b16 v[100:101], v35 offset:12304
    ds_read_b64_tr_b16 v[102:103], v35 offset:12496
    ds_read_b64_tr_b16 v[104:105], v35 offset:12320
    ds_read_b64_tr_b16 v[106:107], v35 offset:12512
    ds_read_b64_tr_b16 v[108:109], v35 offset:13824
    ds_read_b64_tr_b16 v[110:111], v35 offset:14016
    ds_read_b64_tr_b16 v[112:113], v35 offset:13840
    ds_read_b64_tr_b16 v[114:115], v35 offset:14032
    ds_read_b64_tr_b16 v[116:117], v35 offset:13856
    ds_read_b64_tr_b16 v[118:119], v35 offset:14048
    s_waitcnt lgkmcnt(0)
    s_waitcnt vmcnt(0)
    ds_read_b64_tr_b16 v[120:121], v39 offset:0
    ds_read_b64_tr_b16 v[122:123], v39 offset:1536
    ds_read_b64_tr_b16 v[124:125], v39 offset:32
    ds_read_b64_tr_b16 v[126:127], v39 offset:1568
    ds_read_b64_tr_b16 v[128:129], v39 offset:64
    ds_read_b64_tr_b16 v[130:131], v39 offset:1600
    ds_read_b64_tr_b16 v[132:133], v39 offset:96
    ds_read_b64_tr_b16 v[134:135], v39 offset:1632
    ds_read_b64_tr_b16 v[136:137], v39 offset:128
    ds_read_b64_tr_b16 v[138:139], v39 offset:1664
    ds_read_b64_tr_b16 v[140:141], v39 offset:160
    ds_read_b64_tr_b16 v[142:143], v39 offset:1696
    s_waitcnt lgkmcnt(0)
    ds_read_b64_tr_b16 v[144:145], v39 offset:192
    ds_read_b64_tr_b16 v[146:147], v39 offset:1728
    ds_read_b64_tr_b16 v[148:149], v39 offset:224
    ds_read_b64_tr_b16 v[150:151], v39 offset:1760
    ds_read_b64_tr_b16 v[152:153], v39 offset:256
    ds_read_b64_tr_b16 v[154:155], v39 offset:1792
    ds_read_b64_tr_b16 v[156:157], v39 offset:288
    ds_read_b64_tr_b16 v[158:159], v39 offset:1824
    ds_read_b64_tr_b16 v[160:161], v39 offset:320
    ds_read_b64_tr_b16 v[162:163], v39 offset:1856
    ds_read_b64_tr_b16 v[164:165], v39 offset:352
    ds_read_b64_tr_b16 v[166:167], v39 offset:1888
    s_waitcnt lgkmcnt(0)
    s_add_u32 s79, s70, 8
    s_lshl_b64 exec, 1, s79
    v_mov_b32 v5, 64
    ds_write_b32 v1, v5
    s_mov_b64 exec, -1
    s_lshl_b32 s75, s70, 10
    s_add_u32 s75, s75, 160512
    v_lshrrev_b32 v2, 8, v0
    v_lshlrev_b32 v6, 6, v2
    v_lshlrev_b32 v2, 4, v2
    v_add_u32 v3, s75, v2
    v_min_u32 v4, 128, v6
    v_bfe_u32 v5, v0, 4, 3
    v_lshl_add_u32 v4, v5, 2, v4
    v_add_u32 v4, 160512, v4
    v_sub_u32 v5, v0, v6
L_F_layer:
    s_lshl_b32 s74, s35, 4
    s_add_u32 s74, s74, 11
    s_lshl_b32 s75, 16384, s35
L_w114:
    ds_read_b32 v7, v1
    s_waitcnt lgkmcnt(0)
    v_cmp_gt_u32 vcc, s74, v7
    s_and_b32 s79, vcc_lo, 0xff
    s_cbranch_scc0 L_wd115
    s_sleep 24
    s_sub_i32 s34, s34, 97
    s_cmp_gt_i32 s34, 0
    s_cbranch_scc1 L_w114
L_wd115:
    s_add_u32 s74, s35, 2
L_w116:
    ds_read_b32 v7, v1
    s_waitcnt lgkmcnt(0)
    v_cmp_gt_u32 vcc, s74, v7
    s_and_b32 s79, vcc_hi, 0x3c0
    s_cbranch_scc0 L_wd117
    s_sleep 6
    s_sub_i32 s34, s34, 25
    s_cmp_gt_i32 s34, 0
    s_cbranch_scc1 L_w116
L_wd117:
L_w118:
    ds_read_b32 v7, v1
    s_waitcnt lgkmcnt(0)
    v_cmp_gt_u32 vcc, 1, v7
    s_and_b32 s79, vcc_hi, s75
    s_cbranch_scc0 L_wd119
    s_sub_i32 s34, s34, 1
    s_cmp_gt_i32 s34, 0
    s_cbranch_scc1 L_w118
L_wd119:
    s_add_u32 s79, s35, 46
    v_readlane_b32 s73, v7, s79
    s_and_b32 s67, s73, 0x7ff
    s_xor_b32 s67, s67, 0x7ff
    s_lshr_b32 s74, s67, 6
    s_mul_i32 s74, s74, 335872
    s_bfe_u32 s79, s67, 0x20004
    s_mul_i32 s79, s79, 2304
    s_add_u32 s74, s74, s79
    s_mul_i32 s79, s35, 9216
    s_add_u32 s74, s74, s79
    s_add_u32 s74, s74, 1286144
    s_mul_i32 s75, s70, 384
    s_add_u32 s74, s74, s75
L_F_row:
    buffer_load_dwordx4 v[8:11], v2, s[36:39], s74 offen offset:0 sc1
    buffer_load_dwordx4 v[12:15], v2, s[36:39], s74 offen offset:64 sc1
    buffer_load_dwordx4 v[16:19], v2, s[36:39], s74 offen offset:128 sc1
    buffer_load_dwordx4 v[20:23], v2, s[36:39], s74 offen offset:192 sc1
    buffer_load_dwordx4 v[24:27], v2, s[36:39], s74 offen offset:256 sc1
    buffer_load_dwordx4 v[28:31], v2, s[36:39], s74 offen offset:320 sc1
    s_and_b32 s75, s73, 0xffff0000
    s_ashr_i32 s76, s75, 31
    s_not_b32 s76, s76
    s_or_b32 s76, s76, 0x80000000
    s_xor_b32 s75, s75, s76
    s_and_b32 s75, s75, 0xffff0000
    v_mov_b32 v45, 0xbfb8aa3b
    v_mul_f32 v44, s75, v45
    v_exp_f32 v44, v44
    s_add_u32 s18, s35, 1
    s_waitcnt vmcnt(0)
    v_mfma_f32_16x16x32_bf16 v[32:35], v[48:51], v[8:11], 0
    v_max3_u32 v7, v8, v9, v10
    v_mfma_f32_16x16x32_bf16 v[36:39], v[52:55], v[8:11], 0
    v_max3_u32 v7, v7, v11, v12
    v_mfma_f32_16x16x32_bf16 v[40:43], v[56:59], v[8:11], 0
    v_max3_u32 v7, v7, v13, v14
    v_mfma_f32_16x16x32_bf16 v[32:35], v[60:63], v[12:15], v[32:35]
    v_max3_u32 v7, v7, v15, v16
    v_mfma_f32_16x16x32_bf16 v[36:39], v[64:67], v[12:15], v[36:39]
    v_max3_u32 v7, v7, v17, v18
    v_mfma_f32_16x16x32_bf16 v[40:43], v[68:71], v[12:15], v[40:43]
    v_max3_u32 v7, v7, v19, v20
    v_mfma_f32_16x16x32_bf16 v[32:35], v[72:75], v[16:19], v[32:35]
    v_max3_u32 v7, v7, v21, v22
    v_mfma_f32_16x16x32_bf16 v[36:39], v[76:79], v[16:19], v[36:39]
    v_max3_u32 v7, v7, v23, v24
    v_mfma_f32_16x16x32_bf16 v[40:43], v[80:83], v[16:19], v[40:43]
    v_max3_u32 v7, v7, v25, v26
    v_mfma_f32_16x16x32_bf16 v[32:35], v[84:87], v[20:23], v[32:35]
    v_max3_u32 v7, v7, v27, v28
    v_mfma_f32_16x16x32_bf16 v[36:39], v[88:91], v[20:23], v[36:39]
    v_max3_u32 v7, v7, v29, v30
    v_mfma_f32_16x16x32_bf16 v[40:43], v[92:95], v[20:23], v[40:43]
    v_max_u32 v7, v7, v31
    v_mfma_f32_16x16x32_bf16 v[32:35], v[96:99], v[24:27], v[32:35]
    v_cmp_eq_u32 vcc, -1, v7
    v_mfma_f32_16x16x32_bf16 v[36:39], v[100:103], v[24:27], v[36:39]
    v_add_f32 v46, 1.0, v44
    v_mfma_f32_16x16x32_bf16 v[40:43], v[104:107], v[24:27], v[40:43]
    v_mfma_f32_16x16x32_bf16 v[32:35], v[108:111], v[28:31], v[32:35]
    v_mfma_f32_16x16x32_bf16 v[36:39], v[112:115], v[28:31], v[36:39]
    v_mfma_f32_16x16x32_bf16 v[40:43], v[116:119], v[28:31], v[40:43]
    s_cbranch_vccz L_rd120
    s_sub_i32 s34, s34, 16
    s_cmp_gt_i32 s34, 0
    s_cbranch_scc1 L_F_row
L_rd120:
    s_mul_i32 s74, s35, 442368
    s_mul_i32 s75, s71, 2304
    s_add_u32 s74, s74, s75
    s_mul_i32 s75, s70, 768
    s_add_u32 s74, s74, s75
    s_add_u32 s74, s74, 11796480
    v_add_u32 v6, 1024, v4
    v_add_u32 v47, 2048, v4
    s_mov_b32 exec_lo, 0x00010001
    s_mov_b32 exec_hi, 0x00010001
    ds_write_b128 v3, v[32:35] offset:0
    ds_write_b128 v3, v[36:39] offset:64
    ds_write_b128 v3, v[40:43] offset:128
    s_add_u32 s79, s70, 48
    s_lshl_b64 exec, 1, s79
    v_mov_b32 v7, s18
    ds_write_b32 v1, v7
    s_mov_b64 exec, -1
L_F_sum:
    ds_read_b32 v7, v1
    ds_read2_b32 v[8:9], v4 offset0:0 offset1:8
    ds_read2_b32 v[10:11], v6 offset0:0 offset1:8
    ds_read2_b32 v[12:13], v47 offset0:0 offset1:8
    v_mov_b32 v16, 0
    v_mov_b32 v17, 0
    v_mov_b32 v18, 0
    v_mov_b32 v19, 0
    v_mov_b32 v20, 0
    v_mov_b32 v21, 0
    v_mov_b32 v22, 0
    v_mov_b32 v23, 0
    v_mov_b32 v24, 0
    v_mov_b32 v25, 0
    v_mov_b32 v26, 0
    v_mov_b32 v27, 0
    s_mov_b32 s76, 0xaaaaaaaa
    s_mov_b32 s77, s76
    s_mov_b32 s14, 0xcccccccc
    s_mov_b32 s15, s14
    s_waitcnt lgkmcnt(0)
    v_cmp_gt_u32 vcc, s18, v7
    v_add_f32 v8, v8, v10
    v_add_f32 v9, v9, v11
    s_and_b32 vcc_lo, vcc_hi, 458752
    s_mov_b32 vcc_hi, 0
    s_cbranch_vccz L_rd121
    s_sub_i32 s34, s34, 16
    s_cmp_gt_i32 s34, 0
    s_cbranch_scc1 L_F_sum
L_rd121:
    v_add_f32 v8, v8, v12
    v_add_f32 v9, v9, v13
    v_mul_f32 v10, v8, v45
    v_exp_f32 v10, v10
    v_mul_f32 v8, v8, v9
    v_fma_f32 v10, v10, v46, v46
    v_rcp_f32 v10, v10
    s_nop 0
    v_mul_f32 v8, v8, v10
    s_nop 1
    v_mov_b32_dpp v9, v8 quad_perm:[1,0,3,2] row_mask:0xf bank_mask:0xf
    v_cvt_pk_bf16_f32 v8, v8, v9
    s_nop 1
    v_mov_b32_dpp v16, v8 row_newbcast:0 row_mask:0x7 bank_mask:0x1
    v_mov_b32_dpp v17, v8 row_newbcast:2 row_mask:0x7 bank_mask:0x1
    v_mov_b32_dpp v18, v8 row_newbcast:4 row_mask:0x7 bank_mask:0x1
    v_mov_b32_dpp v19, v8 row_newbcast:6 row_mask:0x7 bank_mask:0x1
    v_mov_b32_dpp v20, v8 row_newbcast:0 row_mask:0x7 bank_mask:0x2
    v_mov_b32_dpp v21, v8 row_newbcast:2 row_mask:0x7 bank_mask:0x2
    v_mov_b32_dpp v22, v8 row_newbcast:4 row_mask:0x7 bank_mask:0x2
    v_mov_b32_dpp v23, v8 row_newbcast:6 row_mask:0x7 bank_mask:0x2
    v_mfma_f32_16x16x32_bf16 v[28:31], v[120:123], v[16:19], 0
    v_mfma_f32_16x16x32_bf16 v[32:35], v[124:127], v[16:19], 0
    v_mfma_f32_16x16x32_bf16 v[36:39], v[128:131], v[16:19], 0
    v_mfma_f32_16x16x32_bf16 v[40:43], v[132:135], v[16:19], 0
    v_mov_b32_dpp v24, v8 row_newbcast:0 row_mask:0x7 bank_mask:0x4
    v_mov_b32_dpp v25, v8 row_newbcast:2 row_mask:0x7 bank_mask:0x4
    v_mov_b32_dpp v26, v8 row_newbcast:4 row_mask:0x7 bank_mask:0x4
    v_mov_b32_dpp v27, v8 row_newbcast:6 row_mask:0x7 bank_mask:0x4
    v_mfma_f32_16x16x32_bf16 v[28:31], v[136:139], v[20:23], v[28:31]
    v_mfma_f32_16x16x32_bf16 v[32:35], v[140:143], v[20:23], v[32:35]
    v_mfma_f32_16x16x32_bf16 v[36:39], v[144:147], v[20:23], v[36:39]
    v_mfma_f32_16x16x32_bf16 v[40:43], v[148:151], v[20:23], v[40:43]
    v_mfma_f32_16x16x32_bf16 v[28:31], v[152:155], v[24:27], v[28:31]
    v_mfma_f32_16x16x32_bf16 v[32:35], v[156:159], v[24:27], v[32:35]
    v_mfma_f32_16x16x32_bf16 v[36:39], v[160:163], v[24:27], v[36:39]
    v_mfma_f32_16x16x32_bf16 v[40:43], v[164:167], v[24:27], v[40:43]
    s_nop 5
    v_cndmask_b32 v28, v28, v32, s[76:77]
    v_cndmask_b32 v29, v29, v33, s[76:77]
    v_cndmask_b32 v30, v30, v34, s[76:77]
    v_cndmask_b32 v31, v31, v35, s[76:77]
    v_cndmask_b32 v36, v36, v40, s[76:77]
    v_cndmask_b32 v37, v37, v41, s[76:77]
    v_cndmask_b32 v38, v38, v42, s[76:77]
    v_cndmask_b32 v39, v39, v43, s[76:77]
    v_cndmask_b32 v24, v28, v36, s[14:15]
    v_cndmask_b32 v25, v29, v37, s[14:15]
    v_cndmask_b32 v26, v30, v38, s[14:15]
    v_cndmask_b32 v27, v31, v39, s[14:15]
    s_mov_b32 exec_lo, 0x0fff0fff
    s_mov_b32 exec_hi, 0x0fff0fff
    buffer_store_dwordx4 v[24:27], v5, s[36:39], s74 offen sc1
    s_mov_b64 exec, -1
    s_cmp_lg_u32 s35, 0
    s_cbranch_scc1 L_end
    s_mov_b32 s35, 1
    s_branch L_F_layer
L_H_free:
    s_cmp_ge_u32 s66, 30
    s_cbranch_scc1 L_R_start
    s_sub_u32 s72, s66, 24
    s_lshl_b32 s72, s72, 3
    s_add_u32 s72, s72, s5
    s_mul_i32 s71, s72, 3
    s_add_u32 s71, s71, s70
    s_lshl_b32 s9, s71, 3
    s_mul_i32 s74, s71, 1366
    s_lshr_b32 s74, s74, 16
    s_mul_i32 s74, s74, 48
    s_sub_u32 s75, s71, s74
    s_and_b32 s76, s75, 3
    s_mul_i32 s76, s76, 12
    s_lshr_b32 s75, s75, 2
    s_add_u32 s74, s74, s75
    s_add_u32 s71, s74, s76
    v_mul_u32_u24 v6, 144, v0
L_Z_layer:
    s_lshl_b32 s74, s35, 4
    s_add_u32 s74, s74, 11
    s_lshl_b32 s75, 16384, s35
L_w122:
    ds_read_b32 v5, v1
    s_waitcnt lgkmcnt(0)
    v_cmp_gt_u32 vcc, s74, v5
    s_and_b32 s79, vcc_lo, 0xff
    s_cbranch_scc0 L_wd123
    s_sleep 24
    s_sub_i32 s34, s34, 97
    s_cmp_gt_i32 s34, 0
    s_cbranch_scc1 L_w122
L_wd123:
    s_add_u32 s74, s35, 2
L_w124:
    ds_read_b32 v5, v1
    s_waitcnt lgkmcnt(0)
    v_cmp_gt_u32 vcc, s74, v5
    s_and_b32 s79, vcc_hi, 0x3c0
    s_cbranch_scc0 L_wd125
    s_sleep 6
    s_sub_i32 s34, s34, 25
    s_cmp_gt_i32 s34, 0
    s_cbranch_scc1 L_w124
L_wd125:
L_w126:
    ds_read_b32 v5, v1
    s_waitcnt lgkmcnt(0)
    v_cmp_gt_u32 vcc, 1, v5
    s_and_b32 s79, vcc_hi, s75
    s_cbranch_scc0 L_wd127
    s_sub_i32 s34, s34, 1
    s_cmp_gt_i32 s34, 0
    s_cbranch_scc1 L_w126
L_wd127:
    s_add_u32 s79, s35, 46
    v_readlane_b32 s73, v5, s79
    s_and_b32 s67, s73, 0x7ff
    s_xor_b32 s67, s67, 0x7ff
    s_lshr_b32 s75, s67, 6
    s_mul_i32 s75, s75, 335872
    s_bfe_u32 s79, s67, 0x20004
    s_mul_i32 s79, s79, 2304
    s_add_u32 s75, s75, s79
    s_mul_i32 s79, s35, 9216
    s_add_u32 s75, s75, s79
    s_add_u32 s75, s75, 1286144
    s_add_u32 s75, s75, s9
    s_lshl_b32 s74, s71, 4
    s_mul_i32 s76, s35, 442368
    s_add_u32 s74, s74, s76
    s_add_u32 s74, s74, 11796480
    s_add_u32 s76, s74, 147456
    s_add_u32 s77, s74, 294912
L_Z_x:
    buffer_load_dwordx2 v[34:35], off, s[36:39], s75 sc1
    buffer_load_dwordx2 v[36:37], off, s[36:39], s75 offset:1152 sc1
    s_waitcnt vmcnt(0)
    v_max3_u32 v5, v34, v35, v36
    v_max_u32 v5, v5, v37
    v_cmp_eq_u32 vcc, -1, v5
    s_cbranch_vccz L_rd128
    s_sleep 1
    s_sub_i32 s34, s34, 16
    s_cmp_gt_i32 s34, 0
    s_cbranch_scc1 L_Z_x
L_rd128:
    v_lshlrev_b32 v38, 16, v34
    v_and_b32 v39, 0xffff0000, v34
    v_lshlrev_b32 v2, 16, v36
    v_and_b32 v3, 0xffff0000, v36
    v_add_f32 v38, v38, v2
    v_add_f32 v39, v39, v3
    v_lshlrev_b32 v40, 16, v35
    v_and_b32 v41, 0xffff0000, v35
    v_lshlrev_b32 v2, 16, v37
    v_and_b32 v3, 0xffff0000, v37
    v_add_f32 v40, v40, v2
    v_add_f32 v41, v41, v3
L_w129:
    ds_read_b32 v5, v1
    s_waitcnt lgkmcnt(0)
    v_cmp_gt_u32 vcc, 19, v5
    s_and_b32 s79, vcc_lo, 0x800
    s_cbranch_scc0 L_wd130
    s_sleep 4
    s_sub_i32 s34, s34, 17
    s_cmp_gt_i32 s34, 0
    s_cbranch_scc1 L_w129
L_wd130:
    s_sleep 30
    s_mov_b64 s[14:15], -1
    s_mov_b64 s[16:17], -1
    s_mov_b64 s[18:19], -1
L_Z_y:
    s_mov_b64 exec, s[14:15]
    s_cbranch_execz L_Z_s0
    buffer_load_dwordx4 v[60:63], v6, s[36:39], s74 offen sc1
L_Z_s0:
    s_mov_b64 exec, s[16:17]
    s_cbranch_execz L_Z_s1
    buffer_load_dwordx4 v[64:67], v6, s[36:39], s76 offen sc1
L_Z_s1:
    s_mov_b64 exec, s[18:19]
    s_cbranch_execz L_Z_s2
    buffer_load_dwordx4 v[68:71], v6, s[36:39], s77 offen sc1
L_Z_s2:
    s_mov_b64 exec, -1
    s_waitcnt vmcnt(0)
    v_max3_u32 v2, v60, v61, v62
    v_max_u32 v2, v2, v63
    v_cmp_eq_u32 s[14:15], -1, v2
    v_max3_u32 v3, v64, v65, v66
    v_max_u32 v3, v3, v67
    v_cmp_eq_u32 s[16:17], -1, v3
    v_max3_u32 v4, v68, v69, v70
    v_max_u32 v4, v4, v71
    v_cmp_eq_u32 s[18:19], -1, v4
    s_or_b64 vcc, s[14:15], s[16:17]
    s_or_b64 vcc, vcc, s[18:19]
    s_cbranch_vccz L_rd131
    s_sleep 1
    s_sub_i32 s34, s34, 16
    s_cmp_gt_i32 s34, 0
    s_cbranch_scc1 L_Z_y
L_rd131:
    v_add_f32 v60, v60, v64
    v_add_f32 v61, v61, v65
    v_add_f32 v62, v62, v66
    v_add_f32 v63, v63, v67
    v_add_f32 v60, v60, v68
    v_add_f32 v61, v61, v69
    v_add_f32 v62, v62, v70
    v_add_f32 v63, v63, v71
    v_add_f32_dpp v60, v60, v60 quad_perm:[1,0,3,2] row_mask:0xf bank_mask:0xf
    v_add_f32_dpp v61, v61, v61 quad_perm:[1,0,3,2] row_mask:0xf bank_mask:0xf
    v_add_f32_dpp v62, v62, v62 quad_perm:[1,0,3,2] row_mask:0xf bank_mask:0xf
    v_add_f32_dpp v63, v63, v63 quad_perm:[1,0,3,2] row_mask:0xf bank_mask:0xf
    v_add_f32_dpp v60, v60, v60 quad_perm:[2,3,0,1] row_mask:0xf bank_mask:0xf
    v_add_f32_dpp v61, v61, v61 quad_perm:[2,3,0,1] row_mask:0xf bank_mask:0xf
    v_add_f32_dpp v62, v62, v62 quad_perm:[2,3,0,1] row_mask:0xf bank_mask:0xf
    v_add_f32_dpp v63, v63, v63 quad_perm:[2,3,0,1] row_mask:0xf bank_mask:0xf
    v_add_f32_dpp v60, v60, v60 row_half_mirror row_mask:0xf bank_mask:0xf
    v_add_f32_dpp v61, v61, v61 row_half_mirror row_mask:0xf bank_mask:0xf
    v_add_f32_dpp v62, v62, v62 row_half_mirror row_mask:0xf bank_mask:0xf
    v_add_f32_dpp v63, v63, v63 row_half_mirror row_mask:0xf bank_mask:0xf
    v_add_f32_dpp v60, v60, v60 row_mirror row_mask:0xf bank_mask:0xf
    v_add_f32_dpp v61, v61, v61 row_mirror row_mask:0xf bank_mask:0xf
    v_add_f32_dpp v62, v62, v62 row_mirror row_mask:0xf bank_mask:0xf
    v_add_f32_dpp v63, v63, v63 row_mirror row_mask:0xf bank_mask:0xf
    v_mov_b32 v64, v60
    v_mov_b32 v65, v61
    v_mov_b32 v66, v62
    v_mov_b32 v67, v63
    v_permlane16_swap_b32 v60, v64
    v_permlane16_swap_b32 v61, v65
    v_permlane16_swap_b32 v62, v66
    v_permlane16_swap_b32 v63, v67
    v_add_f32 v60, v60, v64
    v_add_f32 v61, v61, v65
    v_add_f32 v62, v62, v66
    v_add_f32 v63, v63, v67
    v_mov_b32 v64, v60
    v_mov_b32 v65, v61
    v_mov_b32 v66, v62
    v_mov_b32 v67, v63
    v_permlane32_swap_b32 v60, v64
    v_permlane32_swap_b32 v61, v65
    v_permlane32_swap_b32 v62, v66
    v_permlane32_swap_b32 v63, v67
    v_add_f32 v60, v60, v64
    v_add_f32 v61, v61, v65
    v_add_f32 v62, v62, v66
    v_add_f32 v63, v63, v67
    v_add_f32 v38, v38, v60
    v_add_f32 v39, v39, v61
    v_add_f32 v40, v40, v62
    v_add_f32 v41, v41, v63
    v_cvt_pk_bf16_f32 v36, v38, v39
    v_cvt_pk_bf16_f32 v37, v40, v41
    s_mov_b32 s74, s9
    s_mov_b64 exec, 1
    s_cmp_eq_u32 s35, 0
    s_cbranch_scc1 L_Z_l0
    s_mul_i32 s75, s67, 1152
    s_add_u32 s74, s74, s75
    buffer_store_dwordx2 v[36:37], off, s[52:55], s74
    s_branch L_end
L_Z_l0:
    s_add_u32 s74, s74, 12681216
    buffer_store_dwordx2 v[36:37], off, s[36:39], s74 sc1
    s_mov_b64 exec, -1
    s_mov_b32 s35, 1
    s_cmp_ge_u32 s72, 32
    s_cbranch_scc1 L_Z_next
    s_cmp_eq_u32 s70, 1
    s_cbranch_scc1 L_C_start
    s_cmp_eq_u32 s70, 2
    s_cbranch_scc1 L_Z_next
L_w132:
    ds_read_b32 v5, v1
    s_waitcnt lgkmcnt(0)
    v_cmp_gt_u32 vcc, 19, v5
    s_and_b32 s79, vcc_lo, 0x800
    s_cbranch_scc0 L_wd133
    s_sleep 2
    s_sub_i32 s34, s34, 9
    s_cmp_gt_i32 s34, 0
    s_cbranch_scc1 L_w132
L_wd133:
    v_bfe_u32 v2, v0, 4, 5
    v_mul_u32_u24 v2, 36, v2
    v_lshrrev_b32 v3, 9, v0
    v_lshl_add_u32 v3, v3, 4, v2
    v_lshrrev_b32 v4, 2, v0
    v_min_u32 v4, 20, v4
    s_mov_b32 s74, 12683264
    s_mov_b32 s75, 12685312
    s_lshr_b32 s76, s67, 6
    s_cmp_eq_u32 s76, s72
    s_cselect_b32 s75, s75, s74
L_Q_poll:
    buffer_load_dwordx4 v[8:11], v3, s[36:39], s74 offen sc1
    buffer_load_dword v12, v2, s[36:39], s74 offen offset:32 sc1
    buffer_load_dword v13, v4, s[36:39], s75 offen sc1
    s_waitcnt vmcnt(0)
    v_max3_u32 v5, v8, v9, v10
    v_max3_u32 v5, v5, v11, v12
    v_max_u32 v5, v5, v13
    v_cmp_eq_u32 vcc, -1, v5
    s_cbranch_vccz L_rd134
    s_sleep 4
    s_sub_i32 s34, s34, 16
    s_cmp_gt_i32 s34, 0
    s_cbranch_scc1 L_Q_poll
L_rd134:
    v_mov_b32 v13, 0
    s_mov_b32 exec_lo, 0
    v_mov_b32 v12, 0
    s_mov_b32 exec_lo, -1
    s_lshl_b32 s18, s72, 1
    s_add_u32 s19, s18, 2
    s_mov_b32 s73, 163840
    v_lshrrev_b32 v32, 9, v0
    v_mul_u32_u24 v32, 304, v32
    v_and_b32 v35, 0x1f0, v0
    v_add_u32 v34, v32, v35
    v_cmp_gt_u32 vcc, 304, v35
    v_mov_b32 v32, 2130706432
    s_nop 0
    v_cndmask_b32 v34, v32, v34, vcc
    v_lshrrev_b32 v35, 2, v35
    v_mov_b32 v30, 0xff61b1e6
    v_mov_b32 v29, 0
    v_mov_b32 v60, 0
    v_mov_b32 v61, 0
    v_mov_b32 v62, 0
    v_mov_b32 v63, 0
    v_mov_b32 v64, 0
    v_mov_b32 v65, 0
    v_mov_b32 v66, 0
    v_mov_b32 v67, 0
    v_mov_b32 v68, 0
    v_mov_b32 v69, 0
    v_mov_b32 v70, 0
    v_mov_b32 v71, 0
    v_mov_b32 v72, 0
    v_mov_b32 v73, 0
    v_mov_b32 v74, 0
    v_mov_b32 v75, 0
L_st135:
    s_lshr_b32 s76, s18, 2
    s_mul_i32 s76, s76, 9472
    s_add_u32 s76, s76, s73
    s_and_b32 s77, s18, 3
    s_lshl_b32 s78, s77, 10
    s_add_u32 s78, s78, s76
    buffer_load_dwordx4 v[16:19], v0, s[36:39], s78 offen sc1
    s_lshl_b32 s78, s77, 7
    s_add_u32 s78, s78, s76
    s_add_u32 s78, s78, 8960
    buffer_load_dword v28, v35, s[36:39], s78 offen sc1
    s_mul_i32 s78, s77, 1216
    s_add_u32 s78, s78, s76
    s_add_u32 s78, s78, 4096
    buffer_load_dwordx4 v[20:23], v34, s[36:39], s78 offen sc1
    buffer_load_dwordx4 v[24:27], v34, s[36:39], s78 offen offset:608 sc1
    s_waitcnt vmcnt(2)
    v_mfma_f32_32x32x16_bf16 v[76:91], v[16:19], v[8:11], 0
    v_mfma_f32_32x32x8_bf16 v[76:91], v[28:29], v[12:13], v[76:91]
    s_nop 11
    v_max3_f32 v32, v76, v77, v30
    v_max3_f32 v32, v78, v79, v32
    v_max3_f32 v32, v80, v81, v32
    v_max3_f32 v32, v82, v83, v32
    v_max3_f32 v32, v84, v85, v32
    v_max3_f32 v32, v86, v87, v32
    v_max3_f32 v32, v88, v89, v32
    v_max3_f32 v32, v90, v91, v32
    v_mov_b32 v33, v32
    s_nop 1
    v_permlane32_swap_b32 v32, v33
    v_max_f32 v32, v32, v33
    v_sub_f32 v33, v30, v32
    v_exp_f32 v33, v33
    v_mov_b32 v30, v32
    v_sub_f32 v76, v76, v30
    v_sub_f32 v77, v77, v30
    v_sub_f32 v78, v78, v30
    v_sub_f32 v79, v79, v30
    v_sub_f32 v80, v80, v30
    v_sub_f32 v81, v81, v30
    v_sub_f32 v82, v82, v30
    v_sub_f32 v83, v83, v30
    v_sub_f32 v84, v84, v30
    v_sub_f32 v85, v85, v30
    v_sub_f32 v86, v86, v30
    v_sub_f32 v87, v87, v30
    v_sub_f32 v88, v88, v30
    v_sub_f32 v89, v89, v30
    v_sub_f32 v90, v90, v30
    v_sub_f32 v91, v91, v30
    v_exp_f32 v76, v76
    v_exp_f32 v77, v77
    v_exp_f32 v78, v78
    v_exp_f32 v79, v79
    v_exp_f32 v80, v80
    v_exp_f32 v81, v81
    v_exp_f32 v82, v82
    v_exp_f32 v83, v83
    v_exp_f32 v84, v84
    v_exp_f32 v85, v85
    v_exp_f32 v86, v86
    v_exp_f32 v87, v87
    v_exp_f32 v88, v88
    v_exp_f32 v89, v89
    v_exp_f32 v90, v90
    v_exp_f32 v91, v91
    v_mul_f32 v60, v60, v33
    v_mul_f32 v61, v61, v33
    v_mul_f32 v62, v62, v33
    v_mul_f32 v63, v63, v33
    v_mul_f32 v64, v64, v33
    v_mul_f32 v65, v65, v33
    v_mul_f32 v66, v66, v33
    v_mul_f32 v67, v67, v33
    v_mul_f32 v68, v68, v33
    v_mul_f32 v69, v69, v33
    v_mul_f32 v70, v70, v33
    v_cvt_pk_bf16_f32 v76, v76, v77
    v_cvt_pk_bf16_f32 v77, v78, v79
    v_cvt_pk_bf16_f32 v78, v80, v81
    v_cvt_pk_bf16_f32 v79, v82, v83
    v_cvt_pk_bf16_f32 v80, v84, v85
    v_cvt_pk_bf16_f32 v81, v86, v87
    v_cvt_pk_bf16_f32 v82, v88, v89
    v_cvt_pk_bf16_f32 v83, v90, v91
    s_waitcnt vmcnt(0)
    v_mfma_f32_32x32x16_bf16 v[60:75], v[20:23], v[76:79], v[60:75]
    v_mfma_f32_32x32x16_bf16 v[60:75], v[24:27], v[80:83], v[60:75]
    s_add_u32 s18, s18, 1
    s_cmp_lt_u32 s18, s19
    s_cbranch_scc1 L_st135
    s_nop 8
    s_mul_i32 s74, s72, 3072
    s_add_u32 s74, s74, 12686336
    v_mov_b32 v71, v30
    buffer_store_dwordx4 v[60:63], v0, s[36:39], s74 offen offset:0 sc1
    buffer_store_dwordx4 v[64:67], v0, s[36:39], s74 offen offset:1024 sc1
    buffer_store_dwordx4 v[68:71], v0, s[36:39], s74 offen offset:2048 sc1
    s_branch L_Z_next
L_C_start:
    v_bfe_u32 v2, v0, 4, 5
    v_mul_u32_u24 v2, 3072, v2
    v_and_b32 v3, 0x200, v0
    v_add_u32 v2, v2, v3
    s_lshl_b32 s74, s72, 4
    s_add_u32 s74, s74, 12686336
L_C_poll:
    buffer_load_dwordx4 v[8:11], v2, s[36:39], s74 offen offset:0 sc1
    buffer_load_dwordx4 v[12:15], v2, s[36:39], s74 offen offset:1024 sc1
    buffer_load_dwordx4 v[16:19], v2, s[36:39], s74 offen offset:2048 sc1
    s_waitcnt vmcnt(0)
    v_max3_u32 v5, v8, v9, v10
    v_max3_u32 v5, v5, v11, v12
    v_max3_u32 v5, v5, v13, v14
    v_max3_u32 v5, v5, v15, v16
    v_max3_u32 v5, v5, v17, v18
    v_max_u32 v5, v5, v19
    v_cmp_eq_u32 vcc, -1, v5
    s_cbranch_vccz L_rd136
    s_sleep 8
    s_sub_i32 s34, s34, 16
    s_cmp_gt_i32 s34, 0
    s_cbranch_scc1 L_C_poll
L_rd136:
    v_mov_b32 v20, v19
    s_nop 1
    v_max_f32_dpp v20, v20, v20 quad_perm:[1,0,3,2] row_mask:0xf bank_mask:0xf
    s_nop 1
    v_max_f32_dpp v20, v20, v20 quad_perm:[2,3,0,1] row_mask:0xf bank_mask:0xf
    s_nop 1
    v_max_f32_dpp v20, v20, v20 row_half_mirror row_mask:0xf bank_mask:0xf
    s_nop 1
    v_max_f32_dpp v20, v20, v20 row_mirror row_mask:0xf bank_mask:0xf
    v_mov_b32 v21, v20
    s_nop 1
    v_permlane16_swap_b32 v20, v21
    v_max_f32 v20, v20, v21
    v_mov_b32 v21, v20
    s_nop 1
    v_permlane32_swap_b32 v20, v21
    v_max_f32 v20, v20, v21
    v_sub_f32 v20, v19, v20
    v_exp_f32 v20, v20
    s_nop 0
    v_mul_f32 v8, v8, v20
    v_mul_f32 v9, v9, v20
    v_mul_f32 v10, v10, v20
    v_mul_f32 v11, v11, v20
    v_mul_f32 v12, v12, v20
    v_mul_f32 v13, v13, v20
    v_mul_f32 v14, v14, v20
    v_mul_f32 v15, v15, v20
    v_mul_f32 v16, v16, v20
    v_mul_f32 v17, v17, v20
    v_mul_f32 v18, v18, v20
    v_add_f32_dpp v8, v8, v8 quad_perm:[1,0,3,2] row_mask:0xf bank_mask:0xf
    v_add_f32_dpp v9, v9, v9 quad_perm:[1,0,3,2] row_mask:0xf bank_mask:0xf
    v_add_f32_dpp v10, v10, v10 quad_perm:[1,0,3,2] row_mask:0xf bank_mask:0xf
    v_add_f32_dpp v11, v11, v11 quad_perm:[1,0,3,2] row_mask:0xf bank_mask:0xf
    v_add_f32_dpp v12, v12, v12 quad_perm:[1,0,3,2] row_mask:0xf bank_mask:0xf
    v_add_f32_dpp v13, v13, v13 quad_perm:[1,0,3,2] row_mask:0xf bank_mask:0xf
    v_add_f32_dpp v14, v14, v14 quad_perm:[1,0,3,2] row_mask:0xf bank_mask:0xf
    v_add_f32_dpp v15, v15, v15 quad_perm:[1,0,3,2] row_mask:0xf bank_mask:0xf
    v_add_f32_dpp v16, v16, v16 quad_perm:[1,0,3,2] row_mask:0xf bank_mask:0xf
    v_add_f32_dpp v17, v17, v17 quad_perm:[1,0,3,2] row_mask:0xf bank_mask:0xf
    v_add_f32_dpp v18, v18, v18 quad_perm:[1,0,3,2] row_mask:0xf bank_mask:0xf
    v_add_f32_dpp v8, v8, v8 quad_perm:[2,3,0,1] row_mask:0xf bank_mask:0xf
    v_add_f32_dpp v9, v9, v9 quad_perm:[2,3,0,1] row_mask:0xf bank_mask:0xf
    v_add_f32_dpp v10, v10, v10 quad_perm:[2,3,0,1] row_mask:0xf bank_mask:0xf
    v_add_f32_dpp v11, v11, v11 quad_perm:[2,3,0,1] row_mask:0xf bank_mask:0xf
    v_add_f32_dpp v12, v12, v12 quad_perm:[2,3,0,1] row_mask:0xf bank_mask:0xf
    v_add_f32_dpp v13, v13, v13 quad_perm:[2,3,0,1] row_mask:0xf bank_mask:0xf
    v_add_f32_dpp v14, v14, v14 quad_perm:[2,3,0,1] row_mask:0xf bank_mask:0xf
    v_add_f32_dpp v15, v15, v15 quad_perm:[2,3,0,1] row_mask:0xf bank_mask:0xf
    v_add_f32_dpp v16, v16, v16 quad_perm:[2,3,0,1] row_mask:0xf bank_mask:0xf
    v_add_f32_dpp v17, v17, v17 quad_perm:[2,3,0,1] row_mask:0xf bank_mask:0xf
    v_add_f32_dpp v18, v18, v18 quad_perm:[2,3,0,1] row_mask:0xf bank_mask:0xf
    v_add_f32_dpp v8, v8, v8 row_half_mirror row_mask:0xf bank_mask:0xf
    v_add_f32_dpp v9, v9, v9 row_half_mirror row_mask:0xf bank_mask:0xf
    v_add_f32_dpp v10, v10, v10 row_half_mirror row_mask:0xf bank_mask:0xf
    v_add_f32_dpp v11, v11, v11 row_half_mirror row_mask:0xf bank_mask:0xf
    v_add_f32_dpp v12, v12, v12 row_half_mirror row_mask:0xf bank_mask:0xf
    v_add_f32_dpp v13, v13, v13 row_half_mirror row_mask:0xf bank_mask:0xf
    v_add_f32_dpp v14, v14, v14 row_half_mirror row_mask:0xf bank_mask:0xf
    v_add_f32_dpp v15, v15, v15 row_half_mirror row_mask:0xf bank_mask:0xf
    v_add_f32_dpp v16, v16, v16 row_half_mirror row_mask:0xf bank_mask:0xf
    v_add_f32_dpp v17, v17, v17 row_half_mirror row_mask:0xf bank_mask:0xf
    v_add_f32_dpp v18, v18, v18 row_half_mirror row_mask:0xf bank_mask:0xf
    v_add_f32_dpp v8, v8, v8 row_mirror row_mask:0xf bank_mask:0xf
    v_add_f32_dpp v9, v9, v9 row_mirror row_mask:0xf bank_mask:0xf
    v_add_f32_dpp v10, v10, v10 row_mirror row_mask:0xf bank_mask:0xf
    v_add_f32_dpp v11, v11, v11 row_mirror row_mask:0xf bank_mask:0xf
    v_add_f32_dpp v12, v12, v12 row_mirror row_mask:0xf bank_mask:0xf
    v_add_f32_dpp v13, v13, v13 row_mirror row_mask:0xf bank_mask:0xf
    v_add_f32_dpp v14, v14, v14 row_mirror row_mask:0xf bank_mask:0xf
    v_add_f32_dpp v15, v15, v15 row_mirror row_mask:0xf bank_mask:0xf
    v_add_f32_dpp v16, v16, v16 row_mirror row_mask:0xf bank_mask:0xf
    v_add_f32_dpp v17, v17, v17 row_mirror row_mask:0xf bank_mask:0xf
    v_add_f32_dpp v18, v18, v18 row_mirror row_mask:0xf bank_mask:0xf
    v_mov_b32 v24, v8
    v_mov_b32 v25, v9
    v_mov_b32 v26, v10
    v_mov_b32 v27, v11
    v_mov_b32 v28, v12
    v_mov_b32 v29, v13
    v_mov_b32 v30, v14
    v_mov_b32 v31, v15
    v_mov_b32 v32, v16
    v_mov_b32 v33, v17
    v_mov_b32 v34, v18
    v_permlane16_swap_b32 v8, v24
    v_permlane16_swap_b32 v9, v25
    v_permlane16_swap_b32 v10, v26
    v_permlane16_swap_b32 v11, v27
    v_permlane16_swap_b32 v12, v28
    v_permlane16_swap_b32 v13, v29
    v_permlane16_swap_b32 v14, v30
    v_permlane16_swap_b32 v15, v31
    v_permlane16_swap_b32 v16, v32
    v_permlane16_swap_b32 v17, v33
    v_permlane16_swap_b32 v18, v34
    v_add_f32 v8, v8, v24
    v_add_f32 v9, v9, v25
    v_add_f32 v10, v10, v26
    v_add_f32 v11, v11, v27
    v_add_f32 v12, v12, v28
    v_add_f32 v13, v13, v29
    v_add_f32 v14, v14, v30
    v_add_f32 v15, v15, v31
    v_add_f32 v16, v16, v32
    v_add_f32 v17, v17, v33
    v_add_f32 v18, v18, v34
    v_mov_b32 v20, v18
    s_nop 1
    v_permlane32_swap_b32 v18, v20
    v_rcp_f32 v18, v18
    s_nop 0
    v_mul_f32 v8, v8, v18
    v_mul_f32 v9, v9, v18
    v_mul_f32 v10, v10, v18
    v_mul_f32 v11, v11, v18
    v_mul_f32 v12, v12, v18
    v_mul_f32 v13, v13, v18
    v_mul_f32 v14, v14, v18
    v_mul_f32 v15, v15, v18
    v_mul_f32 v16, v16, v18
    v_mul_f32 v17, v17, v18
    v_cvt_pk_bf16_f32 v24, v8, v9
    v_cvt_pk_bf16_f32 v25, v10, v11
    v_cvt_pk_bf16_f32 v26, v12, v13
    v_cvt_pk_bf16_f32 v27, v14, v15
    v_cvt_pk_bf16_f32 v28, v16, v17
    s_lshr_b32 s75, s72, 2
    s_mul_i32 s75, s75, 2304
    s_add_u32 s74, s75, 12784640
    s_and_b32 s75, s72, 3
    s_lshl_b32 s76, s75, 9
    s_add_u32 s76, s76, s74
    s_lshl_b32 s75, s75, 2
    s_add_u32 s75, s75, s74
    v_lshrrev_b32 v3, 1, v3
    s_mov_b32 exec_lo, 1
    s_mov_b32 exec_hi, 1
    buffer_store_dwordx4 v[24:27], v3, s[36:39], s76 offen sc1
    s_mov_b32 exec_hi, 0
    buffer_store_dword v28, off, s[36:39], s75 offset:2048 sc1
    s_mov_b64 exec, -1
L_Z_next:
    s_branch L_Z_layer
L_R_start:
    s_lshl_b32 s74, s70, 2
    s_lshr_b32 s71, 0x435, s74
    s_and_b32 s71, s71, 7
    s_cmp_eq_u32 s66, 30
    s_cselect_b32 s71, s70, s71
    s_lshl_b32 s74, s71, 3
    s_add_u32 s74, s74, s5
    s_cmp_ge_u32 s74, 46
    s_cbranch_scc1 L_end
    s_cmp_ge_u32 s71, 4
    s_cbranch_scc1 L_R_have
    v_lshrrev_b32 v2, 8, v0
    v_lshlrev_b32 v2, 4, v2
    s_lshl_b32 s74, s71, 6
    s_add_u32 s74, s74, 158976
    v_add_u32 v2, s74, v2
    ds_read_b128 v[56:59], v2
L_R_have:
L_w137:
    ds_read_b32 v5, v1
    s_waitcnt lgkmcnt(0)
    v_cmp_gt_u32 vcc, 19, v5
    s_and_b32 s79, vcc_lo, 0x800
    s_cbranch_scc0 L_wd138
    s_sleep 8
    s_sub_i32 s34, s34, 33
    s_cmp_gt_i32 s34, 0
    s_cbranch_scc1 L_w137
L_wd138:
    v_readlane_b32 s73, v5, 46
    s_and_b32 s67, s73, 0x7ff
    s_xor_b32 s67, s67, 0x7ff
    s_mov_b32 s74, 12681216
    v_bfe_u32 v2, v0, 4, 4
    v_lshrrev_b32 v3, 8, v0
    v_lshl_add_u32 v3, v2, 2, v3
    v_lshlrev_b32 v3, 4, v3
    v_cmp_gt_u32 vcc, 2, v2
    v_add_u32 v4, 1024, v3
    v_mov_b32 v5, 2130706432
    v_cndmask_b32 v4, v5, v4, vcc
    v_mov_b32 v6, 0x3f803f80
L_rl139:
    buffer_load_dwordx4 v[8:11], v3, s[36:39], s74 offen sc1
    buffer_load_dwordx4 v[12:15], v4, s[36:39], s74 offen sc1
    v_mov_b32 v32, 0
    v_mov_b32 v33, 0
    s_waitcnt vmcnt(0)
    v_max3_u32 v5, v8, v9, v10
    v_max3_u32 v5, v5, v11, v12
    v_max3_u32 v5, v5, v13, v14
    v_max_u32 v5, v5, v15
    v_cmp_eq_u32 vcc, -1, v5
    s_cbranch_vccz L_rd140
    s_sleep 4
    s_sub_i32 s34, s34, 16
    s_cmp_gt_i32 s34, 0
    s_cbranch_scc1 L_rl139
L_rd140:
    s_mov_b32 s76, 0x00010001
    s_mov_b32 s77, 0x00010001
    s_cmp_ge_u32 s71, 4
    s_cbranch_scc1 L_rd_p
    v_cndmask_b32 v16, 0, v8, s[76:77]
    v_cndmask_b32 v17, 0, v9, s[76:77]
    v_cndmask_b32 v18, 0, v10, s[76:77]
    v_cndmask_b32 v19, 0, v11, s[76:77]
    s_lshl_b64 s[76:77], s[76:77], 1
    s_nop 0
    v_mfma_f32_16x16x32_bf16 v[24:27], v[60:63], v[16:19], 0
    v_cndmask_b32 v20, 0, v8, s[76:77]
    v_cndmask_b32 v21, 0, v9, s[76:77]
    v_cndmask_b32 v22, 0, v10, s[76:77]
    v_cndmask_b32 v23, 0, v11, s[76:77]
    s_lshl_b64 s[76:77], s[76:77], 1
    s_nop 0
    v_mfma_f32_16x16x32_bf16 v[28:31], v[64:67], v[20:23], 0
    v_cndmask_b32 v16, 0, v8, s[76:77]
    v_cndmask_b32 v17, 0, v9, s[76:77]
    v_cndmask_b32 v18, 0, v10, s[76:77]
    v_cndmask_b32 v19, 0, v11, s[76:77]
    s_lshl_b64 s[76:77], s[76:77], 1
    s_nop 0
    v_mfma_f32_16x16x32_bf16 v[24:27], v[68:71], v[16:19], v[24:27]
    v_cndmask_b32 v20, 0, v8, s[76:77]
    v_cndmask_b32 v21, 0, v9, s[76:77]
    v_cndmask_b32 v22, 0, v10, s[76:77]
    v_cndmask_b32 v23, 0, v11, s[76:77]
    s_lshl_b64 s[76:77], s[76:77], 1
    s_nop 0
    v_mfma_f32_16x16x32_bf16 v[28:31], v[72:75], v[20:23], v[28:31]
    v_cndmask_b32 v16, 0, v8, s[76:77]
    v_cndmask_b32 v17, 0, v9, s[76:77]
    v_cndmask_b32 v18, 0, v10, s[76:77]
    v_cndmask_b32 v19, 0, v11, s[76:77]
    s_lshl_b64 s[76:77], s[76:77], 1
    s_nop 0
    v_mfma_f32_16x16x32_bf16 v[24:27], v[76:79], v[16:19], v[24:27]
    v_cndmask_b32 v20, 0, v8, s[76:77]
    v_cndmask_b32 v21, 0, v9, s[76:77]
    v_cndmask_b32 v22, 0, v10, s[76:77]
    v_cndmask_b32 v23, 0, v11, s[76:77]
    s_lshl_b64 s[76:77], s[76:77], 1
    s_nop 0
    v_mfma_f32_16x16x32_bf16 v[28:31], v[80:83], v[20:23], v[28:31]
    v_cndmask_b32 v16, 0, v8, s[76:77]
    v_cndmask_b32 v17, 0, v9, s[76:77]
    v_cndmask_b32 v18, 0, v10, s[76:77]
    v_cndmask_b32 v19, 0, v11, s[76:77]
    s_lshl_b64 s[76:77], s[76:77], 1
    s_nop 0
    v_mfma_f32_16x16x32_bf16 v[24:27], v[84:87], v[16:19], v[24:27]
    v_cndmask_b32 v20, 0, v8, s[76:77]
    v_cndmask_b32 v21, 0, v9, s[76:77]
    v_cndmask_b32 v22, 0, v10, s[76:77]
    v_cndmask_b32 v23, 0, v11, s[76:77]
    s_lshl_b64 s[76:77], s[76:77], 1
    s_nop 0
    v_mfma_f32_16x16x32_bf16 v[28:31], v[88:91], v[20:23], v[28:31]
    v_cndmask_b32 v16, 0, v8, s[76:77]
    v_cndmask_b32 v17, 0, v9, s[76:77]
    v_cndmask_b32 v18, 0, v10, s[76:77]
    v_cndmask_b32 v19, 0, v11, s[76:77]
    s_lshl_b64 s[76:77], s[76:77], 1
    s_nop 0
    v_mfma_f32_16x16x32_bf16 v[24:27], v[92:95], v[16:19], v[24:27]
    v_cndmask_b32 v20, 0, v8, s[76:77]
    v_cndmask_b32 v21, 0, v9, s[76:77]
    v_cndmask_b32 v22, 0, v10, s[76:77]
    v_cndmask_b32 v23, 0, v11, s[76:77]
    s_lshl_b64 s[76:77], s[76:77], 1
    s_nop 0
    v_mfma_f32_16x16x32_bf16 v[28:31], v[96:99], v[20:23], v[28:31]
    v_cndmask_b32 v16, 0, v8, s[76:77]
    v_cndmask_b32 v17, 0, v9, s[76:77]
    v_cndmask_b32 v18, 0, v10, s[76:77]
    v_cndmask_b32 v19, 0, v11, s[76:77]
    s_lshl_b64 s[76:77], s[76:77], 1
    s_nop 0
    v_mfma_f32_16x16x32_bf16 v[24:27], v[100:103], v[16:19], v[24:27]
    v_cndmask_b32 v20, 0, v8, s[76:77]
    v_cndmask_b32 v21, 0, v9, s[76:77]
    v_cndmask_b32 v22, 0, v10, s[76:77]
    v_cndmask_b32 v23, 0, v11, s[76:77]
    s_lshl_b64 s[76:77], s[76:77], 1
    s_nop 0
    v_mfma_f32_16x16x32_bf16 v[28:31], v[104:107], v[20:23], v[28:31]
    v_cndmask_b32 v16, 0, v8, s[76:77]
    v_cndmask_b32 v17, 0, v9, s[76:77]
    v_cndmask_b32 v18, 0, v10, s[76:77]
    v_cndmask_b32 v19, 0, v11, s[76:77]
    s_lshl_b64 s[76:77], s[76:77], 1
    s_nop 0
    v_mfma_f32_16x16x32_bf16 v[24:27], v[108:111], v[16:19], v[24:27]
    v_cndmask_b32 v20, 0, v8, s[76:77]
    v_cndmask_b32 v21, 0, v9, s[76:77]
    v_cndmask_b32 v22, 0, v10, s[76:77]
    v_cndmask_b32 v23, 0, v11, s[76:77]
    s_lshl_b64 s[76:77], s[76:77], 1
    s_nop 0
    v_mfma_f32_16x16x32_bf16 v[28:31], v[112:115], v[20:23], v[28:31]
    v_cndmask_b32 v16, 0, v8, s[76:77]
    v_cndmask_b32 v17, 0, v9, s[76:77]
    v_cndmask_b32 v18, 0, v10, s[76:77]
    v_cndmask_b32 v19, 0, v11, s[76:77]
    s_lshl_b64 s[76:77], s[76:77], 1
    s_nop 0
    v_mfma_f32_16x16x32_bf16 v[24:27], v[116:119], v[16:19], v[24:27]
    v_cndmask_b32 v20, 0, v8, s[76:77]
    v_cndmask_b32 v21, 0, v9, s[76:77]
    v_cndmask_b32 v22, 0, v10, s[76:77]
    v_cndmask_b32 v23, 0, v11, s[76:77]
    s_lshl_b64 s[76:77], s[76:77], 1
    s_nop 0
    v_mfma_f32_16x16x32_bf16 v[28:31], v[120:123], v[20:23], v[28:31]
    s_mov_b32 s76, 0x00010001
    s_mov_b32 s77, 0x00010001
    v_cndmask_b32 v16, 0, v12, s[76:77]
    v_cndmask_b32 v17, 0, v13, s[76:77]
    v_cndmask_b32 v18, 0, v14, s[76:77]
    v_cndmask_b32 v19, 0, v15, s[76:77]
    s_lshl_b64 s[76:77], s[76:77], 1
    s_nop 0
    v_mfma_f32_16x16x32_bf16 v[24:27], v[124:127], v[16:19], v[24:27]
    v_cndmask_b32 v20, 0, v12, s[76:77]
    v_cndmask_b32 v21, 0, v13, s[76:77]
    v_cndmask_b32 v22, 0, v14, s[76:77]
    v_cndmask_b32 v23, 0, v15, s[76:77]
    s_lshl_b64 s[76:77], s[76:77], 1
    s_nop 0
    v_mfma_f32_16x16x32_bf16 v[28:31], v[128:131], v[20:23], v[28:31]
    s_branch L_rd_c
L_rd_p:
    v_cndmask_b32 v16, 0, v8, s[76:77]
    v_cndmask_b32 v17, 0, v9, s[76:77]
    v_cndmask_b32 v18, 0, v10, s[76:77]
    v_cndmask_b32 v19, 0, v11, s[76:77]
    s_lshl_b64 s[76:77], s[76:77], 1
    s_nop 0
    v_mfma_f32_16x16x32_bf16 v[24:27], v[60:63], v[16:19], 0
    v_cndmask_b32 v20, 0, v8, s[76:77]
    v_cndmask_b32 v21, 0, v9, s[76:77]
    v_cndmask_b32 v22, 0, v10, s[76:77]
    v_cndmask_b32 v23, 0, v11, s[76:77]
    s_lshl_b64 s[76:77], s[76:77], 1
    s_nop 0
    v_mfma_f32_16x16x32_bf16 v[28:31], v[60:63], v[20:23], 0
    v_cndmask_b32 v16, 0, v8, s[76:77]
    v_cndmask_b32 v17, 0, v9, s[76:77]
    v_cndmask_b32 v18, 0, v10, s[76:77]
    v_cndmask_b32 v19, 0, v11, s[76:77]
    s_lshl_b64 s[76:77], s[76:77], 1
    s_nop 0
    v_mfma_f32_16x16x32_bf16 v[24:27], v[64:67], v[16:19], v[24:27]
    v_cndmask_b32 v20, 0, v8, s[76:77]
    v_cndmask_b32 v21, 0, v9, s[76:77]
    v_cndmask_b32 v22, 0, v10, s[76:77]
    v_cndmask_b32 v23, 0, v11, s[76:77]
    s_lshl_b64 s[76:77], s[76:77], 1
    s_nop 0
    v_mfma_f32_16x16x32_bf16 v[28:31], v[64:67], v[20:23], v[28:31]
    v_cndmask_b32 v16, 0, v8, s[76:77]
    v_cndmask_b32 v17, 0, v9, s[76:77]
    v_cndmask_b32 v18, 0, v10, s[76:77]
    v_cndmask_b32 v19, 0, v11, s[76:77]
    s_lshl_b64 s[76:77], s[76:77], 1
    s_nop 0
    v_mfma_f32_16x16x32_bf16 v[24:27], v[68:71], v[16:19], v[24:27]
    v_cndmask_b32 v20, 0, v8, s[76:77]
    v_cndmask_b32 v21, 0, v9, s[76:77]
    v_cndmask_b32 v22, 0, v10, s[76:77]
    v_cndmask_b32 v23, 0, v11, s[76:77]
    s_lshl_b64 s[76:77], s[76:77], 1
    s_nop 0
    v_mfma_f32_16x16x32_bf16 v[28:31], v[68:71], v[20:23], v[28:31]
    v_cndmask_b32 v16, 0, v8, s[76:77]
    v_cndmask_b32 v17, 0, v9, s[76:77]
    v_cndmask_b32 v18, 0, v10, s[76:77]
    v_cndmask_b32 v19, 0, v11, s[76:77]
    s_lshl_b64 s[76:77], s[76:77], 1
    s_nop 0
    v_mfma_f32_16x16x32_bf16 v[24:27], v[72:75], v[16:19], v[24:27]
    v_cndmask_b32 v20, 0, v8, s[76:77]
    v_cndmask_b32 v21, 0, v9, s[76:77]
    v_cndmask_b32 v22, 0, v10, s[76:77]
    v_cndmask_b32 v23, 0, v11, s[76:77]
    s_lshl_b64 s[76:77], s[76:77], 1
    s_nop 0
    v_mfma_f32_16x16x32_bf16 v[28:31], v[72:75], v[20:23], v[28:31]
    v_cndmask_b32 v16, 0, v8, s[76:77]
    v_cndmask_b32 v17, 0, v9, s[76:77]
    v_cndmask_b32 v18, 0, v10, s[76:77]
    v_cndmask_b32 v19, 0, v11, s[76:77]
    s_lshl_b64 s[76:77], s[76:77], 1
    s_nop 0
    v_mfma_f32_16x16x32_bf16 v[24:27], v[76:79], v[16:19], v[24:27]
    v_cndmask_b32 v20, 0, v8, s[76:77]
    v_cndmask_b32 v21, 0, v9, s[76:77]
    v_cndmask_b32 v22, 0, v10, s[76:77]
    v_cndmask_b32 v23, 0, v11, s[76:77]
    s_lshl_b64 s[76:77], s[76:77], 1
    s_nop 0
    v_mfma_f32_16x16x32_bf16 v[28:31], v[76:79], v[20:23], v[28:31]
    v_cndmask_b32 v16, 0, v8, s[76:77]
    v_cndmask_b32 v17, 0, v9, s[76:77]
    v_cndmask_b32 v18, 0, v10, s[76:77]
    v_cndmask_b32 v19, 0, v11, s[76:77]
    s_lshl_b64 s[76:77], s[76:77], 1
    s_nop 0
    v_mfma_f32_16x16x32_bf16 v[24:27], v[80:83], v[16:19], v[24:27]
    v_cndmask_b32 v20, 0, v8, s[76:77]
    v_cndmask_b32 v21, 0, v9, s[76:77]
    v_cndmask_b32 v22, 0, v10, s[76:77]
    v_cndmask_b32 v23, 0, v11, s[76:77]
    s_lshl_b64 s[76:77], s[76:77], 1
    s_nop 0
    v_mfma_f32_16x16x32_bf16 v[28:31], v[80:83], v[20:23], v[28:31]
    v_cndmask_b32 v16, 0, v8, s[76:77]
    v_cndmask_b32 v17, 0, v9, s[76:77]
    v_cndmask_b32 v18, 0, v10, s[76:77]
    v_cndmask_b32 v19, 0, v11, s[76:77]
    s_lshl_b64 s[76:77], s[76:77], 1
    s_nop 0
    v_mfma_f32_16x16x32_bf16 v[24:27], v[84:87], v[16:19], v[24:27]
    v_cndmask_b32 v20, 0, v8, s[76:77]
    v_cndmask_b32 v21, 0, v9, s[76:77]
    v_cndmask_b32 v22, 0, v10, s[76:77]
    v_cndmask_b32 v23, 0, v11, s[76:77]
    s_lshl_b64 s[76:77], s[76:77], 1
    s_nop 0
    v_mfma_f32_16x16x32_bf16 v[28:31], v[84:87], v[20:23], v[28:31]
    v_cndmask_b32 v16, 0, v8, s[76:77]
    v_cndmask_b32 v17, 0, v9, s[76:77]
    v_cndmask_b32 v18, 0, v10, s[76:77]
    v_cndmask_b32 v19, 0, v11, s[76:77]
    s_lshl_b64 s[76:77], s[76:77], 1
    s_nop 0
    v_mfma_f32_16x16x32_bf16 v[24:27], v[88:91], v[16:19], v[24:27]
    v_cndmask_b32 v20, 0, v8, s[76:77]
    v_cndmask_b32 v21, 0, v9, s[76:77]
    v_cndmask_b32 v22, 0, v10, s[76:77]
    v_cndmask_b32 v23, 0, v11, s[76:77]
    s_lshl_b64 s[76:77], s[76:77], 1
    s_nop 0
    v_mfma_f32_16x16x32_bf16 v[28:31], v[88:91], v[20:23], v[28:31]
    s_mov_b32 s76, 0x00010001
    s_mov_b32 s77, 0x00010001
    v_cndmask_b32 v16, 0, v12, s[76:77]
    v_cndmask_b32 v17, 0, v13, s[76:77]
    v_cndmask_b32 v18, 0, v14, s[76:77]
    v_cndmask_b32 v19, 0, v15, s[76:77]
    s_lshl_b64 s[76:77], s[76:77], 1
    s_nop 0
    v_mfma_f32_16x16x32_bf16 v[24:27], v[92:95], v[16:19], v[24:27]
    v_cndmask_b32 v20, 0, v12, s[76:77]
    v_cndmask_b32 v21, 0, v13, s[76:77]
    v_cndmask_b32 v22, 0, v14, s[76:77]
    v_cndmask_b32 v23, 0, v15, s[76:77]
    s_lshl_b64 s[76:77], s[76:77], 1
    s_nop 0
    v_mfma_f32_16x16x32_bf16 v[28:31], v[92:95], v[20:23], v[28:31]
    s_mov_b32 exec_lo, 0
    s_nop 6
    v_mov_b32 v24, v28
    v_mov_b32 v25, v29
    v_mov_b32 v26, v30
    v_mov_b32 v27, v31
    s_mov_b32 exec_lo, -1
    v_mov_b32 v28, v24
    v_mov_b32 v29, v25
    v_mov_b32 v30, v26
    v_mov_b32 v31, v27
    v_permlane32_swap_b32 v24, v28
    v_permlane32_swap_b32 v25, v29
    v_permlane32_swap_b32 v26, v30
    v_permlane32_swap_b32 v27, v31
L_rd_c:
    v_dot2c_f32_bf16 v32, v8, v6
    v_dot2c_f32_bf16 v33, v8, v8
    v_dot2c_f32_bf16 v32, v9, v6
    v_dot2c_f32_bf16 v33, v9, v9
    v_dot2c_f32_bf16 v32, v10, v6
    v_dot2c_f32_bf16 v33, v10, v10
    v_dot2c_f32_bf16 v32, v11, v6
    v_dot2c_f32_bf16 v33, v11, v11
    v_dot2c_f32_bf16 v32, v12, v6
    v_dot2c_f32_bf16 v33, v12, v12
    v_dot2c_f32_bf16 v32, v13, v6
    v_dot2c_f32_bf16 v33, v13, v13
    v_dot2c_f32_bf16 v32, v14, v6
    v_dot2c_f32_bf16 v33, v14, v14
    v_dot2c_f32_bf16 v32, v15, v6
    v_dot2c_f32_bf16 v33, v15, v15
    s_nop 1
    v_add_f32_dpp v32, v32, v32 quad_perm:[1,0,3,2] row_mask:0xf bank_mask:0xf
    v_add_f32_dpp v33, v33, v33 quad_perm:[1,0,3,2] row_mask:0xf bank_mask:0xf
    s_nop 0
    v_add_f32_dpp v32, v32, v32 quad_perm:[2,3,0,1] row_mask:0xf bank_mask:0xf
    v_add_f32_dpp v33, v33, v33 quad_perm:[2,3,0,1] row_mask:0xf bank_mask:0xf
    s_nop 0
    v_add_f32_dpp v32, v32, v32 row_half_mirror row_mask:0xf bank_mask:0xf
    v_add_f32_dpp v33, v33, v33 row_half_mirror row_mask:0xf bank_mask:0xf
    s_nop 0
    v_add_f32_dpp v32, v32, v32 row_mirror row_mask:0xf bank_mask:0xf
    v_add_f32_dpp v33, v33, v33 row_mirror row_mask:0xf bank_mask:0xf
    v_mov_b32 v34, v32
    v_mov_b32 v35, v33
    s_nop 0
    v_permlane16_swap_b32 v32, v34
    v_permlane16_swap_b32 v33, v35
    v_add_f32 v32, v32, v34
    v_add_f32 v33, v33, v35
    v_mov_b32 v34, v32
    v_mov_b32 v35, v33
    s_nop 0
    v_permlane32_swap_b32 v32, v34
    v_permlane32_swap_b32 v33, v35
    v_add_f32 v32, v32, v34
    v_add_f32 v33, v33, v35
    v_mul_f32 v32, 0x3ae38e39, v32
    v_mul_f32 v33, 0x3ae38e39, v33
    v_fma_f32 v33, -v32, v32, v33
    v_max_f32 v33, 0, v33
    v_add_f32 v34, 0x3727c5ac, v33
    v_rsq_f32 v34, v34
    v_add_f32 v24, v24, v28
    v_add_f32 v25, v25, v29
    v_add_f32 v26, v26, v30
    v_add_f32 v27, v27, v31
    v_add_f32_dpp v24, v24, v24 quad_perm:[1,0,3,2] row_mask:0xf bank_mask:0xf
    v_add_f32_dpp v25, v25, v25 quad_perm:[1,0,3,2] row_mask:0xf bank_mask:0xf
    v_add_f32_dpp v26, v26, v26 quad_perm:[1,0,3,2] row_mask:0xf bank_mask:0xf
    v_add_f32_dpp v27, v27, v27 quad_perm:[1,0,3,2] row_mask:0xf bank_mask:0xf
    v_add_f32_dpp v24, v24, v24 quad_perm:[2,3,0,1] row_mask:0xf bank_mask:0xf
    v_add_f32_dpp v25, v25, v25 quad_perm:[2,3,0,1] row_mask:0xf bank_mask:0xf
    v_add_f32_dpp v26, v26, v26 quad_perm:[2,3,0,1] row_mask:0xf bank_mask:0xf
    v_add_f32_dpp v27, v27, v27 quad_perm:[2,3,0,1] row_mask:0xf bank_mask:0xf
    v_add_f32_dpp v24, v24, v24 row_half_mirror row_mask:0xf bank_mask:0xf
    v_add_f32_dpp v25, v25, v25 row_half_mirror row_mask:0xf bank_mask:0xf
    v_add_f32_dpp v26, v26, v26 row_half_mirror row_mask:0xf bank_mask:0xf
    v_add_f32_dpp v27, v27, v27 row_half_mirror row_mask:0xf bank_mask:0xf
    v_add_f32_dpp v24, v24, v24 row_mirror row_mask:0xf bank_mask:0xf
    v_add_f32_dpp v25, v25, v25 row_mirror row_mask:0xf bank_mask:0xf
    v_add_f32_dpp v26, v26, v26 row_mirror row_mask:0xf bank_mask:0xf
    v_add_f32_dpp v27, v27, v27 row_mirror row_mask:0xf bank_mask:0xf
    v_fma_f32 v24, -v32, v56, v24
    v_fma_f32 v25, -v32, v57, v25
    v_fma_f32 v26, -v32, v58, v26
    v_fma_f32 v27, -v32, v59, v27
    v_mul_f32 v24, v24, v34
    v_mul_f32 v25, v25, v34
    v_mul_f32 v26, v26, v34
    v_mul_f32 v27, v27, v34
    v_lshrrev_b32 v3, 8, v0
    v_mov_b32 v6, 0x3eae1a93
    s_cmp_ge_u32 s71, 4
    s_cselect_b32 s75, 0, 0x00010001
    s_mov_b32 exec_hi, s75
    v_mul_f32 v24, v24, v6
    v_mul_f32 v25, v25, v6
    v_mul_f32 v26, v26, v6
    v_mul_f32 v27, v27, v6
    s_mov_b32 exec_hi, -1
    v_cvt_pk_bf16_f32 v8, v24, v25
    v_cvt_pk_bf16_f32 v9, v26, v27
    v_lshlrev_b32 v2, 3, v3
    s_lshl_b32 s74, s71, 5
    s_add_u32 s74, s74, s64
    s_add_u32 s74, s74, 12683264
    s_cmp_eq_u32 s71, 5
    s_cbranch_scc1 L_R_kv
    s_mov_b32 exec_lo, 0x00010001
    s_mov_b32 exec_hi, s75
    buffer_store_dwordx2 v[8:9], v2, s[36:39], s74 offen sc1
    s_branch L_end
L_R_kv:
    s_lshr_b32 s77, s67, 7
    s_mul_i32 s77, s77, 9472
    s_add_u32 s77, s77, 163840
    s_bfe_u32 s78, s67, 0x20005
    s_and_b32 s18, s67, 31
    s_mov_b32 exec_lo, 0
    s_mov_b32 exec_hi, 0x00010001
    v_and_b32 v3, 1, v3
    s_cmp_eq_u32 s5, 4
    s_cbranch_scc1 L_R_kb
    s_cmp_ge_u32 s5, 2
    s_cbranch_scc1 L_R_v
    s_lshl_b32 s78, s78, 10
    s_add_u32 s77, s77, s78
    s_lshl_b32 s78, s5, 9
    s_add_u32 s77, s77, s78
    s_lshl_b32 s78, s18, 4
    s_add_u32 s77, s77, s78
    v_lshlrev_b32 v3, 3, v3
    buffer_store_dwordx2 v[8:9], v3, s[36:39], s77 offen sc1
    s_branch L_R_done
L_R_kb:
    s_lshl_b32 s78, s78, 7
    s_add_u32 s77, s77, s78
    s_lshl_b32 s78, s18, 2
    s_add_u32 s77, s77, s78
    s_add_u32 s77, s77, 8960
    s_mov_b32 exec_hi, 0x00010000
    buffer_store_dword v9, off, s[36:39], s77 sc1
    s_branch L_R_done
L_R_v:
    s_mul_i32 s78, s78, 1216
    s_add_u32 s77, s77, s78
    s_lshr_b32 s78, s18, 4
    s_mul_i32 s78, s78, 608
    s_add_u32 s77, s77, s78
    s_bfe_u32 s78, s18, 0x10002
    s_mul_i32 s78, s78, 304
    s_add_u32 s77, s77, s78
    s_and_b32 s78, s18, 8
    s_add_u32 s77, s77, s78
    s_and_b32 s78, s18, 3
    s_lshl_b32 s78, s78, 1
    s_add_u32 s77, s77, s78
    s_add_u32 s77, s77, 4096
    s_cmp_eq_u32 s5, 5
    s_cbranch_scc1 L_R_v5
    s_and_b32 s78, s5, 1
    s_lshl_b32 s78, s78, 6
    s_add_u32 s77, s77, s78
    v_lshlrev_b32 v3, 7, v3
    buffer_store_short v8, v3, s[36:39], s77 offen sc1
    buffer_store_short_d16_hi v8, v3, s[36:39], s77 offen offset:16 sc1
    buffer_store_short v9, v3, s[36:39], s77 offen offset:32 sc1
    buffer_store_short_d16_hi v9, v3, s[36:39], s77 offen offset:48 sc1
    s_branch L_R_done
L_R_v5:
    s_mov_b32 exec_hi, 0x00010000
    buffer_store_short v9, off, s[36:39], s77 offset:256 sc1
    buffer_store_short_d16_hi v9, off, s[36:39], s77 offset:272 sc1
L_R_done:
    s_lshl_b32 s74, s5, 2
    s_add_u32 s74, s74, 12685312
    s_mov_b64 exec, 1
    v_mov_b32 v2, 1
    s_waitcnt vmcnt(0)
    buffer_store_dword v2, off, s[36:39], s74 sc1
    s_branch L_end
L_slow5:
L_w141:
    ds_read_b32 v5, v1
    s_waitcnt lgkmcnt(0)
    v_cmp_gt_u32 vcc, s72, v5
    s_and_b32 s79, vcc_lo, 0x800
    s_cbranch_scc0 L_wd142
    s_sub_i32 s34, s34, 1
    s_cmp_gt_i32 s34, 0
    s_cbranch_scc1 L_w141
L_wd142:
    s_branch L_back6
L_slow9:
L_w143:
    ds_read_b32 v5, v1
    s_waitcnt lgkmcnt(0)
    v_cmp_gt_u32 vcc, s72, v5
    s_and_b32 s79, vcc_lo, 0x800
    s_cbranch_scc0 L_wd144
    s_sub_i32 s34, s34, 1
    s_cmp_gt_i32 s34, 0
    s_cbranch_scc1 L_w143
L_wd144:
    s_branch L_back10
L_slow13:
L_w145:
    ds_read_b32 v5, v1
    s_waitcnt lgkmcnt(0)
    v_cmp_gt_u32 vcc, s72, v5
    s_and_b32 s79, vcc_lo, 0x800
    s_cbranch_scc0 L_wd146
    s_sub_i32 s34, s34, 1
    s_cmp_gt_i32 s34, 0
    s_cbranch_scc1 L_w145
L_wd146:
    s_branch L_back14
L_slow17:
L_w147:
    ds_read_b32 v5, v1
    s_waitcnt lgkmcnt(0)
    v_cmp_gt_u32 vcc, s72, v5
    s_and_b32 s79, vcc_lo, 0x800
    s_cbranch_scc0 L_wd148
    s_sub_i32 s34, s34, 1
    s_cmp_gt_i32 s34, 0
    s_cbranch_scc1 L_w147
L_wd148:
    s_branch L_back18
L_sl21:
    buffer_store_dwordx4 v[36:39], v3, s[36:39], s75 offen sc1
    s_mov_b32 exec_hi, 0
    buffer_store_dword v40, v4, s[36:39], s75 offen offset:2048 sc1
    s_mov_b64 exec, -1
    s_branch L_sb22
L_prs:
L_w149:
    ds_read_b32 v5, v1
    s_waitcnt lgkmcnt(0)
    v_cmp_gt_u32 vcc, s73, v5
    s_and_b32 s79, vcc_lo, 0x20ff
    s_cbranch_scc0 L_wd150
    s_sub_i32 s34, s34, 1
    s_cmp_gt_i32 s34, 0
    s_cbranch_scc1 L_w149
L_wd150:
    s_cmp_gt_i32 s34, 0
    s_cbranch_scc1 L_pr0
    s_branch L_pr2
L_prp:
    ds_read_b32 v5, v1
    ds_read_b128 v[68:71], v6
    ds_read_b128 v[72:75], v6 offset:1024
    ds_read2st64_b32 v[76:77], v7 offset0:0 offset1:1
    ds_read_b32 v78, v7 offset:128
    s_waitcnt lgkmcnt(0)
    v_cmp_gt_u32 vcc, s72, v5
    s_and_b32 s79, vcc_lo, s77
    s_cbranch_scc0 L_pr1
    s_sub_i32 s34, s34, 1
    s_cmp_gt_i32 s34, 0
    s_cbranch_scc1 L_prp
    s_branch L_pr1
L_prx:
    v_bfe_u32 v2, v0, 4, 4
    v_cmp_eq_u32 vcc, s18, v2
    v_lshrrev_b32 v2, 8, v0
    v_lshlrev_b32 v2, 3, v2
    s_add_u32 s8, s64, 12681216
    s_mov_b64 exec, vcc
    buffer_load_dwordx2 v[132:133], v2, s[36:39], s8 offen offset:0 sc1
    buffer_load_dwordx2 v[134:135], v2, s[36:39], s8 offen offset:32 sc1
    buffer_load_dwordx2 v[136:137], v2, s[36:39], s8 offen offset:64 sc1
    buffer_load_dwordx2 v[138:139], v2, s[36:39], s8 offen offset:96 sc1
    buffer_load_dwordx2 v[140:141], v2, s[36:39], s8 offen offset:128 sc1
    s_mov_b64 exec, -1
    s_branch L_att_nosel
L_att_fin:
    v_rcp_f32 v6, v110
    s_nop 0
    v_pk_mul_f32 v[100:101], v[100:101], v[6:7] op_sel_hi:[1,0]
    v_pk_mul_f32 v[102:103], v[102:103], v[6:7] op_sel_hi:[1,0]
    v_pk_mul_f32 v[104:105], v[104:105], v[6:7] op_sel_hi:[1,0]
    v_pk_mul_f32 v[106:107], v[106:107], v[6:7] op_sel_hi:[1,0]
    v_pk_mul_f32 v[108:109], v[108:109], v[6:7] op_sel_hi:[1,0]
    v_cvt_pk_bf16_f32 v36, v100, v101
    v_cvt_pk_bf16_f32 v37, v102, v103
    v_cvt_pk_bf16_f32 v38, v104, v105
    v_cvt_pk_bf16_f32 v39, v106, v107
    v_cvt_pk_bf16_f32 v40, v108, v109
    s_branch L_att_st
L_fallback:
    v_mov_b32 v18, v16
    s_mov_b32 exec_lo, 0
    v_mov_b32 v18, 0
    s_mov_b32 exec_lo, -1
    v_mov_b32 v19, 0
    s_mov_b32 s18, 0
    s_mov_b32 s19, 64
    s_mul_i32 s73, s35, 163840
    v_lshrrev_b32 v54, 9, v0
    v_mul_u32_u24 v54, 304, v54
    v_and_b32 v57, 0x1f0, v0
    v_add_u32 v56, v54, v57
    v_cmp_gt_u32 vcc, 304, v57
    v_mov_b32 v54, 2130706432
    s_nop 0
    v_cndmask_b32 v56, v54, v56, vcc
    v_lshrrev_b32 v57, 2, v57
    v_mov_b32 v52, 0xff61b1e6
    v_mov_b32 v21, 0
    v_mov_b32 v100, 0
    v_mov_b32 v101, 0
    v_mov_b32 v102, 0
    v_mov_b32 v103, 0
    v_mov_b32 v104, 0
    v_mov_b32 v105, 0
    v_mov_b32 v106, 0
    v_mov_b32 v107, 0
    v_mov_b32 v108, 0
    v_mov_b32 v109, 0
    v_mov_b32 v110, 0
    v_mov_b32 v111, 0
    v_mov_b32 v112, 0
    v_mov_b32 v113, 0
    v_mov_b32 v114, 0
    v_mov_b32 v115, 0
L_st151:
    s_lshr_b32 s76, s18, 2
    s_mul_i32 s76, s76, 9472
    s_add_u32 s76, s76, s73
    s_and_b32 s77, s18, 3
    s_lshl_b32 s78, s77, 10
    s_add_u32 s78, s78, s76
    buffer_load_dwordx4 v[24:27], v0, s[36:39], s78 offen sc1
    s_lshl_b32 s78, s77, 7
    s_add_u32 s78, s78, s76
    s_add_u32 s78, s78, 8960
    buffer_load_dword v20, v57, s[36:39], s78 offen sc1
    s_mul_i32 s78, s77, 1216
    s_add_u32 s78, s78, s76
    s_add_u32 s78, s78, 4096
    buffer_load_dwordx4 v[28:31], v56, s[36:39], s78 offen sc1
    buffer_load_dwordx4 v[32:35], v56, s[36:39], s78 offen offset:608 sc1
    s_waitcnt vmcnt(2)
    v_mfma_f32_32x32x16_bf16 v[36:51], v[24:27], v[8:11], 0
    v_mfma_f32_32x32x8_bf16 v[36:51], v[20:21], v[18:19], v[36:51]
    s_nop 11
    v_max3_f32 v54, v36, v37, v52
    v_max3_f32 v54, v38, v39, v54
    v_max3_f32 v54, v40, v41, v54
    v_max3_f32 v54, v42, v43, v54
    v_max3_f32 v54, v44, v45, v54
    v_max3_f32 v54, v46, v47, v54
    v_max3_f32 v54, v48, v49, v54
    v_max3_f32 v54, v50, v51, v54
    v_mov_b32 v55, v54
    s_nop 1
    v_permlane32_swap_b32 v54, v55
    v_max_f32 v54, v54, v55
    v_sub_f32 v55, v52, v54
    v_exp_f32 v55, v55
    v_mov_b32 v52, v54
    v_sub_f32 v36, v36, v52
    v_sub_f32 v37, v37, v52
    v_sub_f32 v38, v38, v52
    v_sub_f32 v39, v39, v52
    v_sub_f32 v40, v40, v52
    v_sub_f32 v41, v41, v52
    v_sub_f32 v42, v42, v52
    v_sub_f32 v43, v43, v52
    v_sub_f32 v44, v44, v52
    v_sub_f32 v45, v45, v52
    v_sub_f32 v46, v46, v52
    v_sub_f32 v47, v47, v52
    v_sub_f32 v48, v48, v52
    v_sub_f32 v49, v49, v52
    v_sub_f32 v50, v50, v52
    v_sub_f32 v51, v51, v52
    v_exp_f32 v36, v36
    v_exp_f32 v37, v37
    v_exp_f32 v38, v38
    v_exp_f32 v39, v39
    v_exp_f32 v40, v40
    v_exp_f32 v41, v41
    v_exp_f32 v42, v42
    v_exp_f32 v43, v43
    v_exp_f32 v44, v44
    v_exp_f32 v45, v45
    v_exp_f32 v46, v46
    v_exp_f32 v47, v47
    v_exp_f32 v48, v48
    v_exp_f32 v49, v49
    v_exp_f32 v50, v50
    v_exp_f32 v51, v51
    v_mul_f32 v100, v100, v55
    v_mul_f32 v101, v101, v55
    v_mul_f32 v102, v102, v55
    v_mul_f32 v103, v103, v55
    v_mul_f32 v104, v104, v55
    v_mul_f32 v105, v105, v55
    v_mul_f32 v106, v106, v55
    v_mul_f32 v107, v107, v55
    v_mul_f32 v108, v108, v55
    v_mul_f32 v109, v109, v55
    v_mul_f32 v110, v110, v55
    v_cvt_pk_bf16_f32 v36, v36, v37
    v_cvt_pk_bf16_f32 v37, v38, v39
    v_cvt_pk_bf16_f32 v38, v40, v41
    v_cvt_pk_bf16_f32 v39, v42, v43
    v_cvt_pk_bf16_f32 v40, v44, v45
    v_cvt_pk_bf16_f32 v41, v46, v47
    v_cvt_pk_bf16_f32 v42, v48, v49
    v_cvt_pk_bf16_f32 v43, v50, v51
    s_waitcnt vmcnt(0)
    v_mfma_f32_32x32x16_bf16 v[100:115], v[28:31], v[36:39], v[100:115]
    v_mfma_f32_32x32x16_bf16 v[100:115], v[32:35], v[40:43], v[100:115]
    s_add_u32 s18, s18, 1
    s_cmp_lt_u32 s18, s19
    s_cbranch_scc1 L_st151
    s_nop 8
    v_mov_b32 v6, v110
    s_nop 1
    v_permlane32_swap_b32 v110, v6
    s_branch L_att_fin
L_cr36:
    buffer_load_dwordx4 v[68:71], v6, s[36:39], s77 offen offset:3072 sc1
    buffer_load_dwordx4 v[72:75], v6, s[36:39], s78 offen offset:0 sc1
    buffer_load_dwordx4 v[76:79], v6, s[36:39], s78 offen offset:1024 sc1
    s_or_b32 s16, s16, 32
L_cr36b:
    s_mov_b32 s73, 5
    s_branch L_cc152
L_cr34:
    buffer_load_dwordx4 v[56:59], v6, s[36:39], s77 offen offset:0 sc1
    buffer_load_dwordx4 v[60:63], v6, s[36:39], s77 offen offset:1024 sc1
    buffer_load_dwordx4 v[64:67], v6, s[36:39], s77 offen offset:2048 sc1
    s_or_b32 s16, s16, 48
L_cr34b:
    s_mov_b32 s73, 4
    s_branch L_cc152
L_cr32:
    buffer_load_dwordx4 v[44:47], v6, s[36:39], s76 offen offset:1024 sc1
    buffer_load_dwordx4 v[48:51], v6, s[36:39], s76 offen offset:2048 sc1
    buffer_load_dwordx4 v[52:55], v6, s[36:39], s76 offen offset:3072 sc1
    s_or_b32 s16, s16, 56
L_cr32b:
    s_mov_b32 s73, 3
    s_branch L_cc152
L_cr30:
    buffer_load_dwordx4 v[32:35], v6, s[36:39], s75 offen offset:2048 sc1
    buffer_load_dwordx4 v[36:39], v6, s[36:39], s75 offen offset:3072 sc1
    buffer_load_dwordx4 v[40:43], v6, s[36:39], s76 offen offset:0 sc1
    s_or_b32 s16, s16, 60
L_cr30b:
    s_mov_b32 s73, 2
    s_branch L_cc152
L_cr28:
    buffer_load_dwordx4 v[20:23], v6, s[36:39], s74 offen offset:3072 sc1
    buffer_load_dwordx4 v[24:27], v6, s[36:39], s75 offen offset:0 sc1
    buffer_load_dwordx4 v[28:31], v6, s[36:39], s75 offen offset:1024 sc1
    s_or_b32 s16, s16, 30
L_cr28b:
    s_mov_b32 s73, 1
    s_branch L_cc152
L_cr26:
    buffer_load_dwordx4 v[8:11], v6, s[36:39], s74 offen offset:0 sc1
    buffer_load_dwordx4 v[12:15], v6, s[36:39], s74 offen offset:1024 sc1
    buffer_load_dwordx4 v[16:19], v6, s[36:39], s74 offen offset:2048 sc1
    s_or_b32 s16, s16, 15
    s_mov_b32 s73, 0
L_cc152:
    s_sub_i32 s34, s34, 16
    s_cmp_gt_i32 s34, 0
    s_cselect_b32 s69, s69, -1
    s_waitcnt vmcnt(0)
    s_bitcmp1_b32 s16, 0
    s_cbranch_scc0 L_cs153
    v_max3_u32 v7, v8, v9, v10
    v_max3_u32 v7, v7, v11, v12
    v_max3_u32 v7, v7, v13, v14
    v_max3_u32 v7, v7, v15, v16
    v_max3_u32 v7, v7, v17, v18
    v_max_u32 v7, v7, v19
    v_cmp_lt_u32 vcc, s69, v7
    s_bitset0_b32 s16, 0
    s_cbranch_vccz L_cs153
    buffer_load_dwordx4 v[8:11], v6, s[36:39], s74 offen offset:0 sc1
    buffer_load_dwordx4 v[12:15], v6, s[36:39], s74 offen offset:1024 sc1
    buffer_load_dwordx4 v[16:19], v6, s[36:39], s74 offen offset:2048 sc1
    s_bitset1_b32 s16, 0
L_cs153:
    s_bitcmp1_b32 s16, 1
    s_cbranch_scc0 L_cs154
    v_max3_u32 v7, v20, v21, v22
    v_max3_u32 v7, v7, v23, v24
    v_max3_u32 v7, v7, v25, v26
    v_max3_u32 v7, v7, v27, v28
    v_max3_u32 v7, v7, v29, v30
    v_max_u32 v7, v7, v31
    v_cmp_lt_u32 vcc, s69, v7
    s_bitset0_b32 s16, 1
    s_cbranch_vccz L_cs154
    buffer_load_dwordx4 v[20:23], v6, s[36:39], s74 offen offset:3072 sc1
    buffer_load_dwordx4 v[24:27], v6, s[36:39], s75 offen offset:0 sc1
    buffer_load_dwordx4 v[28:31], v6, s[36:39], s75 offen offset:1024 sc1
    s_bitset1_b32 s16, 1
L_cs154:
    s_bitcmp1_b32 s16, 2
    s_cbranch_scc0 L_cs155
    v_max3_u32 v7, v32, v33, v34
    v_max3_u32 v7, v7, v35, v36
    v_max3_u32 v7, v7, v37, v38
    v_max3_u32 v7, v7, v39, v40
    v_max3_u32 v7, v7, v41, v42
    v_max_u32 v7, v7, v43
    v_cmp_lt_u32 vcc, s69, v7
    s_bitset0_b32 s16, 2
    s_cbranch_vccz L_cs155
    buffer_load_dwordx4 v[32:35], v6, s[36:39], s75 offen offset:2048 sc1
    buffer_load_dwordx4 v[36:39], v6, s[36:39], s75 offen offset:3072 sc1
    buffer_load_dwordx4 v[40:43], v6, s[36:39], s76 offen offset:0 sc1
    s_bitset1_b32 s16, 2
L_cs155:
    s_bitcmp1_b32 s16, 3
    s_cbranch_scc0 L_cs156
    v_max3_u32 v7, v44, v45, v46
    v_max3_u32 v7, v7, v47, v48
    v_max3_u32 v7, v7, v49, v50
    v_max3_u32 v7, v7, v51, v52
    v_max3_u32 v7, v7, v53, v54
    v_max_u32 v7, v7, v55
    v_cmp_lt_u32 vcc, s69, v7
    s_bitset0_b32 s16, 3
    s_cbranch_vccz L_cs156
    buffer_load_dwordx4 v[44:47], v6, s[36:39], s76 offen offset:1024 sc1
    buffer_load_dwordx4 v[48:51], v6, s[36:39], s76 offen offset:2048 sc1
    buffer_load_dwordx4 v[52:55], v6, s[36:39], s76 offen offset:3072 sc1
    s_bitset1_b32 s16, 3
L_cs156:
    s_bitcmp1_b32 s16, 4
    s_cbranch_scc0 L_cs157
    v_max3_u32 v7, v56, v57, v58
    v_max3_u32 v7, v7, v59, v60
    v_max3_u32 v7, v7, v61, v62
    v_max3_u32 v7, v7, v63, v64
    v_max3_u32 v7, v7, v65, v66
    v_max_u32 v7, v7, v67
    v_cmp_lt_u32 vcc, s69, v7
    s_bitset0_b32 s16, 4
    s_cbranch_vccz L_cs157
    buffer_load_dwordx4 v[56:59], v6, s[36:39], s77 offen offset:0 sc1
    buffer_load_dwordx4 v[60:63], v6, s[36:39], s77 offen offset:1024 sc1
    buffer_load_dwordx4 v[64:67], v6, s[36:39], s77 offen offset:2048 sc1
    s_bitset1_b32 s16, 4
L_cs157:
    s_bitcmp1_b32 s16, 5
    s_cbranch_scc0 L_cs158
    v_max3_u32 v7, v68, v69, v70
    v_max3_u32 v7, v7, v71, v72
    v_max3_u32 v7, v7, v73, v74
    v_max3_u32 v7, v7, v75, v76
    v_max3_u32 v7, v7, v77, v78
    v_max_u32 v7, v7, v79
    v_cmp_lt_u32 vcc, s69, v7
    s_bitset0_b32 s16, 5
    s_cbranch_vccz L_cs158
    buffer_load_dwordx4 v[68:71], v6, s[36:39], s77 offen offset:3072 sc1
    buffer_load_dwordx4 v[72:75], v6, s[36:39], s78 offen offset:0 sc1
    buffer_load_dwordx4 v[76:79], v6, s[36:39], s78 offen offset:1024 sc1
    s_bitset1_b32 s16, 5
L_cs158:
    s_bitcmp1_b32 s16, s73
    s_cbranch_scc1 L_cc152
    s_cmp_eq_u32 s73, 0
    s_cbranch_scc1 L_cg25
    s_cmp_eq_u32 s73, 1
    s_cbranch_scc1 L_cg27
    s_cmp_eq_u32 s73, 2
    s_cbranch_scc1 L_cg29
    s_cmp_eq_u32 s73, 3
    s_cbranch_scc1 L_cg31
    s_cmp_eq_u32 s73, 4
    s_cbranch_scc1 L_cg33
    s_branch L_cg35
L_sl37:
    buffer_store_dwordx4 v[8:11], v3, s[36:39], s75 offen sc1
    buffer_store_dwordx4 v[12:15], v3, s[36:39], s75 offen offset:1024 sc1
    s_branch L_sb38
L_sl39:
    buffer_store_dwordx2 v[16:17], v4, s[36:39], s75 offen offset:2048 sc1
    s_branch L_sb40
L_sl41:
    buffer_store_dwordx3 v[30:32], v0, s[36:39], s76 offen sc1
    s_branch L_sb42
L_gs58:
L_w159:
    ds_read_b32 v7, v1
    s_waitcnt lgkmcnt(0)
    v_cmp_gt_u32 vcc, 2, v7
    s_and_b32 s79, vcc_lo, 0xf0000
    s_cbranch_scc0 L_wd160
    s_sub_i32 s34, s34, 1
    s_cmp_gt_i32 s34, 0
    s_cbranch_scc1 L_w159
L_wd160:
    s_branch L_gb59
L_gs62:
L_w161:
    ds_read_b32 v7, v1
    s_waitcnt lgkmcnt(0)
    v_cmp_gt_u32 vcc, s13, v7
    s_and_b32 s79, vcc_lo, 0xf0000
    s_cbranch_scc0 L_wd162
    s_sub_i32 s34, s34, 1
    s_cmp_gt_i32 s34, 0
    s_cbranch_scc1 L_w161
L_wd162:
    s_branch L_gb63
L_gs66:
L_w163:
    ds_read_b32 v7, v1
    s_waitcnt lgkmcnt(0)
    v_cmp_gt_u32 vcc, 3, v7
    s_and_b32 s79, vcc_lo, 0xf0000
    s_cbranch_scc0 L_wd164
    s_sub_i32 s34, s34, 1
    s_cmp_gt_i32 s34, 0
    s_cbranch_scc1 L_w163
L_wd164:
    s_branch L_gb67
L_qts:
L_w165:
    ds_read_b32 v7, v1
    s_waitcnt lgkmcnt(0)
    v_cmp_gt_u32 vcc, 2, v7
    s_and_b32 s79, vcc_hi, s14
    s_cbranch_scc0 L_wd166
    s_sub_i32 s34, s34, 1
    s_cmp_gt_i32 s34, 0
    s_cbranch_scc1 L_w165
L_wd166:
    s_branch L_qtb
L_cr71:
    buffer_load_dwordx4 v[68:71], v0, s[36:39], s77 offen offset:3072 sc1
    buffer_load_dwordx4 v[72:75], v0, s[36:39], s78 offen offset:0 sc1
    buffer_load_dwordx4 v[76:79], v0, s[36:39], s78 offen offset:1024 sc1
    s_or_b32 s16, s16, 32
L_cr71b:
    s_mov_b32 s73, 5
    s_branch L_cc167
L_cr69:
    buffer_load_dwordx4 v[56:59], v0, s[36:39], s77 offen offset:0 sc1
    buffer_load_dwordx4 v[60:63], v0, s[36:39], s77 offen offset:1024 sc1
    buffer_load_dwordx4 v[64:67], v0, s[36:39], s77 offen offset:2048 sc1
    s_or_b32 s16, s16, 48
L_cr69b:
    s_mov_b32 s73, 4
    s_branch L_cc167
L_cr65:
    buffer_load_dwordx4 v[44:47], v0, s[36:39], s76 offen offset:1024 sc1
    buffer_load_dwordx4 v[48:51], v0, s[36:39], s76 offen offset:2048 sc1
    buffer_load_dwordx4 v[52:55], v0, s[36:39], s76 offen offset:3072 sc1
    s_or_b32 s16, s16, 56
L_cr65b:
    s_mov_b32 s73, 3
    s_branch L_cc167
L_cr61:
    buffer_load_dwordx4 v[32:35], v0, s[36:39], s75 offen offset:2048 sc1
    buffer_load_dwordx4 v[36:39], v0, s[36:39], s75 offen offset:3072 sc1
    buffer_load_dwordx4 v[40:43], v0, s[36:39], s76 offen offset:0 sc1
    s_or_b32 s16, s16, 60
L_cr61b:
    s_mov_b32 s73, 2
    s_branch L_cc167
L_cr56:
    buffer_load_dwordx4 v[20:23], v0, s[36:39], s74 offen offset:3072 sc1
    buffer_load_dwordx4 v[24:27], v0, s[36:39], s75 offen offset:0 sc1
    buffer_load_dwordx4 v[28:31], v0, s[36:39], s75 offen offset:1024 sc1
    s_or_b32 s16, s16, 30
L_cr56b:
    s_mov_b32 s73, 1
    s_branch L_cc167
L_cr53:
    buffer_load_dwordx4 v[8:11], v0, s[36:39], s74 offen offset:0 sc1
    buffer_load_dwordx4 v[12:15], v0, s[36:39], s74 offen offset:1024 sc1
    buffer_load_dwordx4 v[16:19], v0, s[36:39], s74 offen offset:2048 sc1
    s_or_b32 s16, s16, 15
    s_mov_b32 s73, 0
L_cc167:
    s_sub_i32 s34, s34, 16
    s_cmp_gt_i32 s34, 0
    s_cselect_b32 s69, s69, -1
    s_waitcnt vmcnt(0)
    s_bitcmp1_b32 s16, 0
    s_cbranch_scc0 L_cs168
    v_max3_u32 v7, v8, v9, v10
    v_max3_u32 v7, v7, v11, v12
    v_max3_u32 v7, v7, v13, v14
    v_max3_u32 v7, v7, v15, v16
    v_max3_u32 v7, v7, v17, v18
    v_max_u32 v7, v7, v19
    v_cmp_lt_u32 vcc, s69, v7
    s_bitset0_b32 s16, 0
    s_cbranch_vccz L_cs168
    buffer_load_dwordx4 v[8:11], v0, s[36:39], s74 offen offset:0 sc1
    buffer_load_dwordx4 v[12:15], v0, s[36:39], s74 offen offset:1024 sc1
    buffer_load_dwordx4 v[16:19], v0, s[36:39], s74 offen offset:2048 sc1
    s_bitset1_b32 s16, 0
L_cs168:
    s_bitcmp1_b32 s16, 1
    s_cbranch_scc0 L_cs169
    v_max3_u32 v7, v20, v21, v22
    v_max3_u32 v7, v7, v23, v24
    v_max3_u32 v7, v7, v25, v26
    v_max3_u32 v7, v7, v27, v28
    v_max3_u32 v7, v7, v29, v30
    v_max_u32 v7, v7, v31
    v_cmp_lt_u32 vcc, s69, v7
    s_bitset0_b32 s16, 1
    s_cbranch_vccz L_cs169
    buffer_load_dwordx4 v[20:23], v0, s[36:39], s74 offen offset:3072 sc1
    buffer_load_dwordx4 v[24:27], v0, s[36:39], s75 offen offset:0 sc1
    buffer_load_dwordx4 v[28:31], v0, s[36:39], s75 offen offset:1024 sc1
    s_bitset1_b32 s16, 1
L_cs169:
    s_bitcmp1_b32 s16, 2
    s_cbranch_scc0 L_cs170
    v_max3_u32 v7, v32, v33, v34
    v_max3_u32 v7, v7, v35, v36
    v_max3_u32 v7, v7, v37, v38
    v_max3_u32 v7, v7, v39, v40
    v_max3_u32 v7, v7, v41, v42
    v_max_u32 v7, v7, v43
    v_cmp_lt_u32 vcc, s69, v7
    s_bitset0_b32 s16, 2
    s_cbranch_vccz L_cs170
    buffer_load_dwordx4 v[32:35], v0, s[36:39], s75 offen offset:2048 sc1
    buffer_load_dwordx4 v[36:39], v0, s[36:39], s75 offen offset:3072 sc1
    buffer_load_dwordx4 v[40:43], v0, s[36:39], s76 offen offset:0 sc1
    s_bitset1_b32 s16, 2
L_cs170:
    s_bitcmp1_b32 s16, 3
    s_cbranch_scc0 L_cs171
    v_max3_u32 v7, v44, v45, v46
    v_max3_u32 v7, v7, v47, v48
    v_max3_u32 v7, v7, v49, v50
    v_max3_u32 v7, v7, v51, v52
    v_max3_u32 v7, v7, v53, v54
    v_max_u32 v7, v7, v55
    v_cmp_lt_u32 vcc, s69, v7
    s_bitset0_b32 s16, 3
    s_cbranch_vccz L_cs171
    buffer_load_dwordx4 v[44:47], v0, s[36:39], s76 offen offset:1024 sc1
    buffer_load_dwordx4 v[48:51], v0, s[36:39], s76 offen offset:2048 sc1
    buffer_load_dwordx4 v[52:55], v0, s[36:39], s76 offen offset:3072 sc1
    s_bitset1_b32 s16, 3
L_cs171:
    s_bitcmp1_b32 s16, 4
    s_cbranch_scc0 L_cs172
    v_max3_u32 v7, v56, v57, v58
    v_max3_u32 v7, v7, v59, v60
    v_max3_u32 v7, v7, v61, v62
    v_max3_u32 v7, v7, v63, v64
    v_max3_u32 v7, v7, v65, v66
    v_max_u32 v7, v7, v67
    v_cmp_lt_u32 vcc, s69, v7
    s_bitset0_b32 s16, 4
    s_cbranch_vccz L_cs172
    buffer_load_dwordx4 v[56:59], v0, s[36:39], s77 offen offset:0 sc1
    buffer_load_dwordx4 v[60:63], v0, s[36:39], s77 offen offset:1024 sc1
    buffer_load_dwordx4 v[64:67], v0, s[36:39], s77 offen offset:2048 sc1
    s_bitset1_b32 s16, 4
L_cs172:
    s_bitcmp1_b32 s16, 5
    s_cbranch_scc0 L_cs173
    v_max3_u32 v7, v68, v69, v70
    v_max3_u32 v7, v7, v71, v72
    v_max3_u32 v7, v7, v73, v74
    v_max3_u32 v7, v7, v75, v76
    v_max3_u32 v7, v7, v77, v78
    v_max_u32 v7, v7, v79
    v_cmp_lt_u32 vcc, s69, v7
    s_bitset0_b32 s16, 5
    s_cbranch_vccz L_cs173
    buffer_load_dwordx4 v[68:71], v0, s[36:39], s77 offen offset:3072 sc1
    buffer_load_dwordx4 v[72:75], v0, s[36:39], s78 offen offset:0 sc1
    buffer_load_dwordx4 v[76:79], v0, s[36:39], s78 offen offset:1024 sc1
    s_bitset1_b32 s16, 5
L_cs173:
    s_bitcmp1_b32 s16, s73
    s_cbranch_scc1 L_cc167
    s_cmp_eq_u32 s73, 0
    s_cbranch_scc1 L_cg52
    s_cmp_eq_u32 s73, 1
    s_cbranch_scc1 L_cg55
    s_cmp_eq_u32 s73, 2
    s_cbranch_scc1 L_cg60
    s_cmp_eq_u32 s73, 3
    s_cbranch_scc1 L_cg64
    s_cmp_eq_u32 s73, 4
    s_cbranch_scc1 L_cg68
    s_branch L_cg70
L_end:
L_exit:
    s_endpgm
.section .rodata,"a"
.p2align 6
.amdhsa_kernel interleave_layers__grouped_kv_mqa__moe_arch_mod__prompt_kernel
  .amdhsa_next_free_vgpr 168
  .amdhsa_next_free_sgpr 102
  .amdhsa_accum_offset 168
  .amdhsa_group_segment_fixed_size 0
  .amdhsa_kernarg_size 104
  .amdhsa_user_sgpr_count 2
  .amdhsa_user_sgpr_kernarg_segment_ptr 1
  .amdhsa_system_sgpr_workgroup_id_x 1
.end_amdhsa_kernel
```
